```python
import torch

def _softmax(x, axis=-1):
    return torch.softmax(x, dim=axis)
def _gelu(x):
    return torch.nn.functional.gelu(x, approximate="tanh")
def _silu(x):
    return torch.nn.functional.silu(x)
def _sigmoid(x):
    return torch.sigmoid(x)
def _layernorm(x, axis=-1, eps=1e-5):
    m = x.mean(dim=axis, keepdim=True)
    v = x.var(dim=axis, keepdim=True, unbiased=False)
    return (x - m) / torch.sqrt(v + eps)
def _scatter_add(tgt, idx, src, axis=0):
    return tgt.clone().index_add_(axis, idx, src)
def _segment_sum(src, seg, n):
    out = torch.zeros((n,) + src.shape[1:], dtype=src.dtype)
    return out.index_add_(0, seg, src)
def _pad(x, pw):
    flat = tuple(v for pair in reversed(pw) for v in pair)
    return torch.nn.functional.pad(x, flat)

kernel_name = 'standalone__gqa_block_cached__near_ridge'

def setup_inputs():

    _w = (lambda a: (lambda t: t.to(torch.bfloat16) if t.is_floating_point() else t)(torch.as_tensor(a)))
    B, Sq, D = 16, 128, 640
    Hq, Hkv, Sk, Dh = 32, 32, 1024, 192
    assert Hq % Hkv == 0, (Hq, Hkv)
    return {
        "x": _w((lambda *s: torch.randn(*s, dtype=torch.bfloat16) * 0.8)(B, Sq, D)),
        "k_cache": _w((lambda *s: torch.randn(*s, dtype=torch.bfloat16) * 0.8)(B, Hkv, Sk, Dh)),
        "v_cache": _w((lambda *s: torch.randn(*s, dtype=torch.bfloat16) * 0.05)(B, Hkv, Sk, Dh)),
        "wq": _w((lambda *s: torch.randn(*s, dtype=torch.bfloat16) * 0.8)(D, Hq * Dh) * (D ** -0.5)),
        "wo": _w((lambda *s: torch.randn(*s, dtype=torch.bfloat16) * 0.05)(Hq * Dh, D) * ((Hq * Dh) ** -0.5)),
    }

def reference(x, k_cache, v_cache, wq, wo):
    B, Sq, D = x.shape
    Hq, Dh = 32, 192
    Hkv = k_cache.shape[1]
    rep = Hq // Hkv
    q = (lambda x, *d: x.permute(*d))((x @ wq).reshape(B, Sq, Hq, Dh), 0, 2, 1, 3)
    k = (lambda x, n, axis: torch.repeat_interleave(x, n, dim=axis))(k_cache, rep, axis=1)
    v = (lambda x, n, axis: torch.repeat_interleave(x, n, dim=axis))(v_cache, rep, axis=1)
    scores = torch.einsum("bhqd,bhkd->bhqk", q, k) * (Dh ** -0.5)
    p = _softmax(scores, axis=-1)
    o = torch.einsum("bhqk,bhkd->bhqd", p, v)
    return (lambda x, *d: x.permute(*d))(o, 0, 2, 1, 3).reshape(B, Sq, Hq * Dh) @ wo
```

```asm
; @launch grid=(256,1,1) block=(256,1,1) lds=163840
.amdgcn_target "amdgcn-amd-amdhsa--gfx950"
.text
.globl standalone__gqa_block_cached__near_ridge_kernel
.p2align 8
.type standalone__gqa_block_cached__near_ridge_kernel,@function
standalone__gqa_block_cached__near_ridge_kernel:
    s_cmp_ge_u32 s2, 256
    s_cbranch_scc1 L_end
    s_load_dwordx16 s[32:47], s[0:1], 0
    v_mov_b32 v242, v0
    s_and_b32 s52, s2, 7
    s_lshr_b32 s53, s2, 3
    s_getpc_b64 s[4:5]
    s_mov_b32 s6, L_end-standalone__gqa_block_cached__near_ridge_kernel-128
    s_mov_b32 s7, 0x20000
    v_lshl_add_u32 v6, v0, 5, s53
    v_lshlrev_b32 v34, 7, v6
    buffer_load_dword v243, v34, s[4:7], 0 offen
    v_lshrrev_b32 v6, 6, v0
    v_and_b32 v0, 63, v0
    v_readfirstlane_b32 s48, v6
    s_and_b32 s82, s52, 3
    s_and_b32 s81, s53, 3
    s_lshl_b32 s65, s82, 2
    s_add_u32 s65, s65, s81
    s_lshr_b32 s64, s52, 2
    s_lshl_b32 s64, s64, 3
    s_lshr_b32 s67, s53, 2
    s_add_u32 s64, s64, s67
    v_lshlrev_b32 v35, 4, v0
    s_mul_i32 s49, s48, 6144
    s_lshl_b32 s69, s48, 12
    s_mul_i32 s52, s65, 384
    s_mul_i32 s54, s48, 196608
    s_add_u32 s54, s54, s52
    v_add_u32 v8, 0, v0
    v_mul_u32_u24 v224, 2731, v8
    v_lshrrev_b32 v224, 16, v224
    v_lshlrev_b32 v8, 4, v224
    v_and_b32 v8, 0x20, v8
    v_xor_b32 v8, v8, v35
    v_mul_u32_u24 v9, 11904, v224
    v_add_u32 v24, v9, v8
    v_xor_b32 v8, 64, v24
    v_add_u32 v27, 95232, v8
    v_add_u32 v8, 64, v0
    v_mul_u32_u24 v225, 2731, v8
    v_lshrrev_b32 v225, 16, v225
    v_lshlrev_b32 v8, 4, v225
    v_and_b32 v8, 0x20, v8
    v_xor_b32 v8, v8, v35
    v_mul_u32_u24 v9, 11904, v225
    v_add_u32 v25, v9, v8
    v_xor_b32 v8, 64, v25
    v_add_u32 v28, 99328, v8
    v_add_u32 v8, 128, v0
    v_mul_u32_u24 v226, 2731, v8
    v_lshrrev_b32 v226, 16, v226
    v_lshlrev_b32 v8, 4, v226
    v_and_b32 v8, 0x20, v8
    v_xor_b32 v8, v8, v35
    v_mul_u32_u24 v9, 11904, v226
    v_add_u32 v26, v9, v8
    v_xor_b32 v8, 64, v26
    v_add_u32 v29, 99328, v8
    v_lshrrev_b32 v8, 3, v0
    v_mul_u32_u24 v8, 1152, v8
    v_and_b32 v9, 0x30, v0
    v_xor_b32 v9, v9, v35
    v_add_u32 v10, v8, v9
    v_xor_b32 v11, 64, v10
    s_and_b32 s52, s82, 1
    s_mul_i32 s52, s52, 20480
    s_sub_u32 s53, 20480, s52
    s_add_u32 s52, s52, 4096
    v_add_u32 v30, s52, v10
    s_add_u32 s52, s52, 9216
    v_add_u32 v31, s52, v11
    s_add_u32 s53, s53, 2048
    v_add_u32 v32, s53, v10
    s_add_u32 s53, s53, 9216
    v_add_u32 v33, s53, v11
    s_mul_i32 s3, s64, 163840
    s_mul_i32 s52, s48, 40960
    s_add_u32 s55, s3, s52
    s_add_u32 s55, s55, 20480
    s_mov_b32 s78, s67
    s_waitcnt lgkmcnt(0)
    s_mov_b32 s16, s38
    s_mov_b32 s17, s39
    s_mov_b32 s18, 7864320
    s_mov_b32 s19, 0x20000
    s_sub_u32 s20, s32, 24576
    s_subb_u32 s21, s33, 0
    s_mov_b32 s22, 2646016
    s_mov_b32 s23, 0x20000
    s_mov_b32 s28, s40
    s_mov_b32 s29, s41
    s_mov_b32 s30, 7864320
    s_mov_b32 s31, 0x20000
    s_add_u32 m0, 49152, s49
    s_add_u32 s67, s54, 6144
    buffer_load_dwordx4 v24, s[16:19], s67 offen offset:0 lds
    buffer_load_dwordx4 v25, s[16:19], s67 offen offset:1024 lds
    buffer_load_dwordx4 v26, s[16:19], s67 offen offset:2048 lds
    buffer_load_dwordx4 v27, s[16:19], s67 offen offset:3072 lds
    s_add_u32 m0, m0, 4096
    s_nop 0
    buffer_load_dwordx4 v28, s[16:19], s67 offen offset:0 lds
    buffer_load_dwordx4 v29, s[16:19], s67 offen offset:1024 lds
    s_add_u32 s67, s55, 0
    s_add_u32 m0, 32768, s69
    s_nop 0
    buffer_load_dwordx4 v30, s[20:23], s67 offen offset:0 lds
    buffer_load_dwordx4 v31, s[20:23], s67 offen offset:1024 lds
    buffer_load_dwordx4 v32, s[20:23], s67 offen offset:2048 lds
    buffer_load_dwordx4 v33, s[20:23], s67 offen offset:3072 lds
    s_add_u32 m0, 122880, s49
    s_add_u32 s67, s54, 0
    buffer_load_dwordx4 v24, s[16:19], s67 offen offset:0 lds
    buffer_load_dwordx4 v25, s[16:19], s67 offen offset:1024 lds
    buffer_load_dwordx4 v26, s[16:19], s67 offen offset:2048 lds
    buffer_load_dwordx4 v27, s[16:19], s67 offen offset:3072 lds
    s_add_u32 m0, m0, 4096
    s_nop 0
    buffer_load_dwordx4 v28, s[16:19], s67 offen offset:0 lds
    buffer_load_dwordx4 v29, s[16:19], s67 offen offset:1024 lds
    v_mul_u32_u24 v9, 21846, v0
    v_lshrrev_b32 v9, 16, v9
    v_mul_u32_u24 v9, 11904, v9
    v_mul_u32_u24 v10, 1152, v0
    s_cmp_lt_u32 s48, 2
    s_cselect_b64 vcc, -1, 0
    v_cndmask_b32 v9, 0, v9, vcc
    s_cselect_b32 s92, s16, s28
    s_cselect_b32 s93, s17, s29
    s_mov_b32 s59, 3072
    s_cselect_b32 s59, 786432, s59
    s_mul_i32 s52, s78, 98304
    s_mul_i32 s53, s65, 384
    s_add_u32 s52, s52, s53
    s_mul_i32 s53, s48, 6144
    s_add_u32 s52, s52, s53
    s_add_u32 s52, s52, 1572864
    s_mul_i32 s53, s2, 30720
    s_cmp_lt_u32 s48, 2
    s_cselect_b32 s101, s52, s53
    s_mul_i32 s52, s81, 40960
    s_add_u32 s52, s52, s3
    s_add_u32 s52, s52, 24960
    s_mov_b32 s94, 7864320
    s_mov_b32 s95, 0x20000
    s_cmp_eq_u32 s48, 2
    s_cselect_b64 vcc, -1, 0
    v_cndmask_b32 v9, v9, v10, vcc
    s_cselect_b32 s92, s20, s92
    s_cselect_b32 s93, s21, s93
    s_cselect_b32 s94, s22, s94
    s_cselect_b32 s59, 128, s59
    s_cselect_b32 s101, s52, s101
    s_cselect_b32 s52, 32, 24
    v_lshl_add_u32 v9, v0, 7, v9
    v_mov_b32 v10, 0x70000000
    v_cmp_gt_u32 vcc, s52, v0
    s_nop 1
    v_cndmask_b32 v241, v10, v9, vcc
    s_mul_i32 s83, s48, 5120
    v_lshlrev_b32 v9, 3, v224
    v_and_b32 v9, 0x30, v9
    v_xor_b32 v12, v9, v35
    v_xor_b32 v15, 64, v12
    v_lshlrev_b32 v9, 1, v9
    v_xor_b32 v18, v9, v35
    v_xor_b32 v21, 0, v18
    v_lshlrev_b32 v9, 3, v225
    v_and_b32 v9, 0x30, v9
    v_xor_b32 v13, v9, v35
    v_xor_b32 v16, 4160, v13
    v_lshlrev_b32 v9, 1, v9
    v_xor_b32 v19, v9, v35
    v_xor_b32 v22, 4096, v19
    v_lshlrev_b32 v9, 3, v226
    v_and_b32 v9, 0x30, v9
    v_xor_b32 v14, v9, v35
    v_xor_b32 v17, 4160, v14
    v_lshlrev_b32 v9, 1, v9
    v_xor_b32 v20, v9, v35
    v_xor_b32 v23, 4096, v20
    s_lshl_b32 s52, s64, 5
    s_add_u32 s52, s52, s65
    s_mul_i32 s50, s52, 393216
    s_add_u32 s50, s50, s49
    s_add_u32 s63, s50, 393216
    s_lshr_b32 s52, s2, 3
    s_add_u32 s52, s52, s2
    s_mul_i32 s52, s52, 5
    s_and_b32 s52, s52, 15
    s_mul_i32 s52, s52, 24576
    s_add_u32 s50, s50, s52
    s_mov_b32 s77, s50
    s_mov_b32 s51, 2
    s_mov_b32 s8, s34
    s_mov_b32 s9, s35
    s_mov_b32 s10, 201326592
    s_mov_b32 s11, 0x20000
    s_mov_b32 s24, s46
    s_mov_b32 s25, s47
    s_mov_b32 s26, 46235648
    s_mov_b32 s27, 0x20000
    s_mov_b32 s12, s36
    s_mov_b32 s13, s37
    s_mov_b32 s14, 201326592
    s_mov_b32 s15, 0x20000
    s_mov_b32 s84, s44
    s_mov_b32 s85, s45
    s_mov_b32 s86, 256
    s_mov_b32 s87, 0x20000
    s_mov_b32 s88, s42
    s_mov_b32 s89, s43
    s_mov_b32 s90, 2621440
    s_mov_b32 s91, 0x20000
    v_and_b32 v6, 15, v0
    v_lshrrev_b32 v7, 4, v0
    v_lshrrev_b32 v9, 1, v6
    v_xor_b32 v9, v9, v7
    v_lshlrev_b32 v9, 4, v9
    v_mul_u32_u24 v8, 384, v6
    v_add_u32 v36, v8, v9
    v_xor_b32 v37, 64, v36
    v_lshl_add_u32 v8, v6, 7, v9
    s_add_u32 s52, s69, 147456
    v_add_u32 v38, s52, v8
    v_xor_b32 v39, 64, v38
    v_xor_b32 v56, 180224, v38
    v_xor_b32 v57, 64, v56
    v_bfe_u32 v8, v0, 3, 2
    v_lshlrev_b32 v8, 5, v8
    v_and_b32 v9, 3, v0
    v_lshl_add_u32 v8, v9, 3, v8
    v_bfe_u32 v9, v0, 2, 2
    v_lshl_add_u32 v10, v7, 3, v9
    v_mul_u32_u24 v10, 384, v10
    v_add_u32 v240, v10, v8
    v_lshrrev_b32 v10, 2, v0
    v_mul_u32_u24 v10, 384, v10
    v_add_u32 v10, v10, v8
    v_add_u32 v40, 24576, v10
    v_add_u32 v44, 49152, v240
    v_add_u32 v248, 98304, v240
    v_xor_b32 v41, 32, v40
    v_xor_b32 v45, 32, v44
    v_xor_b32 v249, 32, v248
    v_xor_b32 v42, 64, v40
    v_xor_b32 v46, 64, v44
    v_xor_b32 v250, 64, v248
    v_xor_b32 v43, 96, v40
    v_xor_b32 v47, 96, v44
    v_xor_b32 v251, 96, v248
    s_mov_b32 s72, 0x3dd53b95
    s_mov_b32 s73, 0x3dd53b95
    s_mov_b32 s74, 0xff800000
    s_mov_b32 s75, 0xff800000
    s_mov_b32 s61, 0
    s_mov_b32 s76, 0
    s_mov_b32 s96, 0x400000
    s_mov_b32 s56, 0
    s_mov_b32 s57, 24576
    v_mov_b64 v[2:3], 0
    v_mov_b32 v246, 0
    v_mov_b64 v[48:49], 0
    v_mov_b64 v[50:51], 0
    v_mov_b64 v[52:53], 0
    v_mov_b64 v[54:55], 0
    s_add_u32 s67, s55, 128
    s_add_u32 m0, 147456, s69
    s_nop 0
    buffer_load_dwordx4 v30, s[20:23], s67 offen offset:0 lds
    buffer_load_dwordx4 v31, s[20:23], s67 offen offset:1024 lds
    buffer_load_dwordx4 v32, s[20:23], s67 offen offset:2048 lds
    buffer_load_dwordx4 v33, s[20:23], s67 offen offset:3072 lds
    buffer_load_dword v243, v241, s[92:95], s101 offen
    s_add_u32 s101, s101, s59
    s_waitcnt vmcnt(11)
    s_barrier
    ds_read_b128 a[80:83], v56 offset:0
    ds_read_b128 a[84:87], v56 offset:2048
    ds_read_b128 a[88:91], v57 offset:0
    ds_read_b128 a[92:95], v57 offset:2048
    ds_read_b64_tr_b16 a[192:193], v44 offset:0
    ds_read_b64_tr_b16 a[194:195], v44 offset:1536
    ds_read_b64_tr_b16 a[196:197], v45 offset:0
    ds_read_b64_tr_b16 a[198:199], v45 offset:1536
    ds_read_b64_tr_b16 a[200:201], v46 offset:0
    ds_read_b64_tr_b16 a[202:203], v46 offset:1536
    ds_read_b64_tr_b16 a[204:205], v47 offset:0
    ds_read_b64_tr_b16 a[206:207], v47 offset:1536
    ds_read_b64_tr_b16 a[208:209], v44 offset:128
    ds_read_b64_tr_b16 a[210:211], v44 offset:1664
    s_waitcnt lgkmcnt(4)
    v_mfma_f32_16x16x32_bf16 a[96:99], a[192:195], a[80:83], 0
    ds_read_b64_tr_b16 a[212:213], v45 offset:128
    ds_read_b64_tr_b16 a[214:215], v45 offset:1664
    ds_read_b64_tr_b16 a[216:217], v46 offset:128
    v_mfma_f32_16x16x32_bf16 a[100:103], a[192:195], a[84:87], 0
    ds_read_b64_tr_b16 a[218:219], v46 offset:1664
    ds_read_b64_tr_b16 a[220:221], v47 offset:128
    ds_read_b64_tr_b16 a[222:223], v47 offset:1664
    v_mfma_f32_16x16x32_bf16 a[108:111], a[196:199], a[84:87], 0
    ds_read_b64_tr_b16 a[192:193], v44 offset:256
    s_add_u32 m0, 73728, s49
    s_add_u32 s67, s54, 792576
    buffer_load_dwordx4 v24, s[16:19], s67 offen offset:0 lds
    v_mfma_f32_16x16x32_bf16 a[104:107], a[196:199], a[80:83], 0
    ds_read_b64_tr_b16 a[194:195], v44 offset:1792
    v_mfma_f32_16x16x32_bf16 a[112:115], a[200:203], a[80:83], 0
    ds_read_b64_tr_b16 a[196:197], v45 offset:256
    s_lshl_b32 s52, s64, 2
    v_mfma_f32_16x16x32_bf16 a[116:119], a[200:203], a[84:87], 0
    ds_read_b64_tr_b16 a[198:199], v45 offset:1792
    s_add_u32 s52, s52, s82
    s_lshl_b32 s52, s52, 2
    s_waitcnt lgkmcnt(8)
    v_mfma_f32_16x16x32_bf16 a[124:127], a[204:207], a[84:87], 0
    ds_read_b64_tr_b16 a[200:201], v46 offset:256
    s_add_u32 s52, s52, s48
    v_mfma_f32_16x16x32_bf16 a[120:123], a[204:207], a[80:83], 0
    ds_read_b64_tr_b16 a[202:203], v46 offset:1792
    buffer_load_dwordx4 v25, s[16:19], s67 offen offset:1024 lds
    v_mfma_f32_16x16x32_bf16 a[128:131], a[208:211], a[80:83], 0
    ds_read_b64_tr_b16 a[204:205], v47 offset:256
    s_lshl_b32 s52, s52, 7
    s_add_u32 s98, s52, 46137344
    v_mfma_f32_16x16x32_bf16 a[132:135], a[208:211], a[84:87], 0
    ds_read_b64_tr_b16 a[206:207], v47 offset:1792
    s_lshl_b32 s52, s81, 2
    s_add_u32 s97, s98, s52
    v_mfma_f32_16x16x32_bf16 a[140:143], a[212:215], a[84:87], 0
    ds_read_b64_tr_b16 a[208:209], v44 offset:12288
    s_lshl_b32 s52, s64, 2
    s_add_u32 s52, s52, s81
    v_mfma_f32_16x16x32_bf16 a[136:139], a[212:215], a[80:83], 0
    ds_read_b64_tr_b16 a[210:211], v44 offset:13824
    s_lshl_b32 s52, s52, 2
    s_add_u32 s52, s52, s48
    s_waitcnt lgkmcnt(8)
    v_mfma_f32_16x16x32_bf16 a[144:147], a[216:219], a[80:83], 0
    ds_read_b64_tr_b16 a[212:213], v45 offset:12288
    buffer_load_dwordx4 v26, s[16:19], s67 offen offset:2048 lds
    v_mfma_f32_16x16x32_bf16 a[148:151], a[216:219], a[84:87], 0
    ds_read_b64_tr_b16 a[214:215], v45 offset:13824
    s_lshl_b32 s52, s52, 7
    v_mfma_f32_16x16x32_bf16 a[156:159], a[220:223], a[84:87], 0
    ds_read_b64_tr_b16 a[216:217], v46 offset:12288
    s_add_u32 s100, s52, 46202880
    s_lshl_b32 s52, s82, 2
    v_mfma_f32_16x16x32_bf16 a[152:155], a[220:223], a[80:83], 0
    ds_read_b64_tr_b16 a[218:219], v46 offset:13824
    s_add_u32 s99, s100, s52
    s_add_u32 s52, s97, 32768
    v_mov_b32 v8, 0
    s_mov_b64 exec, 1
    buffer_store_dword v8, off, s[24:27], s97 sc1
    buffer_store_dword v8, off, s[24:27], s52 sc1
    buffer_store_dword v8, off, s[24:27], s99 sc1
    s_mov_b64 exec, -1
    v_mfma_f32_16x16x32_bf16 a[160:163], a[192:195], a[80:83], 0
    ds_read_b64_tr_b16 a[220:221], v47 offset:12288
    s_lshl_b32 s52, s64, 2
    v_mfma_f32_16x16x32_bf16 a[164:167], a[192:195], a[84:87], 0
    ds_read_b64_tr_b16 a[222:223], v47 offset:13824
    buffer_load_dwordx4 v27, s[16:19], s67 offen offset:3072 lds
    s_add_u32 m0, m0, 4096
    s_waitcnt lgkmcnt(8)
    v_mfma_f32_16x16x32_bf16 a[172:175], a[196:199], a[84:87], 0
    ds_read_b64_tr_b16 a[192:193], v44 offset:12416
    v_mfma_f32_16x16x32_bf16 a[168:171], a[196:199], a[80:83], 0
    ds_read_b64_tr_b16 a[194:195], v44 offset:13952
    s_add_u32 s52, s52, s81
    s_lshl_b32 s52, s52, 18
    v_mfma_f32_16x16x32_bf16 a[176:179], a[200:203], a[80:83], 0
    ds_read_b64_tr_b16 a[196:197], v45 offset:12416
    s_add_u32 s52, s52, s69
    s_add_u32 s52, s52, 25165824
    v_mfma_f32_16x16x32_bf16 a[180:183], a[200:203], a[84:87], 0
    ds_read_b64_tr_b16 a[198:199], v45 offset:13952
    s_xor_b32 s53, s82, 1
    s_lshl_b32 s38, s53, 2
    v_mfma_f32_16x16x32_bf16 a[188:191], a[204:207], a[84:87], 0
    ds_read_b64_tr_b16 a[200:201], v46 offset:12416
    buffer_load_dwordx4 v28, s[16:19], s67 offen offset:0 lds
    v_mfma_f32_16x16x32_bf16 a[184:187], a[204:207], a[80:83], 0
    ds_read_b64_tr_b16 a[202:203], v46 offset:13952
    s_add_u32 s38, s38, s82
    s_lshl_b32 s38, s38, 14
    s_waitcnt lgkmcnt(8)
    v_mfma_f32_16x16x32_bf16 a[96:99], a[208:211], a[88:91], a[96:99]
    ds_read_b64_tr_b16 a[204:205], v47 offset:12416
    s_add_u32 s38, s38, s52
    v_mfma_f32_16x16x32_bf16 a[100:103], a[208:211], a[92:95], a[100:103]
    ds_read_b64_tr_b16 a[206:207], v47 offset:13952
    s_lshl_b32 s42, s82, 2
    s_add_u32 s42, s42, s53
    v_mfma_f32_16x16x32_bf16 a[108:111], a[212:215], a[92:95], a[108:111]
    ds_read_b64_tr_b16 a[208:209], v44 offset:12544
    s_lshl_b32 s42, s42, 14
    s_add_u32 s42, s42, s52
    v_mfma_f32_16x16x32_bf16 a[104:107], a[212:215], a[88:91], a[104:107]
    ds_read_b64_tr_b16 a[210:211], v44 offset:14080
    buffer_load_dwordx4 v29, s[16:19], s67 offen offset:1024 lds
    v_mfma_f32_16x16x32_bf16 a[112:115], a[216:219], a[88:91], a[112:115]
    ds_read_b64_tr_b16 a[212:213], v45 offset:12544
    s_add_u32 s67, s55, 256
    s_add_u32 m0, 32768, s69
    v_mfma_f32_16x16x32_bf16 a[116:119], a[216:219], a[92:95], a[116:119]
    ds_read_b64_tr_b16 a[214:215], v45 offset:14080
    s_xor_b32 s53, s82, 2
    s_lshl_b32 s39, s53, 2
    s_waitcnt lgkmcnt(8)
    v_mfma_f32_16x16x32_bf16 a[124:127], a[220:223], a[92:95], a[124:127]
    ds_read_b64_tr_b16 a[216:217], v46 offset:12544
    s_add_u32 s39, s39, s82
    v_mfma_f32_16x16x32_bf16 a[120:123], a[220:223], a[88:91], a[120:123]
    ds_read_b64_tr_b16 a[218:219], v46 offset:14080
    s_lshl_b32 s39, s39, 14
    s_add_u32 s39, s39, s52
    v_mfma_f32_16x16x32_bf16 a[128:131], a[192:195], a[88:91], a[128:131]
    ds_read_b64_tr_b16 a[220:221], v47 offset:12544
    buffer_load_dwordx4 v30, s[20:23], s67 offen offset:0 lds
    v_mfma_f32_16x16x32_bf16 a[132:135], a[192:195], a[92:95], a[132:135]
    ds_read_b64_tr_b16 a[222:223], v47 offset:14080
    s_lshl_b32 s43, s82, 2
    s_add_u32 s43, s43, s53
    v_mfma_f32_16x16x32_bf16 a[140:143], a[196:199], a[92:95], a[140:143]
    s_waitcnt vmcnt(12)
    s_barrier
    ds_read_b64_tr_b16 a[192:193], v248 offset:24576
    v_mfma_f32_16x16x32_bf16 a[136:139], a[196:199], a[88:91], a[136:139]
    ds_read_b64_tr_b16 a[194:195], v248 offset:26112
    s_lshl_b32 s43, s43, 14
    s_add_u32 s43, s43, s52
    s_waitcnt lgkmcnt(8)
    v_mfma_f32_16x16x32_bf16 a[144:147], a[200:203], a[88:91], a[144:147]
    ds_read_b64_tr_b16 a[196:197], v249 offset:24576
    s_xor_b32 s53, s82, 3
    v_mfma_f32_16x16x32_bf16 a[148:151], a[200:203], a[92:95], a[148:151]
    ds_read_b64_tr_b16 a[198:199], v249 offset:26112
    buffer_load_dwordx4 v31, s[20:23], s67 offen offset:1024 lds
    v_mfma_f32_16x16x32_bf16 a[156:159], a[204:207], a[92:95], a[156:159]
    ds_read_b64_tr_b16 a[200:201], v250 offset:24576
    s_lshl_b32 s40, s53, 2
    s_add_u32 s40, s40, s82
    v_mfma_f32_16x16x32_bf16 a[152:155], a[204:207], a[88:91], a[152:155]
    ds_read_b64_tr_b16 a[202:203], v250 offset:26112
    s_lshl_b32 s40, s40, 14
    s_add_u32 s40, s40, s52
    v_mfma_f32_16x16x32_bf16 a[160:163], a[208:211], a[88:91], a[160:163]
    ds_read_b64_tr_b16 a[204:205], v251 offset:24576
    s_lshl_b32 s44, s82, 2
    s_add_u32 s44, s44, s53
    v_mfma_f32_16x16x32_bf16 a[164:167], a[208:211], a[92:95], a[164:167]
    ds_read_b64_tr_b16 a[206:207], v251 offset:26112
    s_lshl_b32 s44, s44, 14
    s_add_u32 s44, s44, s52
    s_waitcnt lgkmcnt(8)
    v_mfma_f32_16x16x32_bf16 a[172:175], a[212:215], a[92:95], a[172:175]
    ds_read_b64_tr_b16 a[208:209], v248 offset:24704
    buffer_load_dwordx4 v32, s[20:23], s67 offen offset:2048 lds
    v_mfma_f32_16x16x32_bf16 a[168:171], a[212:215], a[88:91], a[168:171]
    ds_read_b64_tr_b16 a[210:211], v248 offset:26240
    s_mul_i32 s66, s64, 1572864
    v_mfma_f32_16x16x32_bf16 a[176:179], a[216:219], a[88:91], a[176:179]
    ds_read_b64_tr_b16 a[212:213], v249 offset:24704
    s_mul_i32 s52, s48, 12288
    s_add_u32 s66, s66, s52
    v_mfma_f32_16x16x32_bf16 a[180:183], a[216:219], a[92:95], a[180:183]
    ds_read_b64_tr_b16 a[214:215], v249 offset:26240
    s_mov_b32 s62, 3
    s_mov_b32 s32, 0xaeaeaa80
    v_mfma_f32_16x16x32_bf16 a[188:191], a[220:223], a[92:95], a[188:191]
    ds_read_b64_tr_b16 a[216:217], v250 offset:24704
    s_mov_b32 s33, 0x00000002
    s_mov_b32 s34, 0xc0000000
    v_mfma_f32_16x16x32_bf16 a[184:187], a[220:223], a[88:91], a[184:187]
    ds_read_b64_tr_b16 a[218:219], v250 offset:26240
    buffer_load_dwordx4 v33, s[20:23], s67 offen offset:3072 lds
    s_waitcnt lgkmcnt(8)
    v_mfma_f32_16x16x32_bf16 v[112:115], a[192:195], a[80:83], 0
    ds_read_b64_tr_b16 a[220:221], v251 offset:24704
    s_add_u32 m0, 98304, s49
    s_add_u32 s67, s54, 786432
    v_mfma_f32_16x16x32_bf16 v[116:119], a[192:195], a[84:87], 0
    ds_read_b64_tr_b16 a[222:223], v251 offset:26240
    s_mov_b32 s35, 0x00000003
    v_mfma_f32_16x16x32_bf16 v[124:127], a[196:199], a[84:87], 0
    ds_read_b64_tr_b16 a[192:193], v248 offset:24832
    v_mfma_f32_16x16x32_bf16 v[120:123], a[196:199], a[80:83], 0
    ds_read_b64_tr_b16 a[194:195], v248 offset:26368
    v_mfma_f32_16x16x32_bf16 v[128:131], a[200:203], a[80:83], 0
    ds_read_b64_tr_b16 a[196:197], v249 offset:24832
    buffer_load_dwordx4 v24, s[16:19], s67 offen offset:0 lds
    v_mfma_f32_16x16x32_bf16 v[132:135], a[200:203], a[84:87], 0
    ds_read_b64_tr_b16 a[198:199], v249 offset:26368
    s_waitcnt lgkmcnt(8)
    v_mfma_f32_16x16x32_bf16 v[140:143], a[204:207], a[84:87], 0
    ds_read_b64_tr_b16 a[200:201], v250 offset:24832
    v_mfma_f32_16x16x32_bf16 v[136:139], a[204:207], a[80:83], 0
    ds_read_b64_tr_b16 a[202:203], v250 offset:26368
    v_mfma_f32_16x16x32_bf16 v[144:147], a[208:211], a[80:83], 0
    ds_read_b64_tr_b16 a[204:205], v251 offset:24832
    v_mfma_f32_16x16x32_bf16 v[148:151], a[208:211], a[84:87], 0
    ds_read_b64_tr_b16 a[206:207], v251 offset:26368
    buffer_load_dwordx4 v25, s[16:19], s67 offen offset:1024 lds
    v_mfma_f32_16x16x32_bf16 v[156:159], a[212:215], a[84:87], 0
    ds_read_b64_tr_b16 a[208:209], v248 offset:36864
    v_mfma_f32_16x16x32_bf16 v[152:155], a[212:215], a[80:83], 0
    ds_read_b64_tr_b16 a[210:211], v248 offset:38400
    s_waitcnt lgkmcnt(8)
    v_mfma_f32_16x16x32_bf16 v[160:163], a[216:219], a[80:83], 0
    ds_read_b64_tr_b16 a[212:213], v249 offset:36864
    v_mfma_f32_16x16x32_bf16 v[164:167], a[216:219], a[84:87], 0
    ds_read_b64_tr_b16 a[214:215], v249 offset:38400
    v_mfma_f32_16x16x32_bf16 v[172:175], a[220:223], a[84:87], 0
    ds_read_b64_tr_b16 a[216:217], v250 offset:36864
    buffer_load_dwordx4 v26, s[16:19], s67 offen offset:2048 lds
    v_mfma_f32_16x16x32_bf16 v[168:171], a[220:223], a[80:83], 0
    ds_read_b64_tr_b16 a[218:219], v250 offset:38400
    v_mfma_f32_16x16x32_bf16 v[176:179], a[192:195], a[80:83], 0
    ds_read_b64_tr_b16 a[220:221], v251 offset:36864
    v_mfma_f32_16x16x32_bf16 v[180:183], a[192:195], a[84:87], 0
    ds_read_b64_tr_b16 a[222:223], v251 offset:38400
    s_waitcnt lgkmcnt(8)
    v_mfma_f32_16x16x32_bf16 v[188:191], a[196:199], a[84:87], 0
    ds_read_b64_tr_b16 a[192:193], v248 offset:36992
    v_mfma_f32_16x16x32_bf16 v[184:187], a[196:199], a[80:83], 0
    ds_read_b64_tr_b16 a[194:195], v248 offset:38528
    buffer_load_dwordx4 v27, s[16:19], s67 offen offset:3072 lds
    s_add_u32 m0, m0, 4096
    v_mfma_f32_16x16x32_bf16 v[192:195], a[200:203], a[80:83], 0
    ds_read_b64_tr_b16 a[196:197], v249 offset:36992
    v_mfma_f32_16x16x32_bf16 v[196:199], a[200:203], a[84:87], 0
    ds_read_b64_tr_b16 a[198:199], v249 offset:38528
    v_mfma_f32_16x16x32_bf16 v[204:207], a[204:207], a[84:87], 0
    ds_read_b64_tr_b16 a[200:201], v250 offset:36992
    v_mfma_f32_16x16x32_bf16 v[200:203], a[204:207], a[80:83], 0
    ds_read_b64_tr_b16 a[202:203], v250 offset:38528
    s_waitcnt lgkmcnt(8)
    v_mfma_f32_16x16x32_bf16 v[112:115], a[208:211], a[88:91], v[112:115]
    ds_read_b64_tr_b16 a[204:205], v251 offset:36992
    buffer_load_dwordx4 v28, s[16:19], s67 offen offset:0 lds
    v_mfma_f32_16x16x32_bf16 v[116:119], a[208:211], a[92:95], v[116:119]
    ds_read_b64_tr_b16 a[206:207], v251 offset:38528
    v_mfma_f32_16x16x32_bf16 v[124:127], a[212:215], a[92:95], v[124:127]
    ds_read_b64_tr_b16 a[208:209], v248 offset:37120
    v_mfma_f32_16x16x32_bf16 v[120:123], a[212:215], a[88:91], v[120:123]
    ds_read_b64_tr_b16 a[210:211], v248 offset:38656
    v_mfma_f32_16x16x32_bf16 v[128:131], a[216:219], a[88:91], v[128:131]
    ds_read_b64_tr_b16 a[212:213], v249 offset:37120
    v_mfma_f32_16x16x32_bf16 v[132:135], a[216:219], a[92:95], v[132:135]
    ds_read_b64_tr_b16 a[214:215], v249 offset:38656
    buffer_load_dwordx4 v29, s[16:19], s67 offen offset:1024 lds
    s_waitcnt lgkmcnt(8)
    v_mfma_f32_16x16x32_bf16 v[140:143], a[220:223], a[92:95], v[140:143]
    ds_read_b64_tr_b16 a[216:217], v250 offset:37120
    buffer_load_dword v243, v241, s[92:95], s101 offen
    v_mfma_f32_16x16x32_bf16 v[136:139], a[220:223], a[88:91], v[136:139]
    ds_read_b64_tr_b16 a[218:219], v250 offset:38656
    s_add_u32 s101, s101, s59
    v_mfma_f32_16x16x32_bf16 v[144:147], a[192:195], a[88:91], v[144:147]
    ds_read_b64_tr_b16 a[220:221], v251 offset:37120
    v_mfma_f32_16x16x32_bf16 v[148:151], a[192:195], a[92:95], v[148:151]
    ds_read_b64_tr_b16 a[222:223], v251 offset:38656
    v_mfma_f32_16x16x32_bf16 v[156:159], a[196:199], a[92:95], v[156:159]
    s_waitcnt vmcnt(11)
    s_barrier
    ds_read_b64_tr_b16 a[192:193], v44 offset:24576
    v_mfma_f32_16x16x32_bf16 v[152:155], a[196:199], a[88:91], v[152:155]
    ds_read_b64_tr_b16 a[194:195], v44 offset:26112
    ds_read_b128 a[64:67], v38 offset:0
    s_waitcnt lgkmcnt(9)
    v_mfma_f32_16x16x32_bf16 v[160:163], a[200:203], a[88:91], v[160:163]
    ds_read_b64_tr_b16 a[196:197], v45 offset:24576
    ds_read_b128 a[68:71], v38 offset:2048
    ds_read_b128 a[72:75], v39 offset:0
    ds_read_b128 a[76:79], v39 offset:2048
    v_mfma_f32_16x16x32_bf16 v[164:167], a[200:203], a[92:95], v[164:167]
    ds_read_b64_tr_b16 a[198:199], v45 offset:26112
    s_add_u32 m0, 49152, s49
    s_add_u32 s67, s54, 1579008
    buffer_load_dwordx4 v24, s[16:19], s67 offen offset:0 lds
    v_mfma_f32_16x16x32_bf16 v[172:175], a[204:207], a[92:95], v[172:175]
    v_mfma_f32_16x16x32_bf16 v[168:171], a[204:207], a[88:91], v[168:171]
    v_mfma_f32_16x16x32_bf16 v[176:179], a[208:211], a[88:91], v[176:179]
    v_mfma_f32_16x16x32_bf16 v[180:183], a[208:211], a[92:95], v[180:183]
    s_waitcnt lgkmcnt(8)
    v_mfma_f32_16x16x32_bf16 v[188:191], a[212:215], a[92:95], v[188:191]
    ds_read_b64_tr_b16 a[200:201], v46 offset:24576
    ds_read_b64_tr_b16 a[202:203], v46 offset:26112
    ds_read_b64_tr_b16 a[204:205], v47 offset:24576
    buffer_load_dwordx4 v25, s[16:19], s67 offen offset:1024 lds
    v_mfma_f32_16x16x32_bf16 v[184:187], a[212:215], a[88:91], v[184:187]
    ds_read_b64_tr_b16 a[206:207], v47 offset:26112
    ds_read_b64_tr_b16 a[208:209], v44 offset:24704
    ds_read_b64_tr_b16 a[210:211], v44 offset:26240
    v_mfma_f32_16x16x32_bf16 v[192:195], a[216:219], a[88:91], v[192:195]
    v_mfma_f32_16x16x32_bf16 v[196:199], a[216:219], a[92:95], v[196:199]
    v_mfma_f32_16x16x32_bf16 v[204:207], a[220:223], a[92:95], v[204:207]
    v_mfma_f32_16x16x32_bf16 v[200:203], a[220:223], a[88:91], v[200:203]
    s_waitcnt lgkmcnt(7)
    buffer_load_dwordx4 v26, s[16:19], s67 offen offset:2048 lds
    v_mfma_f32_16x16x32_bf16 a[96:99], a[192:195], a[64:67], a[96:99]
    ds_read_b64_tr_b16 a[212:213], v45 offset:24704
    ds_read_b64_tr_b16 a[214:215], v45 offset:26240
    ds_read_b64_tr_b16 a[216:217], v46 offset:24704
    v_mfma_f32_16x16x32_bf16 a[100:103], a[192:195], a[68:71], a[100:103]
    ds_read_b64_tr_b16 a[218:219], v46 offset:26240
    ds_read_b64_tr_b16 a[220:221], v47 offset:24704
    ds_read_b64_tr_b16 a[222:223], v47 offset:26240
    s_waitcnt lgkmcnt(10)
    v_mfma_f32_16x16x32_bf16 a[108:111], a[196:199], a[68:71], a[108:111]
    ds_read_b64_tr_b16 a[192:193], v44 offset:24832
    v_mfma_f32_16x16x32_bf16 a[104:107], a[196:199], a[64:67], a[104:107]
    ds_read_b64_tr_b16 a[194:195], v44 offset:26368
    v_mfma_f32_16x16x32_bf16 a[112:115], a[200:203], a[64:67], a[112:115]
    ds_read_b64_tr_b16 a[196:197], v45 offset:24832
    buffer_load_dwordx4 v27, s[16:19], s67 offen offset:3072 lds
    s_add_u32 m0, m0, 4096
    v_mfma_f32_16x16x32_bf16 a[116:119], a[200:203], a[68:71], a[116:119]
    ds_read_b64_tr_b16 a[198:199], v45 offset:26368
    s_waitcnt lgkmcnt(8)
    v_mfma_f32_16x16x32_bf16 a[124:127], a[204:207], a[68:71], a[124:127]
    ds_read_b64_tr_b16 a[200:201], v46 offset:24832
    v_mfma_f32_16x16x32_bf16 a[120:123], a[204:207], a[64:67], a[120:123]
    ds_read_b64_tr_b16 a[202:203], v46 offset:26368
    v_mfma_f32_16x16x32_bf16 a[128:131], a[208:211], a[64:67], a[128:131]
    ds_read_b64_tr_b16 a[204:205], v47 offset:24832
    v_mfma_f32_16x16x32_bf16 a[132:135], a[208:211], a[68:71], a[132:135]
    ds_read_b64_tr_b16 a[206:207], v47 offset:26368
    buffer_load_dwordx4 v28, s[16:19], s67 offen offset:0 lds
    v_mfma_f32_16x16x32_bf16 a[140:143], a[212:215], a[68:71], a[140:143]
    ds_read_b64_tr_b16 a[208:209], v44 offset:36864
    v_mfma_f32_16x16x32_bf16 a[136:139], a[212:215], a[64:67], a[136:139]
    ds_read_b64_tr_b16 a[210:211], v44 offset:38400
    s_waitcnt lgkmcnt(8)
    v_mfma_f32_16x16x32_bf16 a[144:147], a[216:219], a[64:67], a[144:147]
    ds_read_b64_tr_b16 a[212:213], v45 offset:36864
    v_mfma_f32_16x16x32_bf16 a[148:151], a[216:219], a[68:71], a[148:151]
    ds_read_b64_tr_b16 a[214:215], v45 offset:38400
    v_mfma_f32_16x16x32_bf16 a[156:159], a[220:223], a[68:71], a[156:159]
    ds_read_b64_tr_b16 a[216:217], v46 offset:36864
    buffer_load_dwordx4 v29, s[16:19], s67 offen offset:1024 lds
    s_add_u32 s67, s55, 384
    s_add_u32 m0, 147456, s69
    v_mfma_f32_16x16x32_bf16 a[152:155], a[220:223], a[64:67], a[152:155]
    ds_read_b64_tr_b16 a[218:219], v46 offset:38400
    v_mfma_f32_16x16x32_bf16 a[160:163], a[192:195], a[64:67], a[160:163]
    ds_read_b64_tr_b16 a[220:221], v47 offset:36864
    v_mfma_f32_16x16x32_bf16 a[164:167], a[192:195], a[68:71], a[164:167]
    ds_read_b64_tr_b16 a[222:223], v47 offset:38400
    s_waitcnt lgkmcnt(8)
    v_mfma_f32_16x16x32_bf16 a[172:175], a[196:199], a[68:71], a[172:175]
    ds_read_b64_tr_b16 a[192:193], v44 offset:36992
    v_mfma_f32_16x16x32_bf16 a[168:171], a[196:199], a[64:67], a[168:171]
    ds_read_b64_tr_b16 a[194:195], v44 offset:38528
    buffer_load_dwordx4 v30, s[20:23], s67 offen offset:0 lds
    v_mfma_f32_16x16x32_bf16 a[176:179], a[200:203], a[64:67], a[176:179]
    ds_read_b64_tr_b16 a[196:197], v45 offset:36992
    v_mfma_f32_16x16x32_bf16 a[180:183], a[200:203], a[68:71], a[180:183]
    ds_read_b64_tr_b16 a[198:199], v45 offset:38528
    v_mfma_f32_16x16x32_bf16 a[188:191], a[204:207], a[68:71], a[188:191]
    ds_read_b64_tr_b16 a[200:201], v46 offset:36992
    v_mfma_f32_16x16x32_bf16 a[184:187], a[204:207], a[64:67], a[184:187]
    ds_read_b64_tr_b16 a[202:203], v46 offset:38528
    s_waitcnt lgkmcnt(8)
    v_mfma_f32_16x16x32_bf16 a[96:99], a[208:211], a[72:75], a[96:99]
    ds_read_b64_tr_b16 a[204:205], v47 offset:36992
    buffer_load_dwordx4 v31, s[20:23], s67 offen offset:1024 lds
    v_mfma_f32_16x16x32_bf16 a[100:103], a[208:211], a[76:79], a[100:103]
    ds_read_b64_tr_b16 a[206:207], v47 offset:38528
    v_mfma_f32_16x16x32_bf16 a[108:111], a[212:215], a[76:79], a[108:111]
    ds_read_b64_tr_b16 a[208:209], v44 offset:37120
    v_mfma_f32_16x16x32_bf16 a[104:107], a[212:215], a[72:75], a[104:107]
    ds_read_b64_tr_b16 a[210:211], v44 offset:38656
    v_mfma_f32_16x16x32_bf16 a[112:115], a[216:219], a[72:75], a[112:115]
    ds_read_b64_tr_b16 a[212:213], v45 offset:37120
    v_mfma_f32_16x16x32_bf16 a[116:119], a[216:219], a[76:79], a[116:119]
    ds_read_b64_tr_b16 a[214:215], v45 offset:38656
    buffer_load_dwordx4 v32, s[20:23], s67 offen offset:2048 lds
    s_waitcnt lgkmcnt(8)
    v_mfma_f32_16x16x32_bf16 a[124:127], a[220:223], a[76:79], a[124:127]
    ds_read_b64_tr_b16 a[216:217], v46 offset:37120
    v_mfma_f32_16x16x32_bf16 a[120:123], a[220:223], a[72:75], a[120:123]
    ds_read_b64_tr_b16 a[218:219], v46 offset:38656
    v_mfma_f32_16x16x32_bf16 a[128:131], a[192:195], a[72:75], a[128:131]
    ds_read_b64_tr_b16 a[220:221], v47 offset:37120
    v_mfma_f32_16x16x32_bf16 a[132:135], a[192:195], a[76:79], a[132:135]
    ds_read_b64_tr_b16 a[222:223], v47 offset:38656
    v_mfma_f32_16x16x32_bf16 a[140:143], a[196:199], a[76:79], a[140:143]
    s_waitcnt vmcnt(10)
    s_barrier
    ds_read_b64_tr_b16 a[192:193], v248 offset:0
    buffer_load_dwordx4 v33, s[20:23], s67 offen offset:3072 lds
    v_mfma_f32_16x16x32_bf16 a[136:139], a[196:199], a[72:75], a[136:139]
    ds_read_b64_tr_b16 a[194:195], v248 offset:1536
    s_waitcnt lgkmcnt(8)
    v_mfma_f32_16x16x32_bf16 a[144:147], a[200:203], a[72:75], a[144:147]
    ds_read_b64_tr_b16 a[196:197], v249 offset:0
    buffer_load_dword v243, v241, s[92:95], s101 offen
    v_mfma_f32_16x16x32_bf16 a[148:151], a[200:203], a[76:79], a[148:151]
    ds_read_b64_tr_b16 a[198:199], v249 offset:1536
    s_add_u32 s101, s101, s59
    s_add_u32 m0, 122880, s49
    s_add_u32 s67, s54, 1572864
    v_mfma_f32_16x16x32_bf16 a[156:159], a[204:207], a[76:79], a[156:159]
    ds_read_b64_tr_b16 a[200:201], v250 offset:0
    v_mfma_f32_16x16x32_bf16 a[152:155], a[204:207], a[72:75], a[152:155]
    ds_read_b64_tr_b16 a[202:203], v250 offset:1536
    buffer_load_dwordx4 v24, s[16:19], s67 offen offset:0 lds
    v_mfma_f32_16x16x32_bf16 a[160:163], a[208:211], a[72:75], a[160:163]
    ds_read_b64_tr_b16 a[204:205], v251 offset:0
    v_mfma_f32_16x16x32_bf16 a[164:167], a[208:211], a[76:79], a[164:167]
    ds_read_b64_tr_b16 a[206:207], v251 offset:1536
    s_waitcnt lgkmcnt(8)
    v_mfma_f32_16x16x32_bf16 a[172:175], a[212:215], a[76:79], a[172:175]
    ds_read_b64_tr_b16 a[208:209], v248 offset:128
    v_mfma_f32_16x16x32_bf16 a[168:171], a[212:215], a[72:75], a[168:171]
    ds_read_b64_tr_b16 a[210:211], v248 offset:1664
    v_mfma_f32_16x16x32_bf16 a[176:179], a[216:219], a[72:75], a[176:179]
    ds_read_b64_tr_b16 a[212:213], v249 offset:128
    buffer_load_dwordx4 v25, s[16:19], s67 offen offset:1024 lds
    v_mfma_f32_16x16x32_bf16 a[180:183], a[216:219], a[76:79], a[180:183]
    ds_read_b64_tr_b16 a[214:215], v249 offset:1664
    v_mfma_f32_16x16x32_bf16 a[188:191], a[220:223], a[76:79], a[188:191]
    ds_read_b64_tr_b16 a[216:217], v250 offset:128
    v_mfma_f32_16x16x32_bf16 a[184:187], a[220:223], a[72:75], a[184:187]
    ds_read_b64_tr_b16 a[218:219], v250 offset:1664
    s_waitcnt lgkmcnt(8)
    v_mfma_f32_16x16x32_bf16 v[112:115], a[192:195], a[64:67], v[112:115]
    ds_read_b64_tr_b16 a[220:221], v251 offset:128
    v_mfma_f32_16x16x32_bf16 v[116:119], a[192:195], a[68:71], v[116:119]
    ds_read_b64_tr_b16 a[222:223], v251 offset:1664
    buffer_load_dwordx4 v26, s[16:19], s67 offen offset:2048 lds
    v_mfma_f32_16x16x32_bf16 v[124:127], a[196:199], a[68:71], v[124:127]
    ds_read_b64_tr_b16 a[192:193], v248 offset:256
    v_mfma_f32_16x16x32_bf16 v[120:123], a[196:199], a[64:67], v[120:123]
    ds_read_b64_tr_b16 a[194:195], v248 offset:1792
    v_mfma_f32_16x16x32_bf16 v[128:131], a[200:203], a[64:67], v[128:131]
    ds_read_b64_tr_b16 a[196:197], v249 offset:256
    v_mfma_f32_16x16x32_bf16 v[132:135], a[200:203], a[68:71], v[132:135]
    ds_read_b64_tr_b16 a[198:199], v249 offset:1792
    s_waitcnt lgkmcnt(8)
    v_mfma_f32_16x16x32_bf16 v[140:143], a[204:207], a[68:71], v[140:143]
    ds_read_b64_tr_b16 a[200:201], v250 offset:256
    buffer_load_dwordx4 v27, s[16:19], s67 offen offset:3072 lds
    s_add_u32 m0, m0, 4096
    v_mfma_f32_16x16x32_bf16 v[136:139], a[204:207], a[64:67], v[136:139]
    ds_read_b64_tr_b16 a[202:203], v250 offset:1792
    v_mfma_f32_16x16x32_bf16 v[144:147], a[208:211], a[64:67], v[144:147]
    ds_read_b64_tr_b16 a[204:205], v251 offset:256
    v_mfma_f32_16x16x32_bf16 v[148:151], a[208:211], a[68:71], v[148:151]
    ds_read_b64_tr_b16 a[206:207], v251 offset:1792
    v_mfma_f32_16x16x32_bf16 v[156:159], a[212:215], a[68:71], v[156:159]
    ds_read_b64_tr_b16 a[208:209], v248 offset:12288
    v_mfma_f32_16x16x32_bf16 v[152:155], a[212:215], a[64:67], v[152:155]
    ds_read_b64_tr_b16 a[210:211], v248 offset:13824
    buffer_load_dwordx4 v28, s[16:19], s67 offen offset:0 lds
    s_waitcnt lgkmcnt(8)
    v_mfma_f32_16x16x32_bf16 v[160:163], a[216:219], a[64:67], v[160:163]
    ds_read_b64_tr_b16 a[212:213], v249 offset:12288
    v_mfma_f32_16x16x32_bf16 v[164:167], a[216:219], a[68:71], v[164:167]
    ds_read_b64_tr_b16 a[214:215], v249 offset:13824
    v_mfma_f32_16x16x32_bf16 v[172:175], a[220:223], a[68:71], v[172:175]
    ds_read_b64_tr_b16 a[216:217], v250 offset:12288
    v_mfma_f32_16x16x32_bf16 v[168:171], a[220:223], a[64:67], v[168:171]
    ds_read_b64_tr_b16 a[218:219], v250 offset:13824
    v_mfma_f32_16x16x32_bf16 v[176:179], a[192:195], a[64:67], v[176:179]
    ds_read_b64_tr_b16 a[220:221], v251 offset:12288
    buffer_load_dwordx4 v29, s[16:19], s67 offen offset:1024 lds
    v_mfma_f32_16x16x32_bf16 v[180:183], a[192:195], a[68:71], v[180:183]
    ds_read_b64_tr_b16 a[222:223], v251 offset:13824
    s_waitcnt lgkmcnt(8)
    v_mfma_f32_16x16x32_bf16 v[188:191], a[196:199], a[68:71], v[188:191]
    ds_read_b64_tr_b16 a[192:193], v248 offset:12416
    v_mfma_f32_16x16x32_bf16 v[184:187], a[196:199], a[64:67], v[184:187]
    ds_read_b64_tr_b16 a[194:195], v248 offset:13952
    v_mfma_f32_16x16x32_bf16 v[192:195], a[200:203], a[64:67], v[192:195]
    ds_read_b64_tr_b16 a[196:197], v249 offset:12416
    v_mfma_f32_16x16x32_bf16 v[196:199], a[200:203], a[68:71], v[196:199]
    ds_read_b64_tr_b16 a[198:199], v249 offset:13952
    v_mfma_f32_16x16x32_bf16 v[204:207], a[204:207], a[68:71], v[204:207]
    ds_read_b64_tr_b16 a[200:201], v250 offset:12416
    v_mfma_f32_16x16x32_bf16 v[200:203], a[204:207], a[64:67], v[200:203]
    ds_read_b64_tr_b16 a[202:203], v250 offset:13952
    s_waitcnt lgkmcnt(8)
    v_mfma_f32_16x16x32_bf16 v[112:115], a[208:211], a[72:75], v[112:115]
    ds_read_b64_tr_b16 a[204:205], v251 offset:12416
    v_mfma_f32_16x16x32_bf16 v[116:119], a[208:211], a[76:79], v[116:119]
    ds_read_b64_tr_b16 a[206:207], v251 offset:13952
    v_mfma_f32_16x16x32_bf16 v[124:127], a[212:215], a[76:79], v[124:127]
    ds_read_b64_tr_b16 a[208:209], v248 offset:12544
    v_mfma_f32_16x16x32_bf16 v[120:123], a[212:215], a[72:75], v[120:123]
    ds_read_b64_tr_b16 a[210:211], v248 offset:14080
    v_mfma_f32_16x16x32_bf16 v[128:131], a[216:219], a[72:75], v[128:131]
    ds_read_b64_tr_b16 a[212:213], v249 offset:12544
    v_mfma_f32_16x16x32_bf16 v[132:135], a[216:219], a[76:79], v[132:135]
    ds_read_b64_tr_b16 a[214:215], v249 offset:14080
    s_waitcnt lgkmcnt(8)
    v_mfma_f32_16x16x32_bf16 v[140:143], a[220:223], a[76:79], v[140:143]
    ds_read_b64_tr_b16 a[216:217], v250 offset:12544
    v_mfma_f32_16x16x32_bf16 v[136:139], a[220:223], a[72:75], v[136:139]
    ds_read_b64_tr_b16 a[218:219], v250 offset:14080
    v_mfma_f32_16x16x32_bf16 v[144:147], a[192:195], a[72:75], v[144:147]
    ds_read_b64_tr_b16 a[220:221], v251 offset:12544
    v_mfma_f32_16x16x32_bf16 v[148:151], a[192:195], a[76:79], v[148:151]
    ds_read_b64_tr_b16 a[222:223], v251 offset:14080
    v_mfma_f32_16x16x32_bf16 v[156:159], a[196:199], a[76:79], v[156:159]
    s_waitcnt vmcnt(11)
    s_barrier
    ds_read_b64_tr_b16 a[192:193], v44 offset:0
    v_mfma_f32_16x16x32_bf16 v[152:155], a[196:199], a[72:75], v[152:155]
    ds_read_b64_tr_b16 a[194:195], v44 offset:1536
    ds_read_b128 a[80:83], v56 offset:0
    s_waitcnt lgkmcnt(9)
    v_mfma_f32_16x16x32_bf16 v[160:163], a[200:203], a[72:75], v[160:163]
    ds_read_b64_tr_b16 a[196:197], v45 offset:0
    ds_read_b128 a[84:87], v56 offset:2048
    ds_read_b128 a[88:91], v57 offset:0
    ds_read_b128 a[92:95], v57 offset:2048
    v_mfma_f32_16x16x32_bf16 v[164:167], a[200:203], a[76:79], v[164:167]
    ds_read_b64_tr_b16 a[198:199], v45 offset:1536
    s_add_u32 m0, 73728, s49
    s_add_u32 s67, s54, 2365440
    buffer_load_dwordx4 v24, s[16:19], s67 offen offset:0 lds
    v_mfma_f32_16x16x32_bf16 v[172:175], a[204:207], a[76:79], v[172:175]
    v_mfma_f32_16x16x32_bf16 v[168:171], a[204:207], a[72:75], v[168:171]
    v_mfma_f32_16x16x32_bf16 v[176:179], a[208:211], a[72:75], v[176:179]
    v_mfma_f32_16x16x32_bf16 v[180:183], a[208:211], a[76:79], v[180:183]
    s_waitcnt lgkmcnt(8)
    v_mfma_f32_16x16x32_bf16 v[188:191], a[212:215], a[76:79], v[188:191]
    ds_read_b64_tr_b16 a[200:201], v46 offset:0
    ds_read_b64_tr_b16 a[202:203], v46 offset:1536
    ds_read_b64_tr_b16 a[204:205], v47 offset:0
    buffer_load_dwordx4 v25, s[16:19], s67 offen offset:1024 lds
    v_mfma_f32_16x16x32_bf16 v[184:187], a[212:215], a[72:75], v[184:187]
    ds_read_b64_tr_b16 a[206:207], v47 offset:1536
    ds_read_b64_tr_b16 a[208:209], v44 offset:128
    ds_read_b64_tr_b16 a[210:211], v44 offset:1664
    v_mfma_f32_16x16x32_bf16 v[192:195], a[216:219], a[72:75], v[192:195]
    v_mfma_f32_16x16x32_bf16 v[196:199], a[216:219], a[76:79], v[196:199]
    v_mfma_f32_16x16x32_bf16 v[204:207], a[220:223], a[76:79], v[204:207]
    v_mfma_f32_16x16x32_bf16 v[200:203], a[220:223], a[72:75], v[200:203]
    s_waitcnt lgkmcnt(7)
    buffer_load_dwordx4 v26, s[16:19], s67 offen offset:2048 lds
    v_mfma_f32_16x16x32_bf16 a[96:99], a[192:195], a[80:83], a[96:99]
    ds_read_b64_tr_b16 a[212:213], v45 offset:128
    ds_read_b64_tr_b16 a[214:215], v45 offset:1664
    ds_read_b64_tr_b16 a[216:217], v46 offset:128
    v_mfma_f32_16x16x32_bf16 a[100:103], a[192:195], a[84:87], a[100:103]
    ds_read_b64_tr_b16 a[218:219], v46 offset:1664
    ds_read_b64_tr_b16 a[220:221], v47 offset:128
    ds_read_b64_tr_b16 a[222:223], v47 offset:1664
    s_waitcnt lgkmcnt(10)
    v_mfma_f32_16x16x32_bf16 a[108:111], a[196:199], a[84:87], a[108:111]
    ds_read_b64_tr_b16 a[192:193], v44 offset:256
    v_mfma_f32_16x16x32_bf16 a[104:107], a[196:199], a[80:83], a[104:107]
    ds_read_b64_tr_b16 a[194:195], v44 offset:1792
    v_mfma_f32_16x16x32_bf16 a[112:115], a[200:203], a[80:83], a[112:115]
    ds_read_b64_tr_b16 a[196:197], v45 offset:256
    buffer_load_dwordx4 v27, s[16:19], s67 offen offset:3072 lds
    s_add_u32 m0, m0, 4096
    v_mfma_f32_16x16x32_bf16 a[116:119], a[200:203], a[84:87], a[116:119]
    ds_read_b64_tr_b16 a[198:199], v45 offset:1792
    s_waitcnt lgkmcnt(8)
    v_mfma_f32_16x16x32_bf16 a[124:127], a[204:207], a[84:87], a[124:127]
    ds_read_b64_tr_b16 a[200:201], v46 offset:256
    v_mfma_f32_16x16x32_bf16 a[120:123], a[204:207], a[80:83], a[120:123]
    ds_read_b64_tr_b16 a[202:203], v46 offset:1792
    v_mfma_f32_16x16x32_bf16 a[128:131], a[208:211], a[80:83], a[128:131]
    ds_read_b64_tr_b16 a[204:205], v47 offset:256
    v_mfma_f32_16x16x32_bf16 a[132:135], a[208:211], a[84:87], a[132:135]
    ds_read_b64_tr_b16 a[206:207], v47 offset:1792
    buffer_load_dwordx4 v28, s[16:19], s67 offen offset:0 lds
    v_mfma_f32_16x16x32_bf16 a[140:143], a[212:215], a[84:87], a[140:143]
    ds_read_b64_tr_b16 a[208:209], v44 offset:12288
    v_mfma_f32_16x16x32_bf16 a[136:139], a[212:215], a[80:83], a[136:139]
    ds_read_b64_tr_b16 a[210:211], v44 offset:13824
    s_waitcnt lgkmcnt(8)
    v_mfma_f32_16x16x32_bf16 a[144:147], a[216:219], a[80:83], a[144:147]
    ds_read_b64_tr_b16 a[212:213], v45 offset:12288
    v_mfma_f32_16x16x32_bf16 a[148:151], a[216:219], a[84:87], a[148:151]
    ds_read_b64_tr_b16 a[214:215], v45 offset:13824
    v_mfma_f32_16x16x32_bf16 a[156:159], a[220:223], a[84:87], a[156:159]
    ds_read_b64_tr_b16 a[216:217], v46 offset:12288
    buffer_load_dwordx4 v29, s[16:19], s67 offen offset:1024 lds
    v_mfma_f32_16x16x32_bf16 a[152:155], a[220:223], a[80:83], a[152:155]
    ds_read_b64_tr_b16 a[218:219], v46 offset:13824
    v_mfma_f32_16x16x32_bf16 a[160:163], a[192:195], a[80:83], a[160:163]
    ds_read_b64_tr_b16 a[220:221], v47 offset:12288
    buffer_load_dword v243, v241, s[92:95], s101 offen
    s_add_u32 s101, s101, s59
    v_mfma_f32_16x16x32_bf16 a[164:167], a[192:195], a[84:87], a[164:167]
    ds_read_b64_tr_b16 a[222:223], v47 offset:13824
    s_add_u32 s67, s55, 512
    s_add_u32 m0, 32768, s69
    s_waitcnt lgkmcnt(8)
    v_mfma_f32_16x16x32_bf16 a[172:175], a[196:199], a[84:87], a[172:175]
    ds_read_b64_tr_b16 a[192:193], v44 offset:12416
    v_mfma_f32_16x16x32_bf16 a[168:171], a[196:199], a[80:83], a[168:171]
    ds_read_b64_tr_b16 a[194:195], v44 offset:13952
    buffer_load_dwordx4 v30, s[20:23], s67 offen offset:0 lds
    v_mfma_f32_16x16x32_bf16 a[176:179], a[200:203], a[80:83], a[176:179]
    ds_read_b64_tr_b16 a[196:197], v45 offset:12416
    v_mfma_f32_16x16x32_bf16 a[180:183], a[200:203], a[84:87], a[180:183]
    ds_read_b64_tr_b16 a[198:199], v45 offset:13952
    v_mfma_f32_16x16x32_bf16 a[188:191], a[204:207], a[84:87], a[188:191]
    ds_read_b64_tr_b16 a[200:201], v46 offset:12416
    v_mfma_f32_16x16x32_bf16 a[184:187], a[204:207], a[80:83], a[184:187]
    ds_read_b64_tr_b16 a[202:203], v46 offset:13952
    s_waitcnt lgkmcnt(8)
    v_mfma_f32_16x16x32_bf16 a[96:99], a[208:211], a[88:91], a[96:99]
    ds_read_b64_tr_b16 a[204:205], v47 offset:12416
    buffer_load_dwordx4 v31, s[20:23], s67 offen offset:1024 lds
    v_mfma_f32_16x16x32_bf16 a[100:103], a[208:211], a[92:95], a[100:103]
    ds_read_b64_tr_b16 a[206:207], v47 offset:13952
    v_mfma_f32_16x16x32_bf16 a[108:111], a[212:215], a[92:95], a[108:111]
    ds_read_b64_tr_b16 a[208:209], v44 offset:12544
    v_mfma_f32_16x16x32_bf16 a[104:107], a[212:215], a[88:91], a[104:107]
    ds_read_b64_tr_b16 a[210:211], v44 offset:14080
    v_mfma_f32_16x16x32_bf16 a[112:115], a[216:219], a[88:91], a[112:115]
    ds_read_b64_tr_b16 a[212:213], v45 offset:12544
    v_mfma_f32_16x16x32_bf16 a[116:119], a[216:219], a[92:95], a[116:119]
    ds_read_b64_tr_b16 a[214:215], v45 offset:14080
    buffer_load_dwordx4 v32, s[20:23], s67 offen offset:2048 lds
    s_waitcnt lgkmcnt(8)
    v_mfma_f32_16x16x32_bf16 a[124:127], a[220:223], a[92:95], a[124:127]
    ds_read_b64_tr_b16 a[216:217], v46 offset:12544
    v_mfma_f32_16x16x32_bf16 a[120:123], a[220:223], a[88:91], a[120:123]
    ds_read_b64_tr_b16 a[218:219], v46 offset:14080
    v_mfma_f32_16x16x32_bf16 a[128:131], a[192:195], a[88:91], a[128:131]
    ds_read_b64_tr_b16 a[220:221], v47 offset:12544
    v_mfma_f32_16x16x32_bf16 a[132:135], a[192:195], a[92:95], a[132:135]
    ds_read_b64_tr_b16 a[222:223], v47 offset:14080
    v_mfma_f32_16x16x32_bf16 a[140:143], a[196:199], a[92:95], a[140:143]
    s_waitcnt vmcnt(10)
    s_barrier
    ds_read_b64_tr_b16 a[192:193], v248 offset:24576
    buffer_load_dwordx4 v33, s[20:23], s67 offen offset:3072 lds
    v_mfma_f32_16x16x32_bf16 a[136:139], a[196:199], a[88:91], a[136:139]
    ds_read_b64_tr_b16 a[194:195], v248 offset:26112
    s_waitcnt lgkmcnt(8)
    v_mfma_f32_16x16x32_bf16 a[144:147], a[200:203], a[88:91], a[144:147]
    ds_read_b64_tr_b16 a[196:197], v249 offset:24576
    v_mfma_f32_16x16x32_bf16 a[148:151], a[200:203], a[92:95], a[148:151]
    ds_read_b64_tr_b16 a[198:199], v249 offset:26112
    s_add_u32 m0, 98304, s49
    s_add_u32 s67, s54, 2359296
    v_mfma_f32_16x16x32_bf16 a[156:159], a[204:207], a[92:95], a[156:159]
    ds_read_b64_tr_b16 a[200:201], v250 offset:24576
    v_mfma_f32_16x16x32_bf16 a[152:155], a[204:207], a[88:91], a[152:155]
    ds_read_b64_tr_b16 a[202:203], v250 offset:26112
    buffer_load_dwordx4 v24, s[16:19], s67 offen offset:0 lds
    v_mfma_f32_16x16x32_bf16 a[160:163], a[208:211], a[88:91], a[160:163]
    ds_read_b64_tr_b16 a[204:205], v251 offset:24576
    v_mfma_f32_16x16x32_bf16 a[164:167], a[208:211], a[92:95], a[164:167]
    ds_read_b64_tr_b16 a[206:207], v251 offset:26112
    s_waitcnt lgkmcnt(8)
    v_mfma_f32_16x16x32_bf16 a[172:175], a[212:215], a[92:95], a[172:175]
    ds_read_b64_tr_b16 a[208:209], v248 offset:24704
    v_mfma_f32_16x16x32_bf16 a[168:171], a[212:215], a[88:91], a[168:171]
    ds_read_b64_tr_b16 a[210:211], v248 offset:26240
    v_mfma_f32_16x16x32_bf16 a[176:179], a[216:219], a[88:91], a[176:179]
    ds_read_b64_tr_b16 a[212:213], v249 offset:24704
    buffer_load_dwordx4 v25, s[16:19], s67 offen offset:1024 lds
    v_mfma_f32_16x16x32_bf16 a[180:183], a[216:219], a[92:95], a[180:183]
    ds_read_b64_tr_b16 a[214:215], v249 offset:26240
    v_mfma_f32_16x16x32_bf16 a[188:191], a[220:223], a[92:95], a[188:191]
    ds_read_b64_tr_b16 a[216:217], v250 offset:24704
    v_mfma_f32_16x16x32_bf16 a[184:187], a[220:223], a[88:91], a[184:187]
    ds_read_b64_tr_b16 a[218:219], v250 offset:26240
    s_waitcnt lgkmcnt(8)
    v_mfma_f32_16x16x32_bf16 v[112:115], a[192:195], a[80:83], v[112:115]
    ds_read_b64_tr_b16 a[220:221], v251 offset:24704
    v_mfma_f32_16x16x32_bf16 v[116:119], a[192:195], a[84:87], v[116:119]
    ds_read_b64_tr_b16 a[222:223], v251 offset:26240
    buffer_load_dwordx4 v26, s[16:19], s67 offen offset:2048 lds
    v_mfma_f32_16x16x32_bf16 v[124:127], a[196:199], a[84:87], v[124:127]
    ds_read_b64_tr_b16 a[192:193], v248 offset:24832
    v_mfma_f32_16x16x32_bf16 v[120:123], a[196:199], a[80:83], v[120:123]
    ds_read_b64_tr_b16 a[194:195], v248 offset:26368
    v_mfma_f32_16x16x32_bf16 v[128:131], a[200:203], a[80:83], v[128:131]
    ds_read_b64_tr_b16 a[196:197], v249 offset:24832
    v_mfma_f32_16x16x32_bf16 v[132:135], a[200:203], a[84:87], v[132:135]
    ds_read_b64_tr_b16 a[198:199], v249 offset:26368
    s_waitcnt lgkmcnt(8)
    v_mfma_f32_16x16x32_bf16 v[140:143], a[204:207], a[84:87], v[140:143]
    ds_read_b64_tr_b16 a[200:201], v250 offset:24832
    buffer_load_dwordx4 v27, s[16:19], s67 offen offset:3072 lds
    s_add_u32 m0, m0, 4096
    v_mfma_f32_16x16x32_bf16 v[136:139], a[204:207], a[80:83], v[136:139]
    ds_read_b64_tr_b16 a[202:203], v250 offset:26368
    v_mfma_f32_16x16x32_bf16 v[144:147], a[208:211], a[80:83], v[144:147]
    ds_read_b64_tr_b16 a[204:205], v251 offset:24832
    v_mfma_f32_16x16x32_bf16 v[148:151], a[208:211], a[84:87], v[148:151]
    ds_read_b64_tr_b16 a[206:207], v251 offset:26368
    v_mfma_f32_16x16x32_bf16 v[156:159], a[212:215], a[84:87], v[156:159]
    ds_read_b64_tr_b16 a[208:209], v248 offset:36864
    v_mfma_f32_16x16x32_bf16 v[152:155], a[212:215], a[80:83], v[152:155]
    ds_read_b64_tr_b16 a[210:211], v248 offset:38400
    buffer_load_dwordx4 v28, s[16:19], s67 offen offset:0 lds
    s_waitcnt lgkmcnt(8)
    v_mfma_f32_16x16x32_bf16 v[160:163], a[216:219], a[80:83], v[160:163]
    ds_read_b64_tr_b16 a[212:213], v249 offset:36864
    v_mfma_f32_16x16x32_bf16 v[164:167], a[216:219], a[84:87], v[164:167]
    ds_read_b64_tr_b16 a[214:215], v249 offset:38400
    v_mfma_f32_16x16x32_bf16 v[172:175], a[220:223], a[84:87], v[172:175]
    ds_read_b64_tr_b16 a[216:217], v250 offset:36864
    v_mfma_f32_16x16x32_bf16 v[168:171], a[220:223], a[80:83], v[168:171]
    ds_read_b64_tr_b16 a[218:219], v250 offset:38400
    v_mfma_f32_16x16x32_bf16 v[176:179], a[192:195], a[80:83], v[176:179]
    ds_read_b64_tr_b16 a[220:221], v251 offset:36864
    buffer_load_dwordx4 v29, s[16:19], s67 offen offset:1024 lds
    v_mfma_f32_16x16x32_bf16 v[180:183], a[192:195], a[84:87], v[180:183]
    ds_read_b64_tr_b16 a[222:223], v251 offset:38400
    s_waitcnt lgkmcnt(8)
    v_mfma_f32_16x16x32_bf16 v[188:191], a[196:199], a[84:87], v[188:191]
    ds_read_b64_tr_b16 a[192:193], v248 offset:36992
    buffer_load_dword v243, v241, s[92:95], s101 offen
    s_add_u32 s101, s101, s59
    v_mfma_f32_16x16x32_bf16 v[184:187], a[196:199], a[80:83], v[184:187]
    ds_read_b64_tr_b16 a[194:195], v248 offset:38528
    v_mfma_f32_16x16x32_bf16 v[192:195], a[200:203], a[80:83], v[192:195]
    ds_read_b64_tr_b16 a[196:197], v249 offset:36992
    v_mfma_f32_16x16x32_bf16 v[196:199], a[200:203], a[84:87], v[196:199]
    ds_read_b64_tr_b16 a[198:199], v249 offset:38528
    v_mfma_f32_16x16x32_bf16 v[204:207], a[204:207], a[84:87], v[204:207]
    ds_read_b64_tr_b16 a[200:201], v250 offset:36992
    v_mfma_f32_16x16x32_bf16 v[200:203], a[204:207], a[80:83], v[200:203]
    ds_read_b64_tr_b16 a[202:203], v250 offset:38528
    s_waitcnt lgkmcnt(8)
    v_mfma_f32_16x16x32_bf16 v[112:115], a[208:211], a[88:91], v[112:115]
    ds_read_b64_tr_b16 a[204:205], v251 offset:36992
    v_mfma_f32_16x16x32_bf16 v[116:119], a[208:211], a[92:95], v[116:119]
    ds_read_b64_tr_b16 a[206:207], v251 offset:38528
    v_mfma_f32_16x16x32_bf16 v[124:127], a[212:215], a[92:95], v[124:127]
    ds_read_b64_tr_b16 a[208:209], v248 offset:37120
    v_mfma_f32_16x16x32_bf16 v[120:123], a[212:215], a[88:91], v[120:123]
    ds_read_b64_tr_b16 a[210:211], v248 offset:38656
    v_mfma_f32_16x16x32_bf16 v[128:131], a[216:219], a[88:91], v[128:131]
    ds_read_b64_tr_b16 a[212:213], v249 offset:37120
    v_mfma_f32_16x16x32_bf16 v[132:135], a[216:219], a[92:95], v[132:135]
    ds_read_b64_tr_b16 a[214:215], v249 offset:38656
    s_waitcnt lgkmcnt(8)
    v_mfma_f32_16x16x32_bf16 v[140:143], a[220:223], a[92:95], v[140:143]
    ds_read_b64_tr_b16 a[216:217], v250 offset:37120
    v_mfma_f32_16x16x32_bf16 v[136:139], a[220:223], a[88:91], v[136:139]
    ds_read_b64_tr_b16 a[218:219], v250 offset:38656
    v_mfma_f32_16x16x32_bf16 v[144:147], a[192:195], a[88:91], v[144:147]
    ds_read_b64_tr_b16 a[220:221], v251 offset:37120
    v_mfma_f32_16x16x32_bf16 v[148:151], a[192:195], a[92:95], v[148:151]
    ds_read_b64_tr_b16 a[222:223], v251 offset:38656
    v_mfma_f32_16x16x32_bf16 v[156:159], a[196:199], a[92:95], v[156:159]
    s_waitcnt vmcnt(12)
    s_barrier
    ds_read_b64_tr_b16 a[192:193], v44 offset:24576
    v_mfma_f32_16x16x32_bf16 v[152:155], a[196:199], a[88:91], v[152:155]
    ds_read_b64_tr_b16 a[194:195], v44 offset:26112
    ds_read_b128 a[64:67], v38 offset:0
    s_waitcnt lgkmcnt(9)
    v_mfma_f32_16x16x32_bf16 v[160:163], a[200:203], a[88:91], v[160:163]
    ds_read_b64_tr_b16 a[196:197], v45 offset:24576
    ds_read_b128 a[68:71], v38 offset:2048
    ds_read_b128 a[72:75], v39 offset:0
    ds_read_b128 a[76:79], v39 offset:2048
    v_mfma_f32_16x16x32_bf16 v[164:167], a[200:203], a[92:95], v[164:167]
    ds_read_b64_tr_b16 a[198:199], v45 offset:26112
    s_add_u32 m0, 49152, s49
    s_add_u32 s67, s54, 3145728
    buffer_load_dwordx4 v24, s[16:19], s67 offen offset:0 lds
    v_mfma_f32_16x16x32_bf16 v[172:175], a[204:207], a[92:95], v[172:175]
    v_mfma_f32_16x16x32_bf16 v[168:171], a[204:207], a[88:91], v[168:171]
    v_mfma_f32_16x16x32_bf16 v[176:179], a[208:211], a[88:91], v[176:179]
    v_mfma_f32_16x16x32_bf16 v[180:183], a[208:211], a[92:95], v[180:183]
    s_waitcnt lgkmcnt(8)
    v_mfma_f32_16x16x32_bf16 v[188:191], a[212:215], a[92:95], v[188:191]
    ds_read_b64_tr_b16 a[200:201], v46 offset:24576
    ds_read_b64_tr_b16 a[202:203], v46 offset:26112
    ds_read_b64_tr_b16 a[204:205], v47 offset:24576
    buffer_load_dwordx4 v25, s[16:19], s67 offen offset:1024 lds
    v_mfma_f32_16x16x32_bf16 v[184:187], a[212:215], a[88:91], v[184:187]
    ds_read_b64_tr_b16 a[206:207], v47 offset:26112
    ds_read_b64_tr_b16 a[208:209], v44 offset:24704
    ds_read_b64_tr_b16 a[210:211], v44 offset:26240
    v_mfma_f32_16x16x32_bf16 v[192:195], a[216:219], a[88:91], v[192:195]
    v_mfma_f32_16x16x32_bf16 v[196:199], a[216:219], a[92:95], v[196:199]
    v_mfma_f32_16x16x32_bf16 v[204:207], a[220:223], a[92:95], v[204:207]
    v_mfma_f32_16x16x32_bf16 v[200:203], a[220:223], a[88:91], v[200:203]
    s_waitcnt lgkmcnt(7)
    buffer_load_dwordx4 v26, s[16:19], s67 offen offset:2048 lds
    v_mfma_f32_16x16x32_bf16 a[96:99], a[192:195], a[64:67], a[96:99]
    ds_read_b64_tr_b16 a[212:213], v45 offset:24704
    ds_read_b64_tr_b16 a[214:215], v45 offset:26240
    ds_read_b64_tr_b16 a[216:217], v46 offset:24704
    v_mfma_f32_16x16x32_bf16 a[100:103], a[192:195], a[68:71], a[100:103]
    ds_read_b64_tr_b16 a[218:219], v46 offset:26240
    ds_read_b64_tr_b16 a[220:221], v47 offset:24704
    ds_read_b64_tr_b16 a[222:223], v47 offset:26240
    s_waitcnt lgkmcnt(10)
    v_mfma_f32_16x16x32_bf16 a[108:111], a[196:199], a[68:71], a[108:111]
    ds_read_b64_tr_b16 a[192:193], v44 offset:24832
    v_mfma_f32_16x16x32_bf16 a[104:107], a[196:199], a[64:67], a[104:107]
    ds_read_b64_tr_b16 a[194:195], v44 offset:26368
    v_mfma_f32_16x16x32_bf16 a[112:115], a[200:203], a[64:67], a[112:115]
    ds_read_b64_tr_b16 a[196:197], v45 offset:24832
    buffer_load_dwordx4 v27, s[16:19], s67 offen offset:3072 lds
    s_add_u32 m0, m0, 4096
    v_mfma_f32_16x16x32_bf16 a[116:119], a[200:203], a[68:71], a[116:119]
    ds_read_b64_tr_b16 a[198:199], v45 offset:26368
    s_waitcnt lgkmcnt(8)
    v_mfma_f32_16x16x32_bf16 a[124:127], a[204:207], a[68:71], a[124:127]
    ds_read_b64_tr_b16 a[200:201], v46 offset:24832
    v_mfma_f32_16x16x32_bf16 a[120:123], a[204:207], a[64:67], a[120:123]
    ds_read_b64_tr_b16 a[202:203], v46 offset:26368
    v_mfma_f32_16x16x32_bf16 a[128:131], a[208:211], a[64:67], a[128:131]
    ds_read_b64_tr_b16 a[204:205], v47 offset:24832
    v_mfma_f32_16x16x32_bf16 a[132:135], a[208:211], a[68:71], a[132:135]
    ds_read_b64_tr_b16 a[206:207], v47 offset:26368
    buffer_load_dwordx4 v28, s[16:19], s67 offen offset:0 lds
    v_mfma_f32_16x16x32_bf16 a[140:143], a[212:215], a[68:71], a[140:143]
    ds_read_b64_tr_b16 a[208:209], v44 offset:36864
    v_mfma_f32_16x16x32_bf16 a[136:139], a[212:215], a[64:67], a[136:139]
    ds_read_b64_tr_b16 a[210:211], v44 offset:38400
    s_waitcnt lgkmcnt(8)
    v_mfma_f32_16x16x32_bf16 a[144:147], a[216:219], a[64:67], a[144:147]
    ds_read_b64_tr_b16 a[212:213], v45 offset:36864
    v_mfma_f32_16x16x32_bf16 a[148:151], a[216:219], a[68:71], a[148:151]
    ds_read_b64_tr_b16 a[214:215], v45 offset:38400
    v_mfma_f32_16x16x32_bf16 a[156:159], a[220:223], a[68:71], a[156:159]
    ds_read_b64_tr_b16 a[216:217], v46 offset:36864
    buffer_load_dwordx4 v29, s[16:19], s67 offen offset:1024 lds
    s_add_u32 s67, s55, 640
    s_add_u32 m0, 147456, s69
    v_mfma_f32_16x16x32_bf16 a[152:155], a[220:223], a[64:67], a[152:155]
    ds_read_b64_tr_b16 a[218:219], v46 offset:38400
    v_mfma_f32_16x16x32_bf16 a[160:163], a[192:195], a[64:67], a[160:163]
    ds_read_b64_tr_b16 a[220:221], v47 offset:36864
    v_mfma_f32_16x16x32_bf16 a[164:167], a[192:195], a[68:71], a[164:167]
    ds_read_b64_tr_b16 a[222:223], v47 offset:38400
    s_waitcnt lgkmcnt(8)
    v_mfma_f32_16x16x32_bf16 a[172:175], a[196:199], a[68:71], a[172:175]
    ds_read_b64_tr_b16 a[192:193], v44 offset:36992
    v_mfma_f32_16x16x32_bf16 a[168:171], a[196:199], a[64:67], a[168:171]
    ds_read_b64_tr_b16 a[194:195], v44 offset:38528
    buffer_load_dwordx4 v30, s[20:23], s67 offen offset:0 lds
    v_mfma_f32_16x16x32_bf16 a[176:179], a[200:203], a[64:67], a[176:179]
    ds_read_b64_tr_b16 a[196:197], v45 offset:36992
    v_mfma_f32_16x16x32_bf16 a[180:183], a[200:203], a[68:71], a[180:183]
    ds_read_b64_tr_b16 a[198:199], v45 offset:38528
    v_mfma_f32_16x16x32_bf16 a[188:191], a[204:207], a[68:71], a[188:191]
    ds_read_b64_tr_b16 a[200:201], v46 offset:36992
    v_mfma_f32_16x16x32_bf16 a[184:187], a[204:207], a[64:67], a[184:187]
    ds_read_b64_tr_b16 a[202:203], v46 offset:38528
    s_waitcnt lgkmcnt(8)
    v_mfma_f32_16x16x32_bf16 a[96:99], a[208:211], a[72:75], a[96:99]
    ds_read_b64_tr_b16 a[204:205], v47 offset:36992
    buffer_load_dwordx4 v31, s[20:23], s67 offen offset:1024 lds
    v_mfma_f32_16x16x32_bf16 a[100:103], a[208:211], a[76:79], a[100:103]
    ds_read_b64_tr_b16 a[206:207], v47 offset:38528
    v_mfma_f32_16x16x32_bf16 a[108:111], a[212:215], a[76:79], a[108:111]
    ds_read_b64_tr_b16 a[208:209], v44 offset:37120
    v_mfma_f32_16x16x32_bf16 a[104:107], a[212:215], a[72:75], a[104:107]
    ds_read_b64_tr_b16 a[210:211], v44 offset:38656
    v_mfma_f32_16x16x32_bf16 a[112:115], a[216:219], a[72:75], a[112:115]
    ds_read_b64_tr_b16 a[212:213], v45 offset:37120
    v_mfma_f32_16x16x32_bf16 a[116:119], a[216:219], a[76:79], a[116:119]
    ds_read_b64_tr_b16 a[214:215], v45 offset:38656
    buffer_load_dwordx4 v32, s[20:23], s67 offen offset:2048 lds
    s_waitcnt lgkmcnt(8)
    v_mfma_f32_16x16x32_bf16 a[124:127], a[220:223], a[76:79], a[124:127]
    ds_read_b64_tr_b16 a[216:217], v46 offset:37120
    v_mfma_f32_16x16x32_bf16 a[120:123], a[220:223], a[72:75], a[120:123]
    ds_read_b64_tr_b16 a[218:219], v46 offset:38656
    v_mfma_f32_16x16x32_bf16 a[128:131], a[192:195], a[72:75], a[128:131]
    ds_read_b64_tr_b16 a[220:221], v47 offset:37120
    v_mfma_f32_16x16x32_bf16 a[132:135], a[192:195], a[76:79], a[132:135]
    ds_read_b64_tr_b16 a[222:223], v47 offset:38656
    v_mfma_f32_16x16x32_bf16 a[140:143], a[196:199], a[76:79], a[140:143]
    s_waitcnt vmcnt(10)
    s_barrier
    ds_read_b64_tr_b16 a[192:193], v248 offset:0
    buffer_load_dwordx4 v33, s[20:23], s67 offen offset:3072 lds
    v_mfma_f32_16x16x32_bf16 a[136:139], a[196:199], a[72:75], a[136:139]
    ds_read_b64_tr_b16 a[194:195], v248 offset:1536
    s_waitcnt lgkmcnt(8)
    v_mfma_f32_16x16x32_bf16 a[144:147], a[200:203], a[72:75], a[144:147]
    ds_read_b64_tr_b16 a[196:197], v249 offset:0
    buffer_load_dword v243, v241, s[92:95], s101 offen
    v_mfma_f32_16x16x32_bf16 a[148:151], a[200:203], a[76:79], a[148:151]
    ds_read_b64_tr_b16 a[198:199], v249 offset:1536
    s_add_u32 s101, s101, s59
    s_add_u32 m0, 122880, s49
    s_add_u32 s67, s54, 3932160
    v_mfma_f32_16x16x32_bf16 a[156:159], a[204:207], a[76:79], a[156:159]
    ds_read_b64_tr_b16 a[200:201], v250 offset:0
    v_mfma_f32_16x16x32_bf16 a[152:155], a[204:207], a[72:75], a[152:155]
    ds_read_b64_tr_b16 a[202:203], v250 offset:1536
    buffer_load_dwordx4 v24, s[16:19], s67 offen offset:0 lds
    v_mfma_f32_16x16x32_bf16 a[160:163], a[208:211], a[72:75], a[160:163]
    ds_read_b64_tr_b16 a[204:205], v251 offset:0
    v_mfma_f32_16x16x32_bf16 a[164:167], a[208:211], a[76:79], a[164:167]
    ds_read_b64_tr_b16 a[206:207], v251 offset:1536
    s_waitcnt lgkmcnt(8)
    v_mfma_f32_16x16x32_bf16 a[172:175], a[212:215], a[76:79], a[172:175]
    ds_read_b64_tr_b16 a[208:209], v248 offset:128
    v_mfma_f32_16x16x32_bf16 a[168:171], a[212:215], a[72:75], a[168:171]
    ds_read_b64_tr_b16 a[210:211], v248 offset:1664
    v_mfma_f32_16x16x32_bf16 a[176:179], a[216:219], a[72:75], a[176:179]
    ds_read_b64_tr_b16 a[212:213], v249 offset:128
    buffer_load_dwordx4 v25, s[16:19], s67 offen offset:1024 lds
    v_mfma_f32_16x16x32_bf16 a[180:183], a[216:219], a[76:79], a[180:183]
    ds_read_b64_tr_b16 a[214:215], v249 offset:1664
    v_mfma_f32_16x16x32_bf16 a[188:191], a[220:223], a[76:79], a[188:191]
    ds_read_b64_tr_b16 a[216:217], v250 offset:128
    v_mfma_f32_16x16x32_bf16 a[184:187], a[220:223], a[72:75], a[184:187]
    ds_read_b64_tr_b16 a[218:219], v250 offset:1664
    s_waitcnt lgkmcnt(8)
    v_mfma_f32_16x16x32_bf16 v[112:115], a[192:195], a[64:67], v[112:115]
    ds_read_b64_tr_b16 a[220:221], v251 offset:128
    v_mfma_f32_16x16x32_bf16 v[116:119], a[192:195], a[68:71], v[116:119]
    ds_read_b64_tr_b16 a[222:223], v251 offset:1664
    buffer_load_dwordx4 v26, s[16:19], s67 offen offset:2048 lds
    v_mfma_f32_16x16x32_bf16 v[124:127], a[196:199], a[68:71], v[124:127]
    ds_read_b64_tr_b16 a[192:193], v248 offset:256
    v_mfma_f32_16x16x32_bf16 v[120:123], a[196:199], a[64:67], v[120:123]
    ds_read_b64_tr_b16 a[194:195], v248 offset:1792
    v_mfma_f32_16x16x32_bf16 v[128:131], a[200:203], a[64:67], v[128:131]
    ds_read_b64_tr_b16 a[196:197], v249 offset:256
    v_mfma_f32_16x16x32_bf16 v[132:135], a[200:203], a[68:71], v[132:135]
    ds_read_b64_tr_b16 a[198:199], v249 offset:1792
    s_waitcnt lgkmcnt(8)
    v_mfma_f32_16x16x32_bf16 v[140:143], a[204:207], a[68:71], v[140:143]
    ds_read_b64_tr_b16 a[200:201], v250 offset:256
    buffer_load_dwordx4 v27, s[16:19], s67 offen offset:3072 lds
    s_add_u32 m0, m0, 4096
    v_mfma_f32_16x16x32_bf16 v[136:139], a[204:207], a[64:67], v[136:139]
    ds_read_b64_tr_b16 a[202:203], v250 offset:1792
    v_mfma_f32_16x16x32_bf16 v[144:147], a[208:211], a[64:67], v[144:147]
    ds_read_b64_tr_b16 a[204:205], v251 offset:256
    v_mfma_f32_16x16x32_bf16 v[148:151], a[208:211], a[68:71], v[148:151]
    ds_read_b64_tr_b16 a[206:207], v251 offset:1792
    v_mfma_f32_16x16x32_bf16 v[156:159], a[212:215], a[68:71], v[156:159]
    ds_read_b64_tr_b16 a[208:209], v248 offset:12288
    v_mfma_f32_16x16x32_bf16 v[152:155], a[212:215], a[64:67], v[152:155]
    ds_read_b64_tr_b16 a[210:211], v248 offset:13824
    buffer_load_dwordx4 v28, s[16:19], s67 offen offset:0 lds
    s_waitcnt lgkmcnt(8)
    v_mfma_f32_16x16x32_bf16 v[160:163], a[216:219], a[64:67], v[160:163]
    ds_read_b64_tr_b16 a[212:213], v249 offset:12288
    v_mfma_f32_16x16x32_bf16 v[164:167], a[216:219], a[68:71], v[164:167]
    ds_read_b64_tr_b16 a[214:215], v249 offset:13824
    v_mfma_f32_16x16x32_bf16 v[172:175], a[220:223], a[68:71], v[172:175]
    ds_read_b64_tr_b16 a[216:217], v250 offset:12288
    v_mfma_f32_16x16x32_bf16 v[168:171], a[220:223], a[64:67], v[168:171]
    ds_read_b64_tr_b16 a[218:219], v250 offset:13824
    v_mfma_f32_16x16x32_bf16 v[176:179], a[192:195], a[64:67], v[176:179]
    ds_read_b64_tr_b16 a[220:221], v251 offset:12288
    buffer_load_dwordx4 v29, s[16:19], s67 offen offset:1024 lds
    v_mfma_f32_16x16x32_bf16 v[180:183], a[192:195], a[68:71], v[180:183]
    ds_read_b64_tr_b16 a[222:223], v251 offset:13824
    s_waitcnt lgkmcnt(8)
    v_mfma_f32_16x16x32_bf16 v[188:191], a[196:199], a[68:71], v[188:191]
    ds_read_b64_tr_b16 a[192:193], v248 offset:12416
    v_mfma_f32_16x16x32_bf16 v[184:187], a[196:199], a[64:67], v[184:187]
    ds_read_b64_tr_b16 a[194:195], v248 offset:13952
    v_mfma_f32_16x16x32_bf16 v[192:195], a[200:203], a[64:67], v[192:195]
    ds_read_b64_tr_b16 a[196:197], v249 offset:12416
    v_mfma_f32_16x16x32_bf16 v[196:199], a[200:203], a[68:71], v[196:199]
    ds_read_b64_tr_b16 a[198:199], v249 offset:13952
    v_mfma_f32_16x16x32_bf16 v[204:207], a[204:207], a[68:71], v[204:207]
    ds_read_b64_tr_b16 a[200:201], v250 offset:12416
    v_mfma_f32_16x16x32_bf16 v[200:203], a[204:207], a[64:67], v[200:203]
    ds_read_b64_tr_b16 a[202:203], v250 offset:13952
    s_waitcnt lgkmcnt(8)
    v_mfma_f32_16x16x32_bf16 v[112:115], a[208:211], a[72:75], v[112:115]
    ds_read_b64_tr_b16 a[204:205], v251 offset:12416
    v_mfma_f32_16x16x32_bf16 v[116:119], a[208:211], a[76:79], v[116:119]
    ds_read_b64_tr_b16 a[206:207], v251 offset:13952
    v_mfma_f32_16x16x32_bf16 v[124:127], a[212:215], a[76:79], v[124:127]
    ds_read_b64_tr_b16 a[208:209], v248 offset:12544
    v_mfma_f32_16x16x32_bf16 v[120:123], a[212:215], a[72:75], v[120:123]
    ds_read_b64_tr_b16 a[210:211], v248 offset:14080
    v_mfma_f32_16x16x32_bf16 v[128:131], a[216:219], a[72:75], v[128:131]
    ds_read_b64_tr_b16 a[212:213], v249 offset:12544
    v_mfma_f32_16x16x32_bf16 v[132:135], a[216:219], a[76:79], v[132:135]
    ds_read_b64_tr_b16 a[214:215], v249 offset:14080
    s_waitcnt lgkmcnt(8)
    v_mfma_f32_16x16x32_bf16 v[140:143], a[220:223], a[76:79], v[140:143]
    ds_read_b64_tr_b16 a[216:217], v250 offset:12544
    v_mfma_f32_16x16x32_bf16 v[136:139], a[220:223], a[72:75], v[136:139]
    ds_read_b64_tr_b16 a[218:219], v250 offset:14080
    v_mfma_f32_16x16x32_bf16 v[144:147], a[192:195], a[72:75], v[144:147]
    ds_read_b64_tr_b16 a[220:221], v251 offset:12544
    v_mfma_f32_16x16x32_bf16 v[148:151], a[192:195], a[76:79], v[148:151]
    ds_read_b64_tr_b16 a[222:223], v251 offset:14080
    v_mfma_f32_16x16x32_bf16 v[156:159], a[196:199], a[76:79], v[156:159]
    s_waitcnt vmcnt(11)
    s_barrier
    ds_read_b64_tr_b16 a[192:193], v44 offset:0
    v_mfma_f32_16x16x32_bf16 v[152:155], a[196:199], a[72:75], v[152:155]
    ds_read_b64_tr_b16 a[194:195], v44 offset:1536
    ds_read_b128 a[80:83], v56 offset:0
    s_waitcnt lgkmcnt(9)
    v_mfma_f32_16x16x32_bf16 v[160:163], a[200:203], a[72:75], v[160:163]
    ds_read_b64_tr_b16 a[196:197], v45 offset:0
    ds_read_b128 a[84:87], v56 offset:2048
    ds_read_b128 a[88:91], v57 offset:0
    ds_read_b128 a[92:95], v57 offset:2048
    v_mfma_f32_16x16x32_bf16 v[164:167], a[200:203], a[76:79], v[164:167]
    ds_read_b64_tr_b16 a[198:199], v45 offset:1536
    s_add_u32 m0, 73728, s49
    s_add_u32 s67, s54, 4718592
    buffer_load_dwordx4 v24, s[16:19], s67 offen offset:0 lds
    v_mfma_f32_16x16x32_bf16 v[172:175], a[204:207], a[76:79], v[172:175]
    v_mfma_f32_16x16x32_bf16 v[168:171], a[204:207], a[72:75], v[168:171]
    v_mfma_f32_16x16x32_bf16 v[176:179], a[208:211], a[72:75], v[176:179]
    v_mfma_f32_16x16x32_bf16 v[180:183], a[208:211], a[76:79], v[180:183]
    s_waitcnt lgkmcnt(8)
    v_mfma_f32_16x16x32_bf16 v[188:191], a[212:215], a[76:79], v[188:191]
    ds_read_b64_tr_b16 a[200:201], v46 offset:0
    ds_read_b64_tr_b16 a[202:203], v46 offset:1536
    ds_read_b64_tr_b16 a[204:205], v47 offset:0
    buffer_load_dwordx4 v25, s[16:19], s67 offen offset:1024 lds
    v_mfma_f32_16x16x32_bf16 v[184:187], a[212:215], a[72:75], v[184:187]
    ds_read_b64_tr_b16 a[206:207], v47 offset:1536
    ds_read_b64_tr_b16 a[208:209], v44 offset:128
    ds_read_b64_tr_b16 a[210:211], v44 offset:1664
    v_mfma_f32_16x16x32_bf16 v[192:195], a[216:219], a[72:75], v[192:195]
    v_mfma_f32_16x16x32_bf16 v[196:199], a[216:219], a[76:79], v[196:199]
    v_mfma_f32_16x16x32_bf16 v[204:207], a[220:223], a[76:79], v[204:207]
    v_mfma_f32_16x16x32_bf16 v[200:203], a[220:223], a[72:75], v[200:203]
    s_waitcnt lgkmcnt(7)
    buffer_load_dwordx4 v26, s[16:19], s67 offen offset:2048 lds
    v_mfma_f32_16x16x32_bf16 v[112:115], a[192:195], a[80:83], v[112:115]
    ds_read_b64_tr_b16 a[212:213], v45 offset:128
    ds_read_b64_tr_b16 a[214:215], v45 offset:1664
    ds_read_b64_tr_b16 a[216:217], v46 offset:128
    v_mfma_f32_16x16x32_bf16 v[116:119], a[192:195], a[84:87], v[116:119]
    ds_read_b64_tr_b16 a[218:219], v46 offset:1664
    ds_read_b64_tr_b16 a[220:221], v47 offset:128
    ds_read_b64_tr_b16 a[222:223], v47 offset:1664
    s_waitcnt lgkmcnt(10)
    v_mfma_f32_16x16x32_bf16 v[124:127], a[196:199], a[84:87], v[124:127]
    ds_read_b64_tr_b16 a[192:193], v44 offset:256
    v_mfma_f32_16x16x32_bf16 v[120:123], a[196:199], a[80:83], v[120:123]
    ds_read_b64_tr_b16 a[194:195], v44 offset:1792
    v_mfma_f32_16x16x32_bf16 v[128:131], a[200:203], a[80:83], v[128:131]
    ds_read_b64_tr_b16 a[196:197], v45 offset:256
    buffer_load_dwordx4 v27, s[16:19], s67 offen offset:3072 lds
    s_add_u32 m0, m0, 4096
    v_mfma_f32_16x16x32_bf16 v[132:135], a[200:203], a[84:87], v[132:135]
    ds_read_b64_tr_b16 a[198:199], v45 offset:1792
    s_waitcnt lgkmcnt(8)
    v_mfma_f32_16x16x32_bf16 v[140:143], a[204:207], a[84:87], v[140:143]
    ds_read_b64_tr_b16 a[200:201], v46 offset:256
    v_mfma_f32_16x16x32_bf16 v[136:139], a[204:207], a[80:83], v[136:139]
    ds_read_b64_tr_b16 a[202:203], v46 offset:1792
    v_mfma_f32_16x16x32_bf16 v[144:147], a[208:211], a[80:83], v[144:147]
    ds_read_b64_tr_b16 a[204:205], v47 offset:256
    v_mfma_f32_16x16x32_bf16 v[148:151], a[208:211], a[84:87], v[148:151]
    ds_read_b64_tr_b16 a[206:207], v47 offset:1792
    buffer_load_dwordx4 v28, s[16:19], s67 offen offset:0 lds
    v_mfma_f32_16x16x32_bf16 v[156:159], a[212:215], a[84:87], v[156:159]
    ds_read_b64_tr_b16 a[208:209], v44 offset:12288
    v_mfma_f32_16x16x32_bf16 v[152:155], a[212:215], a[80:83], v[152:155]
    ds_read_b64_tr_b16 a[210:211], v44 offset:13824
    s_waitcnt lgkmcnt(8)
    v_mfma_f32_16x16x32_bf16 v[160:163], a[216:219], a[80:83], v[160:163]
    ds_read_b64_tr_b16 a[212:213], v45 offset:12288
    v_mfma_f32_16x16x32_bf16 v[164:167], a[216:219], a[84:87], v[164:167]
    ds_read_b64_tr_b16 a[214:215], v45 offset:13824
    v_mfma_f32_16x16x32_bf16 v[172:175], a[220:223], a[84:87], v[172:175]
    ds_read_b64_tr_b16 a[216:217], v46 offset:12288
    buffer_load_dwordx4 v29, s[16:19], s67 offen offset:1024 lds
    v_mfma_f32_16x16x32_bf16 v[168:171], a[220:223], a[80:83], v[168:171]
    ds_read_b64_tr_b16 a[218:219], v46 offset:13824
    v_mfma_f32_16x16x32_bf16 v[176:179], a[192:195], a[80:83], v[176:179]
    ds_read_b64_tr_b16 a[220:221], v47 offset:12288
    buffer_load_dword v243, v241, s[92:95], s101 offen
    s_add_u32 s101, s101, s59
    v_mfma_f32_16x16x32_bf16 v[180:183], a[192:195], a[84:87], v[180:183]
    ds_read_b64_tr_b16 a[222:223], v47 offset:13824
    s_add_u32 s67, s55, 768
    s_add_u32 m0, 32768, s69
    s_waitcnt lgkmcnt(8)
    v_mfma_f32_16x16x32_bf16 v[188:191], a[196:199], a[84:87], v[188:191]
    ds_read_b64_tr_b16 a[192:193], v44 offset:12416
    v_mfma_f32_16x16x32_bf16 v[184:187], a[196:199], a[80:83], v[184:187]
    ds_read_b64_tr_b16 a[194:195], v44 offset:13952
    buffer_load_dwordx4 v30, s[20:23], s67 offen offset:0 lds
    v_mfma_f32_16x16x32_bf16 v[192:195], a[200:203], a[80:83], v[192:195]
    ds_read_b64_tr_b16 a[196:197], v45 offset:12416
    v_mfma_f32_16x16x32_bf16 v[196:199], a[200:203], a[84:87], v[196:199]
    ds_read_b64_tr_b16 a[198:199], v45 offset:13952
    v_mfma_f32_16x16x32_bf16 v[204:207], a[204:207], a[84:87], v[204:207]
    ds_read_b64_tr_b16 a[200:201], v46 offset:12416
    v_mfma_f32_16x16x32_bf16 v[200:203], a[204:207], a[80:83], v[200:203]
    ds_read_b64_tr_b16 a[202:203], v46 offset:13952
    s_waitcnt lgkmcnt(8)
    v_mfma_f32_16x16x32_bf16 v[112:115], a[208:211], a[88:91], v[112:115]
    ds_read_b64_tr_b16 a[204:205], v47 offset:12416
    buffer_load_dwordx4 v31, s[20:23], s67 offen offset:1024 lds
    v_mfma_f32_16x16x32_bf16 v[116:119], a[208:211], a[92:95], v[116:119]
    ds_read_b64_tr_b16 a[206:207], v47 offset:13952
    v_mfma_f32_16x16x32_bf16 v[124:127], a[212:215], a[92:95], v[124:127]
    ds_read_b64_tr_b16 a[208:209], v44 offset:12544
    v_mfma_f32_16x16x32_bf16 v[120:123], a[212:215], a[88:91], v[120:123]
    ds_read_b64_tr_b16 a[210:211], v44 offset:14080
    v_mfma_f32_16x16x32_bf16 v[128:131], a[216:219], a[88:91], v[128:131]
    ds_read_b64_tr_b16 a[212:213], v45 offset:12544
    v_mfma_f32_16x16x32_bf16 v[132:135], a[216:219], a[92:95], v[132:135]
    ds_read_b64_tr_b16 a[214:215], v45 offset:14080
    buffer_load_dwordx4 v32, s[20:23], s67 offen offset:2048 lds
    s_waitcnt lgkmcnt(8)
    v_mfma_f32_16x16x32_bf16 v[140:143], a[220:223], a[92:95], v[140:143]
    ds_read_b64_tr_b16 a[216:217], v46 offset:12544
    v_mfma_f32_16x16x32_bf16 v[136:139], a[220:223], a[88:91], v[136:139]
    ds_read_b64_tr_b16 a[218:219], v46 offset:14080
    v_mfma_f32_16x16x32_bf16 v[144:147], a[192:195], a[88:91], v[144:147]
    ds_read_b64_tr_b16 a[220:221], v47 offset:12544
    v_mfma_f32_16x16x32_bf16 v[148:151], a[192:195], a[92:95], v[148:151]
    ds_read_b64_tr_b16 a[222:223], v47 offset:14080
    v_mfma_f32_16x16x32_bf16 v[156:159], a[196:199], a[92:95], v[156:159]
    s_waitcnt vmcnt(10)
    s_barrier
    ds_read_b64_tr_b16 a[192:193], v248 offset:24576
    buffer_load_dwordx4 v33, s[20:23], s67 offen offset:3072 lds
    v_mfma_f32_16x16x32_bf16 v[152:155], a[196:199], a[88:91], v[152:155]
    ds_read_b64_tr_b16 a[194:195], v248 offset:26112
    ds_read_b128 a[64:67], v38 offset:0
    s_waitcnt lgkmcnt(9)
    v_mfma_f32_16x16x32_bf16 v[160:163], a[200:203], a[88:91], v[160:163]
    ds_read_b64_tr_b16 a[196:197], v249 offset:24576
    ds_read_b128 a[68:71], v38 offset:2048
    v_mfma_f32_16x16x32_bf16 v[164:167], a[200:203], a[92:95], v[164:167]
    ds_read_b64_tr_b16 a[198:199], v249 offset:26112
    ds_read_b128 a[72:75], v39 offset:0
    ds_read_b128 a[76:79], v39 offset:2048
    v_mfma_f32_16x16x32_bf16 v[172:175], a[204:207], a[92:95], v[172:175]
    s_add_u32 m0, 98304, s49
    s_add_u32 s67, s54, 5505024
    v_mfma_f32_16x16x32_bf16 v[168:171], a[204:207], a[88:91], v[168:171]
    buffer_load_dwordx4 v24, s[16:19], s67 offen offset:0 lds
    v_mfma_f32_16x16x32_bf16 v[176:179], a[208:211], a[88:91], v[176:179]
    v_mfma_f32_16x16x32_bf16 v[180:183], a[208:211], a[92:95], v[180:183]
    s_waitcnt lgkmcnt(8)
    v_mfma_f32_16x16x32_bf16 v[188:191], a[212:215], a[92:95], v[188:191]
    ds_read_b64_tr_b16 a[200:201], v250 offset:24576
    ds_read_b64_tr_b16 a[202:203], v250 offset:26112
    ds_read_b64_tr_b16 a[204:205], v251 offset:24576
    v_mfma_f32_16x16x32_bf16 v[184:187], a[212:215], a[88:91], v[184:187]
    ds_read_b64_tr_b16 a[206:207], v251 offset:26112
    ds_read_b64_tr_b16 a[208:209], v248 offset:24704
    ds_read_b64_tr_b16 a[210:211], v248 offset:26240
    v_mfma_f32_16x16x32_bf16 v[192:195], a[216:219], a[88:91], v[192:195]
    buffer_load_dwordx4 v25, s[16:19], s67 offen offset:1024 lds
    v_mfma_f32_16x16x32_bf16 v[196:199], a[216:219], a[92:95], v[196:199]
    v_mfma_f32_16x16x32_bf16 v[204:207], a[220:223], a[92:95], v[204:207]
    v_mfma_f32_16x16x32_bf16 v[200:203], a[220:223], a[88:91], v[200:203]
    s_waitcnt lgkmcnt(6)
    v_mfma_f32_16x16x32_bf16 v[112:115], a[192:195], a[64:67], v[112:115]
    ds_read_b64_tr_b16 a[212:213], v249 offset:24704
    ds_read_b64_tr_b16 a[214:215], v249 offset:26240
    ds_read_b64_tr_b16 a[216:217], v250 offset:24704
    v_mfma_f32_16x16x32_bf16 v[116:119], a[192:195], a[68:71], v[116:119]
    ds_read_b64_tr_b16 a[218:219], v250 offset:26240
    ds_read_b64_tr_b16 a[220:221], v251 offset:24704
    ds_read_b64_tr_b16 a[222:223], v251 offset:26240
    buffer_load_dwordx4 v26, s[16:19], s67 offen offset:2048 lds
    v_mfma_f32_16x16x32_bf16 v[124:127], a[196:199], a[68:71], v[124:127]
    ds_read_b64_tr_b16 a[192:193], v248 offset:24832
    v_mfma_f32_16x16x32_bf16 v[120:123], a[196:199], a[64:67], v[120:123]
    ds_read_b64_tr_b16 a[194:195], v248 offset:26368
    s_waitcnt lgkmcnt(12)
    v_mfma_f32_16x16x32_bf16 v[128:131], a[200:203], a[64:67], v[128:131]
    ds_read_b64_tr_b16 a[196:197], v249 offset:24832
    v_mfma_f32_16x16x32_bf16 v[132:135], a[200:203], a[68:71], v[132:135]
    ds_read_b64_tr_b16 a[198:199], v249 offset:26368
    s_waitcnt lgkmcnt(8)
    v_mfma_f32_16x16x32_bf16 v[140:143], a[204:207], a[68:71], v[140:143]
    ds_read_b64_tr_b16 a[200:201], v250 offset:24832
    buffer_load_dwordx4 v27, s[16:19], s67 offen offset:3072 lds
    s_add_u32 m0, m0, 4096
    v_mfma_f32_16x16x32_bf16 v[136:139], a[204:207], a[64:67], v[136:139]
    ds_read_b64_tr_b16 a[202:203], v250 offset:26368
    v_mfma_f32_16x16x32_bf16 v[144:147], a[208:211], a[64:67], v[144:147]
    ds_read_b64_tr_b16 a[204:205], v251 offset:24832
    v_mfma_f32_16x16x32_bf16 v[148:151], a[208:211], a[68:71], v[148:151]
    ds_read_b64_tr_b16 a[206:207], v251 offset:26368
    v_mfma_f32_16x16x32_bf16 v[156:159], a[212:215], a[68:71], v[156:159]
    ds_read_b64_tr_b16 a[208:209], v248 offset:36864
    v_mfma_f32_16x16x32_bf16 v[152:155], a[212:215], a[64:67], v[152:155]
    ds_read_b64_tr_b16 a[210:211], v248 offset:38400
    buffer_load_dwordx4 v28, s[16:19], s67 offen offset:0 lds
    s_waitcnt lgkmcnt(8)
    v_mfma_f32_16x16x32_bf16 v[160:163], a[216:219], a[64:67], v[160:163]
    ds_read_b64_tr_b16 a[212:213], v249 offset:36864
    v_mfma_f32_16x16x32_bf16 v[164:167], a[216:219], a[68:71], v[164:167]
    ds_read_b64_tr_b16 a[214:215], v249 offset:38400
    v_mfma_f32_16x16x32_bf16 v[172:175], a[220:223], a[68:71], v[172:175]
    ds_read_b64_tr_b16 a[216:217], v250 offset:36864
    v_mfma_f32_16x16x32_bf16 v[168:171], a[220:223], a[64:67], v[168:171]
    ds_read_b64_tr_b16 a[218:219], v250 offset:38400
    v_mfma_f32_16x16x32_bf16 v[176:179], a[192:195], a[64:67], v[176:179]
    ds_read_b64_tr_b16 a[220:221], v251 offset:36864
    buffer_load_dwordx4 v29, s[16:19], s67 offen offset:1024 lds
    s_add_u32 s67, s55, 896
    s_add_u32 m0, 147456, s69
    v_mfma_f32_16x16x32_bf16 v[180:183], a[192:195], a[68:71], v[180:183]
    ds_read_b64_tr_b16 a[222:223], v251 offset:38400
    s_waitcnt lgkmcnt(8)
    v_mfma_f32_16x16x32_bf16 v[188:191], a[196:199], a[68:71], v[188:191]
    ds_read_b64_tr_b16 a[192:193], v248 offset:36992
    v_mfma_f32_16x16x32_bf16 v[184:187], a[196:199], a[64:67], v[184:187]
    ds_read_b64_tr_b16 a[194:195], v248 offset:38528
    v_mfma_f32_16x16x32_bf16 v[192:195], a[200:203], a[64:67], v[192:195]
    ds_read_b64_tr_b16 a[196:197], v249 offset:36992
    v_mfma_f32_16x16x32_bf16 v[196:199], a[200:203], a[68:71], v[196:199]
    ds_read_b64_tr_b16 a[198:199], v249 offset:38528
    buffer_load_dwordx4 v30, s[20:23], s67 offen offset:0 lds
    v_mfma_f32_16x16x32_bf16 v[204:207], a[204:207], a[68:71], v[204:207]
    ds_read_b64_tr_b16 a[200:201], v250 offset:36992
    v_mfma_f32_16x16x32_bf16 v[200:203], a[204:207], a[64:67], v[200:203]
    ds_read_b64_tr_b16 a[202:203], v250 offset:38528
    s_waitcnt lgkmcnt(8)
    v_mfma_f32_16x16x32_bf16 v[112:115], a[208:211], a[72:75], v[112:115]
    ds_read_b64_tr_b16 a[204:205], v251 offset:36992
    v_mfma_f32_16x16x32_bf16 v[116:119], a[208:211], a[76:79], v[116:119]
    ds_read_b64_tr_b16 a[206:207], v251 offset:38528
    v_mfma_f32_16x16x32_bf16 v[124:127], a[212:215], a[76:79], v[124:127]
    ds_read_b64_tr_b16 a[208:209], v248 offset:37120
    buffer_load_dwordx4 v31, s[20:23], s67 offen offset:1024 lds
    v_mfma_f32_16x16x32_bf16 v[120:123], a[212:215], a[72:75], v[120:123]
    ds_read_b64_tr_b16 a[210:211], v248 offset:38656
    v_mfma_f32_16x16x32_bf16 v[128:131], a[216:219], a[72:75], v[128:131]
    ds_read_b64_tr_b16 a[212:213], v249 offset:37120
    v_mfma_f32_16x16x32_bf16 v[132:135], a[216:219], a[76:79], v[132:135]
    ds_read_b64_tr_b16 a[214:215], v249 offset:38656
    s_waitcnt lgkmcnt(8)
    v_mfma_f32_16x16x32_bf16 v[140:143], a[220:223], a[76:79], v[140:143]
    ds_read_b64_tr_b16 a[216:217], v250 offset:37120
    v_mfma_f32_16x16x32_bf16 v[136:139], a[220:223], a[72:75], v[136:139]
    ds_read_b64_tr_b16 a[218:219], v250 offset:38656
    buffer_load_dwordx4 v32, s[20:23], s67 offen offset:2048 lds
    v_mfma_f32_16x16x32_bf16 v[144:147], a[192:195], a[72:75], v[144:147]
    ds_read_b64_tr_b16 a[220:221], v251 offset:37120
    v_mfma_f32_16x16x32_bf16 v[148:151], a[192:195], a[76:79], v[148:151]
    ds_read_b64_tr_b16 a[222:223], v251 offset:38656
    v_mfma_f32_16x16x32_bf16 v[156:159], a[196:199], a[76:79], v[156:159]
    s_waitcnt vmcnt(9)
    s_barrier
    ds_read_b64_tr_b16 a[192:193], v44 offset:24576
    v_mfma_f32_16x16x32_bf16 v[152:155], a[196:199], a[72:75], v[152:155]
    ds_read_b64_tr_b16 a[194:195], v44 offset:26112
    ds_read_b128 a[48:51], v56 offset:0
    s_waitcnt lgkmcnt(9)
    v_mfma_f32_16x16x32_bf16 v[160:163], a[200:203], a[72:75], v[160:163]
    ds_read_b64_tr_b16 a[196:197], v45 offset:24576
    ds_read_b128 a[52:55], v56 offset:2048
    ds_read_b128 a[56:59], v57 offset:0
    ds_read_b128 a[60:63], v57 offset:2048
    buffer_load_dwordx4 v33, s[20:23], s67 offen offset:3072 lds
    v_mfma_f32_16x16x32_bf16 v[164:167], a[200:203], a[76:79], v[164:167]
    ds_read_b64_tr_b16 a[198:199], v45 offset:26112
    v_mfma_f32_16x16x32_bf16 v[172:175], a[204:207], a[76:79], v[172:175]
    buffer_load_dword v243, v241, s[92:95], s101 offen
    s_add_u32 s101, s101, s59
    v_mfma_f32_16x16x32_bf16 v[168:171], a[204:207], a[72:75], v[168:171]
    s_add_u32 m0, 49152, s49
    s_add_u32 s67, s54, 6291456
    v_mfma_f32_16x16x32_bf16 v[176:179], a[208:211], a[72:75], v[176:179]
    v_mfma_f32_16x16x32_bf16 v[180:183], a[208:211], a[76:79], v[180:183]
    buffer_load_dwordx4 v24, s[16:19], s67 offen offset:0 lds
    s_waitcnt lgkmcnt(8)
    v_mfma_f32_16x16x32_bf16 v[188:191], a[212:215], a[76:79], v[188:191]
    ds_read_b64_tr_b16 a[200:201], v46 offset:24576
    ds_read_b64_tr_b16 a[202:203], v46 offset:26112
    ds_read_b64_tr_b16 a[204:205], v47 offset:24576
    v_mfma_f32_16x16x32_bf16 v[184:187], a[212:215], a[72:75], v[184:187]
    ds_read_b64_tr_b16 a[206:207], v47 offset:26112
    ds_read_b64_tr_b16 a[208:209], v44 offset:24704
    ds_read_b64_tr_b16 a[210:211], v44 offset:26240
    v_mfma_f32_16x16x32_bf16 v[192:195], a[216:219], a[72:75], v[192:195]
    v_mfma_f32_16x16x32_bf16 v[196:199], a[216:219], a[76:79], v[196:199]
    v_mfma_f32_16x16x32_bf16 v[204:207], a[220:223], a[76:79], v[204:207]
    buffer_load_dwordx4 v25, s[16:19], s67 offen offset:1024 lds
    v_mfma_f32_16x16x32_bf16 v[200:203], a[220:223], a[72:75], v[200:203]
    s_waitcnt lgkmcnt(7)
    v_mfma_f32_16x16x32_bf16 v[112:115], a[192:195], a[48:51], v[112:115]
    ds_read_b64_tr_b16 a[212:213], v45 offset:24704
    ds_read_b64_tr_b16 a[214:215], v45 offset:26240
    ds_read_b64_tr_b16 a[216:217], v46 offset:24704
    v_mfma_f32_16x16x32_bf16 v[116:119], a[192:195], a[52:55], v[116:119]
    ds_read_b64_tr_b16 a[218:219], v46 offset:26240
    ds_read_b64_tr_b16 a[220:221], v47 offset:24704
    ds_read_b64_tr_b16 a[222:223], v47 offset:26240
    s_waitcnt lgkmcnt(10)
    v_mfma_f32_16x16x32_bf16 v[124:127], a[196:199], a[52:55], v[124:127]
    ds_read_b64_tr_b16 a[192:193], v44 offset:24832
    v_mfma_f32_16x16x32_bf16 v[120:123], a[196:199], a[48:51], v[120:123]
    ds_read_b64_tr_b16 a[194:195], v44 offset:26368
    buffer_load_dwordx4 v26, s[16:19], s67 offen offset:2048 lds
    v_mfma_f32_16x16x32_bf16 v[128:131], a[200:203], a[48:51], v[128:131]
    ds_read_b64_tr_b16 a[196:197], v45 offset:24832
    v_mfma_f32_16x16x32_bf16 v[132:135], a[200:203], a[52:55], v[132:135]
    ds_read_b64_tr_b16 a[198:199], v45 offset:26368
    s_waitcnt lgkmcnt(8)
    v_mfma_f32_16x16x32_bf16 v[140:143], a[204:207], a[52:55], v[140:143]
    ds_read_b64_tr_b16 a[200:201], v46 offset:24832
    v_mfma_f32_16x16x32_bf16 v[136:139], a[204:207], a[48:51], v[136:139]
    ds_read_b64_tr_b16 a[202:203], v46 offset:26368
    v_mfma_f32_16x16x32_bf16 v[144:147], a[208:211], a[48:51], v[144:147]
    ds_read_b64_tr_b16 a[204:205], v47 offset:24832
    buffer_load_dwordx4 v27, s[16:19], s67 offen offset:3072 lds
    s_add_u32 m0, m0, 4096
    v_mfma_f32_16x16x32_bf16 v[148:151], a[208:211], a[52:55], v[148:151]
    ds_read_b64_tr_b16 a[206:207], v47 offset:26368
    v_mfma_f32_16x16x32_bf16 v[156:159], a[212:215], a[52:55], v[156:159]
    ds_read_b64_tr_b16 a[208:209], v44 offset:36864
    v_mfma_f32_16x16x32_bf16 v[152:155], a[212:215], a[48:51], v[152:155]
    ds_read_b64_tr_b16 a[210:211], v44 offset:38400
    s_waitcnt lgkmcnt(8)
    v_mfma_f32_16x16x32_bf16 v[160:163], a[216:219], a[48:51], v[160:163]
    ds_read_b64_tr_b16 a[212:213], v45 offset:36864
    v_mfma_f32_16x16x32_bf16 v[164:167], a[216:219], a[52:55], v[164:167]
    ds_read_b64_tr_b16 a[214:215], v45 offset:38400
    buffer_load_dwordx4 v28, s[16:19], s67 offen offset:0 lds
    v_mfma_f32_16x16x32_bf16 v[172:175], a[220:223], a[52:55], v[172:175]
    ds_read_b64_tr_b16 a[216:217], v46 offset:36864
    v_mfma_f32_16x16x32_bf16 v[168:171], a[220:223], a[48:51], v[168:171]
    ds_read_b64_tr_b16 a[218:219], v46 offset:38400
    v_mfma_f32_16x16x32_bf16 v[176:179], a[192:195], a[48:51], v[176:179]
    ds_read_b64_tr_b16 a[220:221], v47 offset:36864
    v_mfma_f32_16x16x32_bf16 v[180:183], a[192:195], a[52:55], v[180:183]
    ds_read_b64_tr_b16 a[222:223], v47 offset:38400
    s_waitcnt lgkmcnt(8)
    v_mfma_f32_16x16x32_bf16 v[188:191], a[196:199], a[52:55], v[188:191]
    ds_read_b64_tr_b16 a[192:193], v44 offset:36992
    buffer_load_dwordx4 v29, s[16:19], s67 offen offset:1024 lds
    s_add_u32 s67, s55, 1024
    s_add_u32 m0, 32768, s69
    v_mfma_f32_16x16x32_bf16 v[184:187], a[196:199], a[48:51], v[184:187]
    ds_read_b64_tr_b16 a[194:195], v44 offset:38528
    v_mfma_f32_16x16x32_bf16 v[192:195], a[200:203], a[48:51], v[192:195]
    ds_read_b64_tr_b16 a[196:197], v45 offset:36992
    v_mfma_f32_16x16x32_bf16 v[196:199], a[200:203], a[52:55], v[196:199]
    ds_read_b64_tr_b16 a[198:199], v45 offset:38528
    v_mfma_f32_16x16x32_bf16 v[204:207], a[204:207], a[52:55], v[204:207]
    ds_read_b64_tr_b16 a[200:201], v46 offset:36992
    v_mfma_f32_16x16x32_bf16 v[200:203], a[204:207], a[48:51], v[200:203]
    ds_read_b64_tr_b16 a[202:203], v46 offset:38528
    buffer_load_dwordx4 v30, s[20:23], s67 offen offset:0 lds
    s_waitcnt lgkmcnt(8)
    v_mfma_f32_16x16x32_bf16 v[112:115], a[208:211], a[56:59], v[112:115]
    ds_read_b64_tr_b16 a[204:205], v47 offset:36992
    v_mfma_f32_16x16x32_bf16 v[116:119], a[208:211], a[60:63], v[116:119]
    ds_read_b64_tr_b16 a[206:207], v47 offset:38528
    v_mfma_f32_16x16x32_bf16 v[124:127], a[212:215], a[60:63], v[124:127]
    ds_read_b64_tr_b16 a[208:209], v44 offset:37120
    v_mfma_f32_16x16x32_bf16 v[120:123], a[212:215], a[56:59], v[120:123]
    ds_read_b64_tr_b16 a[210:211], v44 offset:38656
    v_mfma_f32_16x16x32_bf16 v[128:131], a[216:219], a[56:59], v[128:131]
    ds_read_b64_tr_b16 a[212:213], v45 offset:37120
    buffer_load_dwordx4 v31, s[20:23], s67 offen offset:1024 lds
    v_mfma_f32_16x16x32_bf16 v[132:135], a[216:219], a[60:63], v[132:135]
    ds_read_b64_tr_b16 a[214:215], v45 offset:38656
    s_waitcnt lgkmcnt(8)
    v_mfma_f32_16x16x32_bf16 v[140:143], a[220:223], a[60:63], v[140:143]
    ds_read_b64_tr_b16 a[216:217], v46 offset:37120
    v_mfma_f32_16x16x32_bf16 v[136:139], a[220:223], a[56:59], v[136:139]
    ds_read_b64_tr_b16 a[218:219], v46 offset:38656
    v_mfma_f32_16x16x32_bf16 v[144:147], a[192:195], a[56:59], v[144:147]
    ds_read_b64_tr_b16 a[220:221], v47 offset:37120
    v_mfma_f32_16x16x32_bf16 v[148:151], a[192:195], a[60:63], v[148:151]
    ds_read_b64_tr_b16 a[222:223], v47 offset:38656
    buffer_load_dwordx4 v32, s[20:23], s67 offen offset:2048 lds
    v_mfma_f32_16x16x32_bf16 v[156:159], a[196:199], a[60:63], v[156:159]
    s_waitcnt vmcnt(10)
    s_barrier
    ds_read_b64_tr_b16 a[192:193], v248 offset:0
    v_mfma_f32_16x16x32_bf16 v[152:155], a[196:199], a[56:59], v[152:155]
    ds_read_b64_tr_b16 a[194:195], v248 offset:1536
    ds_read_b128 a[224:227], v38 offset:0
    s_waitcnt lgkmcnt(9)
    v_mfma_f32_16x16x32_bf16 v[160:163], a[200:203], a[56:59], v[160:163]
    ds_read_b64_tr_b16 a[196:197], v249 offset:0
    ds_read_b128 a[228:231], v38 offset:2048
    ds_read_b128 a[232:235], v39 offset:0
    ds_read_b128 a[236:239], v39 offset:2048
    v_mfma_f32_16x16x32_bf16 v[164:167], a[200:203], a[60:63], v[164:167]
    ds_read_b64_tr_b16 a[198:199], v249 offset:1536
    v_mfma_f32_16x16x32_bf16 v[172:175], a[204:207], a[60:63], v[172:175]
    buffer_load_dwordx4 v33, s[20:23], s67 offen offset:3072 lds
    v_mfma_f32_16x16x32_bf16 v[168:171], a[204:207], a[56:59], v[168:171]
    v_mfma_f32_16x16x32_bf16 v[176:179], a[208:211], a[56:59], v[176:179]
    buffer_load_dword v243, v241, s[92:95], s101 offen
    s_add_u32 s101, s101, s59
    s_add_u32 m0, 122880, s49
    s_add_u32 s67, s54, 7077888
    v_mfma_f32_16x16x32_bf16 v[180:183], a[208:211], a[60:63], v[180:183]
    s_waitcnt lgkmcnt(8)
    v_mfma_f32_16x16x32_bf16 v[188:191], a[212:215], a[60:63], v[188:191]
    ds_read_b64_tr_b16 a[200:201], v250 offset:0
    ds_read_b64_tr_b16 a[202:203], v250 offset:1536
    ds_read_b64_tr_b16 a[204:205], v251 offset:0
    v_mfma_f32_16x16x32_bf16 v[184:187], a[212:215], a[56:59], v[184:187]
    ds_read_b64_tr_b16 a[206:207], v251 offset:1536
    ds_read_b64_tr_b16 a[208:209], v248 offset:128
    ds_read_b64_tr_b16 a[210:211], v248 offset:1664
    buffer_load_dwordx4 v24, s[16:19], s67 offen offset:0 lds
    v_mfma_f32_16x16x32_bf16 v[192:195], a[216:219], a[56:59], v[192:195]
    v_mfma_f32_16x16x32_bf16 v[196:199], a[216:219], a[60:63], v[196:199]
    v_mfma_f32_16x16x32_bf16 v[204:207], a[220:223], a[60:63], v[204:207]
    v_mfma_f32_16x16x32_bf16 v[200:203], a[220:223], a[56:59], v[200:203]
    s_waitcnt lgkmcnt(7)
    v_mfma_f32_16x16x32_bf16 v[112:115], a[192:195], a[224:227], v[112:115]
    ds_read_b64_tr_b16 a[212:213], v249 offset:128
    ds_read_b64_tr_b16 a[214:215], v249 offset:1664
    ds_read_b64_tr_b16 a[216:217], v250 offset:128
    buffer_load_dwordx4 v25, s[16:19], s67 offen offset:1024 lds
    v_mfma_f32_16x16x32_bf16 v[116:119], a[192:195], a[228:231], v[116:119]
    ds_read_b64_tr_b16 a[218:219], v250 offset:1664
    ds_read_b64_tr_b16 a[220:221], v251 offset:128
    ds_read_b64_tr_b16 a[222:223], v251 offset:1664
    s_waitcnt lgkmcnt(10)
    v_mfma_f32_16x16x32_bf16 v[124:127], a[196:199], a[228:231], v[124:127]
    ds_read_b64_tr_b16 a[192:193], v248 offset:256
    v_mfma_f32_16x16x32_bf16 v[120:123], a[196:199], a[224:227], v[120:123]
    ds_read_b64_tr_b16 a[194:195], v248 offset:1792
    v_mfma_f32_16x16x32_bf16 v[128:131], a[200:203], a[224:227], v[128:131]
    ds_read_b64_tr_b16 a[196:197], v249 offset:256
    v_mfma_f32_16x16x32_bf16 v[132:135], a[200:203], a[228:231], v[132:135]
    ds_read_b64_tr_b16 a[198:199], v249 offset:1792
    buffer_load_dwordx4 v26, s[16:19], s67 offen offset:2048 lds
    s_waitcnt lgkmcnt(8)
    v_mfma_f32_16x16x32_bf16 v[140:143], a[204:207], a[228:231], v[140:143]
    ds_read_b64_tr_b16 a[200:201], v250 offset:256
    v_mfma_f32_16x16x32_bf16 v[136:139], a[204:207], a[224:227], v[136:139]
    ds_read_b64_tr_b16 a[202:203], v250 offset:1792
    v_mfma_f32_16x16x32_bf16 v[144:147], a[208:211], a[224:227], v[144:147]
    ds_read_b64_tr_b16 a[204:205], v251 offset:256
    v_mfma_f32_16x16x32_bf16 v[148:151], a[208:211], a[228:231], v[148:151]
    ds_read_b64_tr_b16 a[206:207], v251 offset:1792
    v_mfma_f32_16x16x32_bf16 v[156:159], a[212:215], a[228:231], v[156:159]
    ds_read_b64_tr_b16 a[208:209], v248 offset:12288
    buffer_load_dwordx4 v27, s[16:19], s67 offen offset:3072 lds
    s_add_u32 m0, m0, 4096
    v_mfma_f32_16x16x32_bf16 v[152:155], a[212:215], a[224:227], v[152:155]
    ds_read_b64_tr_b16 a[210:211], v248 offset:13824
    s_waitcnt lgkmcnt(8)
    v_mfma_f32_16x16x32_bf16 v[160:163], a[216:219], a[224:227], v[160:163]
    ds_read_b64_tr_b16 a[212:213], v249 offset:12288
    v_mfma_f32_16x16x32_bf16 v[164:167], a[216:219], a[228:231], v[164:167]
    ds_read_b64_tr_b16 a[214:215], v249 offset:13824
    v_mfma_f32_16x16x32_bf16 v[172:175], a[220:223], a[228:231], v[172:175]
    ds_read_b64_tr_b16 a[216:217], v250 offset:12288
    v_mfma_f32_16x16x32_bf16 v[168:171], a[220:223], a[224:227], v[168:171]
    ds_read_b64_tr_b16 a[218:219], v250 offset:13824
    buffer_load_dwordx4 v28, s[16:19], s67 offen offset:0 lds
    v_mfma_f32_16x16x32_bf16 v[176:179], a[192:195], a[224:227], v[176:179]
    ds_read_b64_tr_b16 a[220:221], v251 offset:12288
    v_mfma_f32_16x16x32_bf16 v[180:183], a[192:195], a[228:231], v[180:183]
    ds_read_b64_tr_b16 a[222:223], v251 offset:13824
    s_waitcnt lgkmcnt(8)
    v_mfma_f32_16x16x32_bf16 v[188:191], a[196:199], a[228:231], v[188:191]
    ds_read_b64_tr_b16 a[192:193], v248 offset:12416
    v_mfma_f32_16x16x32_bf16 v[184:187], a[196:199], a[224:227], v[184:187]
    ds_read_b64_tr_b16 a[194:195], v248 offset:13952
    v_mfma_f32_16x16x32_bf16 v[192:195], a[200:203], a[224:227], v[192:195]
    ds_read_b64_tr_b16 a[196:197], v249 offset:12416
    buffer_load_dwordx4 v29, s[16:19], s67 offen offset:1024 lds
    s_add_u32 s67, s55, 1152
    s_add_u32 m0, 147456, s69
    v_mfma_f32_16x16x32_bf16 v[196:199], a[200:203], a[228:231], v[196:199]
    ds_read_b64_tr_b16 a[198:199], v249 offset:13952
    v_mfma_f32_16x16x32_bf16 v[204:207], a[204:207], a[228:231], v[204:207]
    ds_read_b64_tr_b16 a[200:201], v250 offset:12416
    v_mfma_f32_16x16x32_bf16 v[200:203], a[204:207], a[224:227], v[200:203]
    ds_read_b64_tr_b16 a[202:203], v250 offset:13952
    s_waitcnt lgkmcnt(8)
    v_mfma_f32_16x16x32_bf16 v[112:115], a[208:211], a[232:235], v[112:115]
    ds_read_b64_tr_b16 a[204:205], v251 offset:12416
    v_mfma_f32_16x16x32_bf16 v[116:119], a[208:211], a[236:239], v[116:119]
    ds_read_b64_tr_b16 a[206:207], v251 offset:13952
    buffer_load_dwordx4 v30, s[20:23], s67 offen offset:0 lds
    v_mfma_f32_16x16x32_bf16 v[124:127], a[212:215], a[236:239], v[124:127]
    ds_read_b64_tr_b16 a[208:209], v248 offset:12544
    v_mfma_f32_16x16x32_bf16 v[120:123], a[212:215], a[232:235], v[120:123]
    ds_read_b64_tr_b16 a[210:211], v248 offset:14080
    v_mfma_f32_16x16x32_bf16 v[128:131], a[216:219], a[232:235], v[128:131]
    ds_read_b64_tr_b16 a[212:213], v249 offset:12544
    v_mfma_f32_16x16x32_bf16 v[132:135], a[216:219], a[236:239], v[132:135]
    ds_read_b64_tr_b16 a[214:215], v249 offset:14080
    s_waitcnt lgkmcnt(8)
    v_mfma_f32_16x16x32_bf16 v[140:143], a[220:223], a[236:239], v[140:143]
    ds_read_b64_tr_b16 a[216:217], v250 offset:12544
    buffer_load_dwordx4 v31, s[20:23], s67 offen offset:1024 lds
    v_mfma_f32_16x16x32_bf16 v[136:139], a[220:223], a[232:235], v[136:139]
    ds_read_b64_tr_b16 a[218:219], v250 offset:14080
    v_mfma_f32_16x16x32_bf16 v[144:147], a[192:195], a[232:235], v[144:147]
    ds_read_b64_tr_b16 a[220:221], v251 offset:12544
    v_mfma_f32_16x16x32_bf16 v[148:151], a[192:195], a[236:239], v[148:151]
    ds_read_b64_tr_b16 a[222:223], v251 offset:14080
    v_mfma_f32_16x16x32_bf16 v[156:159], a[196:199], a[236:239], v[156:159]
    s_waitcnt vmcnt(9)
    s_barrier
    ds_read_b64_tr_b16 a[192:193], v44 offset:0
    v_mfma_f32_16x16x32_bf16 v[152:155], a[196:199], a[232:235], v[152:155]
    ds_read_b64_tr_b16 a[194:195], v44 offset:1536
    ds_read_b128 a[240:243], v56 offset:0
    buffer_load_dwordx4 v32, s[20:23], s67 offen offset:2048 lds
    s_waitcnt lgkmcnt(9)
    v_mfma_f32_16x16x32_bf16 v[160:163], a[200:203], a[232:235], v[160:163]
    ds_read_b64_tr_b16 a[196:197], v45 offset:0
    ds_read_b128 a[244:247], v56 offset:2048
    v_mfma_f32_16x16x32_bf16 v[164:167], a[200:203], a[236:239], v[164:167]
    ds_read_b64_tr_b16 a[198:199], v45 offset:1536
    ds_read_b128 a[248:251], v57 offset:0
    ds_read_b128 a[252:255], v57 offset:2048
    v_mfma_f32_16x16x32_bf16 v[172:175], a[204:207], a[236:239], v[172:175]
    v_mfma_f32_16x16x32_bf16 v[168:171], a[204:207], a[232:235], v[168:171]
    v_mfma_f32_16x16x32_bf16 v[176:179], a[208:211], a[232:235], v[176:179]
    buffer_load_dwordx4 v33, s[20:23], s67 offen offset:3072 lds
    s_add_u32 m0, 73728, s49
    s_add_u32 s67, s54, 7084032
    v_mfma_f32_16x16x32_bf16 v[180:183], a[208:211], a[236:239], v[180:183]
    s_waitcnt lgkmcnt(8)
    v_mfma_f32_16x16x32_bf16 v[188:191], a[212:215], a[236:239], v[188:191]
    ds_read_b64_tr_b16 a[200:201], v46 offset:0
    ds_read_b64_tr_b16 a[202:203], v46 offset:1536
    ds_read_b64_tr_b16 a[204:205], v47 offset:0
    v_mfma_f32_16x16x32_bf16 v[184:187], a[212:215], a[232:235], v[184:187]
    ds_read_b64_tr_b16 a[206:207], v47 offset:1536
    ds_read_b64_tr_b16 a[208:209], v44 offset:128
    ds_read_b64_tr_b16 a[210:211], v44 offset:1664
    v_mfma_f32_16x16x32_bf16 v[192:195], a[216:219], a[232:235], v[192:195]
    v_mfma_f32_16x16x32_bf16 v[196:199], a[216:219], a[236:239], v[196:199]
    buffer_load_dwordx4 v24, s[16:19], s67 offen offset:0 lds
    v_mfma_f32_16x16x32_bf16 v[204:207], a[220:223], a[236:239], v[204:207]
    v_mfma_f32_16x16x32_bf16 v[200:203], a[220:223], a[232:235], v[200:203]
    s_waitcnt lgkmcnt(6)
    v_mfma_f32_16x16x32_bf16 v[112:115], a[192:195], a[240:243], v[112:115]
    ds_read_b64_tr_b16 a[212:213], v45 offset:128
    ds_read_b64_tr_b16 a[214:215], v45 offset:1664
    ds_read_b64_tr_b16 a[216:217], v46 offset:128
    v_mfma_f32_16x16x32_bf16 v[116:119], a[192:195], a[244:247], v[116:119]
    ds_read_b64_tr_b16 a[218:219], v46 offset:1664
    ds_read_b64_tr_b16 a[220:221], v47 offset:128
    ds_read_b64_tr_b16 a[222:223], v47 offset:1664
    v_mfma_f32_16x16x32_bf16 v[124:127], a[196:199], a[244:247], v[124:127]
    ds_read_b64_tr_b16 a[192:193], v44 offset:256
    buffer_load_dwordx4 v25, s[16:19], s67 offen offset:1024 lds
    v_mfma_f32_16x16x32_bf16 v[120:123], a[196:199], a[240:243], v[120:123]
    ds_read_b64_tr_b16 a[194:195], v44 offset:1792
    s_waitcnt lgkmcnt(12)
    v_mfma_f32_16x16x32_bf16 v[128:131], a[200:203], a[240:243], v[128:131]
    ds_read_b64_tr_b16 a[196:197], v45 offset:256
    v_mfma_f32_16x16x32_bf16 v[132:135], a[200:203], a[244:247], v[132:135]
    ds_read_b64_tr_b16 a[198:199], v45 offset:1792
    s_waitcnt lgkmcnt(8)
    v_mfma_f32_16x16x32_bf16 v[140:143], a[204:207], a[244:247], v[140:143]
    ds_read_b64_tr_b16 a[200:201], v46 offset:256
    v_mfma_f32_16x16x32_bf16 v[136:139], a[204:207], a[240:243], v[136:139]
    ds_read_b64_tr_b16 a[202:203], v46 offset:1792
    buffer_load_dwordx4 v26, s[16:19], s67 offen offset:2048 lds
    v_mfma_f32_16x16x32_bf16 v[144:147], a[208:211], a[240:243], v[144:147]
    ds_read_b64_tr_b16 a[204:205], v47 offset:256
    v_mfma_f32_16x16x32_bf16 v[148:151], a[208:211], a[244:247], v[148:151]
    ds_read_b64_tr_b16 a[206:207], v47 offset:1792
    v_mfma_f32_16x16x32_bf16 v[156:159], a[212:215], a[244:247], v[156:159]
    ds_read_b64_tr_b16 a[208:209], v44 offset:12288
    v_mfma_f32_16x16x32_bf16 v[152:155], a[212:215], a[240:243], v[152:155]
    ds_read_b64_tr_b16 a[210:211], v44 offset:13824
    s_waitcnt lgkmcnt(8)
    v_mfma_f32_16x16x32_bf16 v[160:163], a[216:219], a[240:243], v[160:163]
    ds_read_b64_tr_b16 a[212:213], v45 offset:12288
    buffer_load_dwordx4 v27, s[16:19], s67 offen offset:3072 lds
    s_add_u32 m0, m0, 4096
    v_mfma_f32_16x16x32_bf16 v[164:167], a[216:219], a[244:247], v[164:167]
    ds_read_b64_tr_b16 a[214:215], v45 offset:13824
    v_mfma_f32_16x16x32_bf16 v[172:175], a[220:223], a[244:247], v[172:175]
    ds_read_b64_tr_b16 a[216:217], v46 offset:12288
    v_mfma_f32_16x16x32_bf16 v[168:171], a[220:223], a[240:243], v[168:171]
    ds_read_b64_tr_b16 a[218:219], v46 offset:13824
    v_mfma_f32_16x16x32_bf16 v[176:179], a[192:195], a[240:243], v[176:179]
    ds_read_b64_tr_b16 a[220:221], v47 offset:12288
    v_mfma_f32_16x16x32_bf16 v[180:183], a[192:195], a[244:247], v[180:183]
    ds_read_b64_tr_b16 a[222:223], v47 offset:13824
    buffer_load_dwordx4 v28, s[16:19], s67 offen offset:0 lds
    s_waitcnt lgkmcnt(8)
    v_mfma_f32_16x16x32_bf16 v[188:191], a[196:199], a[244:247], v[188:191]
    ds_read_b64_tr_b16 a[192:193], v44 offset:12416
    v_mfma_f32_16x16x32_bf16 v[184:187], a[196:199], a[240:243], v[184:187]
    ds_read_b64_tr_b16 a[194:195], v44 offset:13952
    v_mfma_f32_16x16x32_bf16 v[192:195], a[200:203], a[240:243], v[192:195]
    ds_read_b64_tr_b16 a[196:197], v45 offset:12416
    v_mfma_f32_16x16x32_bf16 v[196:199], a[200:203], a[244:247], v[196:199]
    ds_read_b64_tr_b16 a[198:199], v45 offset:13952
    v_mfma_f32_16x16x32_bf16 v[204:207], a[204:207], a[244:247], v[204:207]
    ds_read_b64_tr_b16 a[200:201], v46 offset:12416
    buffer_load_dwordx4 v29, s[16:19], s67 offen offset:1024 lds
    v_mfma_f32_16x16x32_bf16 v[200:203], a[204:207], a[240:243], v[200:203]
    ds_read_b64_tr_b16 a[202:203], v46 offset:13952
    s_waitcnt lgkmcnt(8)
    v_mfma_f32_16x16x32_bf16 v[112:115], a[208:211], a[248:251], v[112:115]
    ds_read_b64_tr_b16 a[204:205], v47 offset:12416
    buffer_load_dword v243, v241, s[92:95], s101 offen
    s_add_u32 s101, s101, s59
    v_mfma_f32_16x16x32_bf16 v[116:119], a[208:211], a[252:255], v[116:119]
    ds_read_b64_tr_b16 a[206:207], v47 offset:13952
    s_add_u32 m0, 0, s49
    v_mfma_f32_16x16x32_bf16 v[124:127], a[212:215], a[252:255], v[124:127]
    ds_read_b64_tr_b16 a[208:209], v44 offset:12544
    v_mfma_f32_16x16x32_bf16 v[120:123], a[212:215], a[248:251], v[120:123]
    ds_read_b64_tr_b16 a[210:211], v44 offset:14080
    buffer_load_dwordx4 v12, s[8:11], s50 offen offset:0 nt lds
    v_mfma_f32_16x16x32_bf16 v[128:131], a[216:219], a[248:251], v[128:131]
    ds_read_b64_tr_b16 a[212:213], v45 offset:12544
    v_mfma_f32_16x16x32_bf16 v[132:135], a[216:219], a[252:255], v[132:135]
    ds_read_b64_tr_b16 a[214:215], v45 offset:14080
    s_waitcnt lgkmcnt(8)
    v_mfma_f32_16x16x32_bf16 v[140:143], a[220:223], a[252:255], v[140:143]
    ds_read_b64_tr_b16 a[216:217], v46 offset:12544
    v_mfma_f32_16x16x32_bf16 v[136:139], a[220:223], a[248:251], v[136:139]
    ds_read_b64_tr_b16 a[218:219], v46 offset:14080
    v_mfma_f32_16x16x32_bf16 v[144:147], a[192:195], a[248:251], v[144:147]
    ds_read_b64_tr_b16 a[220:221], v47 offset:12544
    buffer_load_dwordx4 v13, s[8:11], s50 offen offset:1024 nt lds
    v_mfma_f32_16x16x32_bf16 v[148:151], a[192:195], a[252:255], v[148:151]
    ds_read_b64_tr_b16 a[222:223], v47 offset:14080
    v_mfma_f32_16x16x32_bf16 v[156:159], a[196:199], a[252:255], v[156:159]
    s_waitcnt vmcnt(9)
    s_barrier
    ds_read_b64_tr_b16 a[192:193], v248 offset:24576
    v_mfma_f32_16x16x32_bf16 v[152:155], a[196:199], a[248:251], v[152:155]
    ds_read_b64_tr_b16 a[194:195], v248 offset:26112
    ds_read_b128 v[96:99], v38 offset:0
    s_waitcnt lgkmcnt(9)
    v_mfma_f32_16x16x32_bf16 v[160:163], a[200:203], a[248:251], v[160:163]
    ds_read_b64_tr_b16 a[196:197], v248 offset:36864
    ds_read_b128 v[100:103], v38 offset:2048
    ds_read_b128 v[104:107], v39 offset:0
    ds_read_b128 v[108:111], v39 offset:2048
    v_mfma_f32_16x16x32_bf16 v[164:167], a[200:203], a[252:255], v[164:167]
    ds_read_b64_tr_b16 a[198:199], v248 offset:38400
    buffer_load_dwordx4 v14, s[8:11], s50 offen offset:2048 nt lds
    v_mfma_f32_16x16x32_bf16 v[172:175], a[204:207], a[252:255], v[172:175]
    v_mfma_f32_16x16x32_bf16 v[168:171], a[204:207], a[248:251], v[168:171]
    v_mfma_f32_16x16x32_bf16 v[176:179], a[208:211], a[248:251], v[176:179]
    v_mfma_f32_16x16x32_bf16 v[180:183], a[208:211], a[252:255], v[180:183]
    s_waitcnt lgkmcnt(8)
    v_mfma_f32_16x16x32_bf16 v[188:191], a[212:215], a[252:255], v[188:191]
    ds_read_b64_tr_b16 a[200:201], v249 offset:24576
    ds_read_b64_tr_b16 a[202:203], v249 offset:26112
    ds_read_b64_tr_b16 a[204:205], v249 offset:36864
    buffer_load_dwordx4 v15, s[8:11], s50 offen offset:3072 nt lds
    s_add_u32 m0, m0, 4096
    v_mfma_f32_16x16x32_bf16 v[184:187], a[212:215], a[248:251], v[184:187]
    ds_read_b64_tr_b16 a[206:207], v249 offset:38400
    ds_read_b64_tr_b16 a[208:209], v250 offset:24576
    ds_read_b64_tr_b16 a[210:211], v250 offset:26112
    v_mfma_f32_16x16x32_bf16 v[192:195], a[216:219], a[248:251], v[192:195]
    v_mfma_f32_16x16x32_bf16 v[196:199], a[216:219], a[252:255], v[196:199]
    v_mfma_f32_16x16x32_bf16 v[204:207], a[220:223], a[252:255], v[204:207]
    v_mfma_f32_16x16x32_bf16 v[200:203], a[220:223], a[248:251], v[200:203]
    s_waitcnt lgkmcnt(7)
    buffer_load_dwordx4 v16, s[8:11], s50 offen offset:0 nt lds
    v_mfma_f32_16x16x32_bf16 v[112:115], a[192:195], v[96:99], v[112:115]
    ds_read_b64_tr_b16 a[212:213], v250 offset:36864
    ds_read_b64_tr_b16 a[214:215], v250 offset:38400
    ds_read_b64_tr_b16 a[216:217], v251 offset:24576
    v_mfma_f32_16x16x32_bf16 v[116:119], a[192:195], v[100:103], v[116:119]
    ds_read_b64_tr_b16 a[218:219], v251 offset:26112
    ds_read_b64_tr_b16 a[220:221], v251 offset:36864
    ds_read_b64_tr_b16 a[222:223], v251 offset:38400
    s_waitcnt lgkmcnt(10)
    v_mfma_f32_16x16x32_bf16 v[116:119], a[196:199], v[108:111], v[116:119]
    ds_read_b64_tr_b16 a[192:193], v248 offset:24704
    v_mfma_f32_16x16x32_bf16 v[112:115], a[196:199], v[104:107], v[112:115]
    ds_read_b64_tr_b16 a[194:195], v248 offset:26240
    v_mfma_f32_16x16x32_bf16 v[120:123], a[200:203], v[96:99], v[120:123]
    ds_read_b64_tr_b16 a[196:197], v248 offset:36992
    buffer_load_dwordx4 v17, s[8:11], s50 offen offset:1024 nt lds
    s_add_u32 s50, s50, 24576
    v_mfma_f32_16x16x32_bf16 v[124:127], a[200:203], v[100:103], v[124:127]
    ds_read_b64_tr_b16 a[198:199], v248 offset:38528
    s_cmp_eq_u32 s50, s63
    s_cselect_b32 s52, 393216, 0
    s_waitcnt lgkmcnt(8)
    v_mfma_f32_16x16x32_bf16 v[124:127], a[204:207], v[108:111], v[124:127]
    ds_read_b64_tr_b16 a[200:201], v249 offset:24704
    s_sub_u32 s50, s50, s52
    v_mfma_f32_16x16x32_bf16 v[120:123], a[204:207], v[104:107], v[120:123]
    ds_read_b64_tr_b16 a[202:203], v249 offset:26240
    s_add_u32 m0, 98304, s49
    s_add_u32 s67, s54, 6297600
    v_mfma_f32_16x16x32_bf16 v[128:131], a[208:211], v[96:99], v[128:131]
    ds_read_b64_tr_b16 a[204:205], v249 offset:36992
    v_mfma_f32_16x16x32_bf16 v[132:135], a[208:211], v[100:103], v[132:135]
    ds_read_b64_tr_b16 a[206:207], v249 offset:38528
    buffer_load_dwordx4 v24, s[16:19], s67 offen offset:0 lds
    v_mfma_f32_16x16x32_bf16 v[132:135], a[212:215], v[108:111], v[132:135]
    ds_read_b64_tr_b16 a[208:209], v250 offset:24704
    v_mfma_f32_16x16x32_bf16 v[128:131], a[212:215], v[104:107], v[128:131]
    ds_read_b64_tr_b16 a[210:211], v250 offset:26240
    v_mul_f32 v112, s72, v112
    v_mul_f32 v113, s72, v113
    v_mul_f32 v114, s72, v114
    s_waitcnt lgkmcnt(8)
    v_mfma_f32_16x16x32_bf16 v[136:139], a[216:219], v[96:99], v[136:139]
    ds_read_b64_tr_b16 a[212:213], v250 offset:36992
    v_mul_f32 v115, s72, v115
    v_mfma_f32_16x16x32_bf16 v[140:143], a[216:219], v[100:103], v[140:143]
    ds_read_b64_tr_b16 a[214:215], v250 offset:38528
    v_mul_f32 v116, s72, v116
    v_mul_f32 v117, s72, v117
    v_mfma_f32_16x16x32_bf16 v[140:143], a[220:223], v[108:111], v[140:143]
    ds_read_b64_tr_b16 a[216:217], v251 offset:24704
    buffer_load_dwordx4 v25, s[16:19], s67 offen offset:1024 lds
    v_mfma_f32_16x16x32_bf16 v[136:139], a[220:223], v[104:107], v[136:139]
    ds_read_b64_tr_b16 a[218:219], v251 offset:26240
    v_mul_f32 v118, s72, v118
    v_mul_f32 v119, s72, v119
    v_mfma_f32_16x16x32_bf16 v[144:147], a[192:195], v[96:99], v[144:147]
    ds_read_b64_tr_b16 a[220:221], v251 offset:36992
    v_mul_f32 v120, s72, v120
    v_mul_f32 v121, s72, v121
    v_mfma_f32_16x16x32_bf16 v[148:151], a[192:195], v[100:103], v[148:151]
    ds_read_b64_tr_b16 a[222:223], v251 offset:38528
    v_mul_f32 v122, s72, v122
    v_mul_f32 v123, s72, v123
    s_waitcnt lgkmcnt(8)
    v_mfma_f32_16x16x32_bf16 v[148:151], a[196:199], v[108:111], v[148:151]
    ds_read_b64_tr_b16 a[192:193], v248 offset:24832
    v_mul_f32 v124, s72, v124
    v_mfma_f32_16x16x32_bf16 v[144:147], a[196:199], v[104:107], v[144:147]
    ds_read_b64_tr_b16 a[194:195], v248 offset:26368
    buffer_load_dwordx4 v26, s[16:19], s67 offen offset:2048 lds
    v_mfma_f32_16x16x32_bf16 v[152:155], a[200:203], v[96:99], v[152:155]
    ds_read_b64_tr_b16 a[196:197], v248 offset:37120
    v_mul_f32 v125, s72, v125
    v_mul_f32 v126, s72, v126
    v_mfma_f32_16x16x32_bf16 v[156:159], a[200:203], v[100:103], v[156:159]
    ds_read_b64_tr_b16 a[198:199], v248 offset:38656
    v_mul_f32 v127, s72, v127
    v_cvt_pk_bf16_f32 v208, v112, v113
    v_mfma_f32_16x16x32_bf16 v[156:159], a[204:207], v[108:111], v[156:159]
    ds_read_b64_tr_b16 a[200:201], v249 offset:24832
    v_cvt_pk_bf16_f32 v209, v114, v115
    v_cvt_pk_bf16_f32 v210, v120, v121
    v_mfma_f32_16x16x32_bf16 v[152:155], a[204:207], v[104:107], v[152:155]
    ds_read_b64_tr_b16 a[202:203], v249 offset:26368
    v_cvt_pk_bf16_f32 v211, v122, v123
    v_cvt_pk_bf16_f32 v212, v116, v117
    s_waitcnt lgkmcnt(8)
    v_mfma_f32_16x16x32_bf16 v[160:163], a[208:211], v[96:99], v[160:163]
    ds_read_b64_tr_b16 a[204:205], v249 offset:37120
    buffer_load_dwordx4 v27, s[16:19], s67 offen offset:3072 lds
    s_add_u32 m0, m0, 4096
    v_mfma_f32_16x16x32_bf16 v[164:167], a[208:211], v[100:103], v[164:167]
    ds_read_b64_tr_b16 a[206:207], v249 offset:38656
    v_mfma_f32_16x16x32_bf16 v[164:167], a[212:215], v[108:111], v[164:167]
    ds_read_b64_tr_b16 a[208:209], v250 offset:24832
    v_cvt_pk_bf16_f32 v213, v118, v119
    v_cvt_pk_bf16_f32 v214, v124, v125
    v_mfma_f32_16x16x32_bf16 v[160:163], a[212:215], v[104:107], v[160:163]
    ds_read_b64_tr_b16 a[210:211], v250 offset:26368
    v_cvt_pk_bf16_f32 v215, v126, v127
    v_permlane32_swap_b32 v208, v210
    v_mfma_f32_16x16x32_bf16 v[168:171], a[216:219], v[96:99], v[168:171]
    ds_read_b64_tr_b16 a[212:213], v250 offset:37120
    v_permlane32_swap_b32 v209, v211
    v_permlane32_swap_b32 v212, v214
    v_mfma_f32_16x16x32_bf16 v[172:175], a[216:219], v[100:103], v[172:175]
    ds_read_b64_tr_b16 a[214:215], v250 offset:38656
    buffer_load_dwordx4 v28, s[16:19], s67 offen offset:0 lds
    s_waitcnt lgkmcnt(8)
    v_mfma_f32_16x16x32_bf16 v[172:175], a[220:223], v[108:111], v[172:175]
    ds_read_b64_tr_b16 a[216:217], v251 offset:24832
    v_permlane32_swap_b32 v213, v215
    v_mfma_f32_16x16x32_bf16 v[168:171], a[220:223], v[104:107], v[168:171]
    ds_read_b64_tr_b16 a[218:219], v251 offset:26368
    v_permlane16_swap_b32 v208, v210
    v_permlane16_swap_b32 v209, v211
    v_mfma_f32_16x16x32_bf16 v[176:179], a[192:195], v[96:99], v[176:179]
    ds_read_b64_tr_b16 a[220:221], v251 offset:37120
    v_permlane16_swap_b32 v212, v214
    v_permlane16_swap_b32 v213, v215
    v_mfma_f32_16x16x32_bf16 v[180:183], a[192:195], v[100:103], v[180:183]
    ds_read_b64_tr_b16 a[222:223], v251 offset:38656
    v_accvgpr_write_b32 a0, v208
    v_accvgpr_write_b32 a1, v209
    v_mfma_f32_16x16x32_bf16 v[180:183], a[196:199], v[108:111], v[180:183]
    s_waitcnt vmcnt(12)
    s_barrier
    ds_read_b64_tr_b16 a[192:193], v44 offset:24576
    buffer_load_dwordx4 v29, s[16:19], s67 offen offset:1024 lds
    v_mfma_f32_16x16x32_bf16 v[176:179], a[196:199], v[104:107], v[176:179]
    ds_read_b64_tr_b16 a[194:195], v44 offset:26112
    s_waitcnt lgkmcnt(8)
    v_mfma_f32_16x16x32_bf16 v[184:187], a[200:203], v[96:99], v[184:187]
    ds_read_b64_tr_b16 a[196:197], v45 offset:24576
    v_accvgpr_write_b32 a2, v210
    v_mfma_f32_16x16x32_bf16 v[188:191], a[200:203], v[100:103], v[188:191]
    ds_read_b64_tr_b16 a[198:199], v45 offset:26112
    s_add_u32 m0, 49152, s49
    v_accvgpr_write_b32 a3, v211
    v_mfma_f32_16x16x32_bf16 v[188:191], a[204:207], v[108:111], v[188:191]
    ds_read_b64_tr_b16 a[200:201], v46 offset:24576
    v_accvgpr_write_b32 a4, v212
    v_accvgpr_write_b32 a5, v213
    v_mfma_f32_16x16x32_bf16 v[184:187], a[204:207], v[104:107], v[184:187]
    ds_read_b64_tr_b16 a[202:203], v46 offset:26112
    buffer_load_dwordx4 v12, s[8:11], s50 offen offset:0 nt lds
    v_mfma_f32_16x16x32_bf16 v[192:195], a[208:211], v[96:99], v[192:195]
    ds_read_b64_tr_b16 a[204:205], v47 offset:24576
    v_accvgpr_write_b32 a6, v214
    v_accvgpr_write_b32 a7, v215
    v_mfma_f32_16x16x32_bf16 v[196:199], a[208:211], v[100:103], v[196:199]
    ds_read_b64_tr_b16 a[206:207], v47 offset:26112
    v_mul_f32 v128, s72, v128
    v_mul_f32 v129, s72, v129
    s_waitcnt lgkmcnt(8)
    v_mfma_f32_16x16x32_bf16 v[196:199], a[212:215], v[108:111], v[196:199]
    ds_read_b64_tr_b16 a[208:209], v44 offset:24704
    v_mul_f32 v130, s72, v130
    v_mfma_f32_16x16x32_bf16 v[192:195], a[212:215], v[104:107], v[192:195]
    ds_read_b64_tr_b16 a[210:211], v44 offset:26240
    v_mul_f32 v131, s72, v131
    v_mul_f32 v132, s72, v132
    v_mfma_f32_16x16x32_bf16 v[200:203], a[216:219], v[96:99], v[200:203]
    ds_read_b64_tr_b16 a[212:213], v45 offset:24704
    buffer_load_dwordx4 v13, s[8:11], s50 offen offset:1024 nt lds
    v_mfma_f32_16x16x32_bf16 v[204:207], a[216:219], v[100:103], v[204:207]
    ds_read_b64_tr_b16 a[214:215], v45 offset:26240
    v_mul_f32 v133, s72, v133
    v_mul_f32 v134, s72, v134
    v_mfma_f32_16x16x32_bf16 v[204:207], a[220:223], v[108:111], v[204:207]
    ds_read_b64_tr_b16 a[216:217], v46 offset:24704
    v_mul_f32 v135, s72, v135
    v_mul_f32 v136, s72, v136
    v_mfma_f32_16x16x32_bf16 v[200:203], a[220:223], v[104:107], v[200:203]
    ds_read_b64_tr_b16 a[218:219], v46 offset:26240
    v_mul_f32 v137, s72, v137
    v_mul_f32 v138, s72, v138
    s_waitcnt lgkmcnt(8)
    v_mfma_f32_16x16x32_bf16 a[96:99], a[192:195], v[96:99], a[96:99]
    ds_read_b64_tr_b16 a[220:221], v47 offset:24704
    v_mul_f32 v139, s72, v139
    v_mfma_f32_16x16x32_bf16 a[100:103], a[192:195], v[100:103], a[100:103]
    ds_read_b64_tr_b16 a[222:223], v47 offset:26240
    buffer_load_dwordx4 v14, s[8:11], s50 offen offset:2048 nt lds
    v_mfma_f32_16x16x32_bf16 a[108:111], a[196:199], v[100:103], a[108:111]
    ds_read_b64_tr_b16 a[192:193], v44 offset:24832
    v_mul_f32 v140, s72, v140
    v_mul_f32 v141, s72, v141
    v_mfma_f32_16x16x32_bf16 a[104:107], a[196:199], v[96:99], a[104:107]
    ds_read_b64_tr_b16 a[194:195], v44 offset:26368
    v_mul_f32 v142, s72, v142
    v_mul_f32 v143, s72, v143
    v_mfma_f32_16x16x32_bf16 a[112:115], a[200:203], v[96:99], a[112:115]
    ds_read_b64_tr_b16 a[196:197], v45 offset:24832
    v_cvt_pk_bf16_f32 v216, v128, v129
    v_cvt_pk_bf16_f32 v217, v130, v131
    v_mfma_f32_16x16x32_bf16 a[116:119], a[200:203], v[100:103], a[116:119]
    ds_read_b64_tr_b16 a[198:199], v45 offset:26368
    v_cvt_pk_bf16_f32 v218, v136, v137
    v_cvt_pk_bf16_f32 v219, v138, v139
    s_waitcnt lgkmcnt(8)
    v_mfma_f32_16x16x32_bf16 a[124:127], a[204:207], v[100:103], a[124:127]
    ds_read_b64_tr_b16 a[200:201], v46 offset:24832
    buffer_load_dwordx4 v15, s[8:11], s50 offen offset:3072 nt lds
    s_add_u32 m0, m0, 4096
    v_mfma_f32_16x16x32_bf16 a[120:123], a[204:207], v[96:99], a[120:123]
    ds_read_b64_tr_b16 a[202:203], v46 offset:26368
    v_mfma_f32_16x16x32_bf16 a[128:131], a[208:211], v[96:99], a[128:131]
    ds_read_b64_tr_b16 a[204:205], v47 offset:24832
    v_cvt_pk_bf16_f32 v220, v132, v133
    v_cvt_pk_bf16_f32 v221, v134, v135
    v_mfma_f32_16x16x32_bf16 a[132:135], a[208:211], v[100:103], a[132:135]
    ds_read_b64_tr_b16 a[206:207], v47 offset:26368
    v_cvt_pk_bf16_f32 v222, v140, v141
    v_cvt_pk_bf16_f32 v223, v142, v143
    v_mfma_f32_16x16x32_bf16 a[140:143], a[212:215], v[100:103], a[140:143]
    ds_read_b64_tr_b16 a[208:209], v44 offset:36864
    v_permlane32_swap_b32 v216, v218
    v_permlane32_swap_b32 v217, v219
    v_mfma_f32_16x16x32_bf16 a[136:139], a[212:215], v[96:99], a[136:139]
    ds_read_b64_tr_b16 a[210:211], v44 offset:38400
    buffer_load_dwordx4 v16, s[8:11], s50 offen offset:0 nt lds
    s_waitcnt lgkmcnt(8)
    v_mfma_f32_16x16x32_bf16 a[144:147], a[216:219], v[96:99], a[144:147]
    ds_read_b64_tr_b16 a[212:213], v45 offset:36864
    v_permlane32_swap_b32 v220, v222
    v_mfma_f32_16x16x32_bf16 a[148:151], a[216:219], v[100:103], a[148:151]
    ds_read_b64_tr_b16 a[214:215], v45 offset:38400
    v_permlane32_swap_b32 v221, v223
    v_permlane16_swap_b32 v216, v218
    v_mfma_f32_16x16x32_bf16 a[156:159], a[220:223], v[100:103], a[156:159]
    ds_read_b64_tr_b16 a[216:217], v46 offset:36864
    v_permlane16_swap_b32 v217, v219
    v_permlane16_swap_b32 v220, v222
    v_mfma_f32_16x16x32_bf16 a[152:155], a[220:223], v[96:99], a[152:155]
    ds_read_b64_tr_b16 a[218:219], v46 offset:38400
    v_permlane16_swap_b32 v221, v223
    v_accvgpr_write_b32 a8, v216
    v_mfma_f32_16x16x32_bf16 a[160:163], a[192:195], v[96:99], a[160:163]
    ds_read_b64_tr_b16 a[220:221], v47 offset:36864
    buffer_load_dwordx4 v17, s[8:11], s50 offen offset:1024 nt lds
    v_mfma_f32_16x16x32_bf16 a[164:167], a[192:195], v[100:103], a[164:167]
    ds_read_b64_tr_b16 a[222:223], v47 offset:38400
    s_add_u32 s50, s50, 24576
    s_cmp_eq_u32 s50, s63
    s_cselect_b32 s52, 393216, 0
    s_waitcnt lgkmcnt(8)
    v_mfma_f32_16x16x32_bf16 a[172:175], a[196:199], v[100:103], a[172:175]
    ds_read_b64_tr_b16 a[192:193], v44 offset:36992
    v_mfma_f32_16x16x32_bf16 a[168:171], a[196:199], v[96:99], a[168:171]
    ds_read_b64_tr_b16 a[194:195], v44 offset:38528
    s_sub_u32 s50, s50, s52
    v_accvgpr_write_b32 a9, v217
    v_mfma_f32_16x16x32_bf16 a[176:179], a[200:203], v[96:99], a[176:179]
    ds_read_b64_tr_b16 a[196:197], v45 offset:36992
    v_accvgpr_write_b32 a10, v218
    v_accvgpr_write_b32 a11, v219
    v_mfma_f32_16x16x32_bf16 a[180:183], a[200:203], v[100:103], a[180:183]
    ds_read_b64_tr_b16 a[198:199], v45 offset:38528
    v_accvgpr_write_b32 a12, v220
    v_accvgpr_write_b32 a13, v221
    v_mfma_f32_16x16x32_bf16 a[188:191], a[204:207], v[100:103], a[188:191]
    ds_read_b64_tr_b16 a[200:201], v46 offset:36992
    v_accvgpr_write_b32 a14, v222
    v_accvgpr_write_b32 a15, v223
    v_mfma_f32_16x16x32_bf16 a[184:187], a[204:207], v[96:99], a[184:187]
    ds_read_b64_tr_b16 a[202:203], v46 offset:38528
    v_mul_f32 v144, s72, v144
    v_mul_f32 v145, s72, v145
    s_waitcnt lgkmcnt(8)
    v_mfma_f32_16x16x32_bf16 a[96:99], a[208:211], v[104:107], a[96:99]
    ds_read_b64_tr_b16 a[204:205], v47 offset:36992
    v_mul_f32 v146, s72, v146
    v_mfma_f32_16x16x32_bf16 a[100:103], a[208:211], v[108:111], a[100:103]
    ds_read_b64_tr_b16 a[206:207], v47 offset:38528
    v_mul_f32 v147, s72, v147
    v_mul_f32 v148, s72, v148
    v_mfma_f32_16x16x32_bf16 a[108:111], a[212:215], v[108:111], a[108:111]
    ds_read_b64_tr_b16 a[208:209], v44 offset:37120
    v_mul_f32 v149, s72, v149
    v_mul_f32 v150, s72, v150
    v_mfma_f32_16x16x32_bf16 a[104:107], a[212:215], v[104:107], a[104:107]
    ds_read_b64_tr_b16 a[210:211], v44 offset:38656
    v_mul_f32 v151, s72, v151
    v_mul_f32 v152, s72, v152
    v_mfma_f32_16x16x32_bf16 a[112:115], a[216:219], v[104:107], a[112:115]
    ds_read_b64_tr_b16 a[212:213], v45 offset:37120
    v_mul_f32 v153, s72, v153
    v_mul_f32 v154, s72, v154
    v_mfma_f32_16x16x32_bf16 a[116:119], a[216:219], v[108:111], a[116:119]
    ds_read_b64_tr_b16 a[214:215], v45 offset:38656
    v_mul_f32 v155, s72, v155
    v_mul_f32 v156, s72, v156
    s_waitcnt lgkmcnt(8)
    v_mfma_f32_16x16x32_bf16 a[124:127], a[220:223], v[108:111], a[124:127]
    ds_read_b64_tr_b16 a[216:217], v46 offset:37120
    v_mul_f32 v157, s72, v157
    v_mfma_f32_16x16x32_bf16 a[120:123], a[220:223], v[104:107], a[120:123]
    ds_read_b64_tr_b16 a[218:219], v46 offset:38656
    v_mul_f32 v158, s72, v158
    v_mul_f32 v159, s72, v159
    v_mfma_f32_16x16x32_bf16 a[128:131], a[192:195], v[104:107], a[128:131]
    ds_read_b64_tr_b16 a[220:221], v47 offset:37120
    v_cvt_pk_bf16_f32 v224, v144, v145
    v_cvt_pk_bf16_f32 v225, v146, v147
    v_mfma_f32_16x16x32_bf16 a[132:135], a[192:195], v[108:111], a[132:135]
    ds_read_b64_tr_b16 a[222:223], v47 offset:38656
    v_cvt_pk_bf16_f32 v226, v152, v153
    v_cvt_pk_bf16_f32 v227, v154, v155
    v_mfma_f32_16x16x32_bf16 a[140:143], a[196:199], v[108:111], a[140:143]
    s_waitcnt vmcnt(6)
    s_barrier
    ds_read_b64_tr_b16 a[192:193], v248 offset:0
    v_mfma_f32_16x16x32_bf16 a[136:139], a[196:199], v[104:107], a[136:139]
    ds_read_b64_tr_b16 a[194:195], v248 offset:1536
    v_cvt_pk_bf16_f32 v228, v148, v149
    v_cvt_pk_bf16_f32 v229, v150, v151
    s_waitcnt lgkmcnt(8)
    v_mfma_f32_16x16x32_bf16 a[144:147], a[200:203], v[104:107], a[144:147]
    ds_read_b64_tr_b16 a[196:197], v249 offset:0
    v_cvt_pk_bf16_f32 v230, v156, v157
    v_mfma_f32_16x16x32_bf16 a[148:151], a[200:203], v[108:111], a[148:151]
    ds_read_b64_tr_b16 a[198:199], v249 offset:1536
    s_add_u32 m0, 122880, s49
    s_add_u32 s67, s54, 5511168
    buffer_load_dwordx4 v24, s[16:19], s67 offen offset:0 lds
    v_mfma_f32_16x16x32_bf16 a[156:159], a[204:207], v[108:111], a[156:159]
    ds_read_b64_tr_b16 a[200:201], v250 offset:0
    v_mfma_f32_16x16x32_bf16 a[152:155], a[204:207], v[104:107], a[152:155]
    ds_read_b64_tr_b16 a[202:203], v250 offset:1536
    v_cvt_pk_bf16_f32 v231, v158, v159
    v_permlane32_swap_b32 v224, v226
    v_mfma_f32_16x16x32_bf16 a[160:163], a[208:211], v[104:107], a[160:163]
    ds_read_b64_tr_b16 a[204:205], v251 offset:0
    v_permlane32_swap_b32 v225, v227
    v_permlane32_swap_b32 v228, v230
    v_mfma_f32_16x16x32_bf16 a[164:167], a[208:211], v[108:111], a[164:167]
    ds_read_b64_tr_b16 a[206:207], v251 offset:1536
    v_permlane32_swap_b32 v229, v231
    v_permlane16_swap_b32 v224, v226
    s_waitcnt lgkmcnt(8)
    v_mfma_f32_16x16x32_bf16 a[172:175], a[212:215], v[108:111], a[172:175]
    ds_read_b64_tr_b16 a[208:209], v248 offset:128
    buffer_load_dwordx4 v25, s[16:19], s67 offen offset:1024 lds
    v_mfma_f32_16x16x32_bf16 a[168:171], a[212:215], v[104:107], a[168:171]
    ds_read_b64_tr_b16 a[210:211], v248 offset:1664
    v_permlane16_swap_b32 v225, v227
    v_mfma_f32_16x16x32_bf16 a[176:179], a[216:219], v[104:107], a[176:179]
    ds_read_b64_tr_b16 a[212:213], v249 offset:128
    v_permlane16_swap_b32 v228, v230
    v_permlane16_swap_b32 v229, v231
    v_mfma_f32_16x16x32_bf16 a[180:183], a[216:219], v[108:111], a[180:183]
    ds_read_b64_tr_b16 a[214:215], v249 offset:1664
    v_accvgpr_write_b32 a16, v224
    v_accvgpr_write_b32 a17, v225
    v_mfma_f32_16x16x32_bf16 a[188:191], a[220:223], v[108:111], a[188:191]
    ds_read_b64_tr_b16 a[216:217], v250 offset:128
    v_accvgpr_write_b32 a18, v226
    v_accvgpr_write_b32 a19, v227
    v_mfma_f32_16x16x32_bf16 a[184:187], a[220:223], v[104:107], a[184:187]
    ds_read_b64_tr_b16 a[218:219], v250 offset:1664
    buffer_load_dwordx4 v26, s[16:19], s67 offen offset:2048 lds
    s_waitcnt lgkmcnt(8)
    v_mfma_f32_16x16x32_bf16 a[96:99], a[192:195], a[240:243], a[96:99]
    ds_read_b64_tr_b16 a[220:221], v251 offset:128
    v_accvgpr_write_b32 a20, v228
    v_mfma_f32_16x16x32_bf16 a[100:103], a[192:195], a[244:247], a[100:103]
    ds_read_b64_tr_b16 a[222:223], v251 offset:1664
    v_accvgpr_write_b32 a21, v229
    v_accvgpr_write_b32 a22, v230
    v_mfma_f32_16x16x32_bf16 a[108:111], a[196:199], a[244:247], a[108:111]
    ds_read_b64_tr_b16 a[192:193], v248 offset:256
    v_accvgpr_write_b32 a23, v231
    v_mul_f32 v160, s72, v160
    v_mfma_f32_16x16x32_bf16 a[104:107], a[196:199], a[240:243], a[104:107]
    ds_read_b64_tr_b16 a[194:195], v248 offset:1792
    v_mul_f32 v161, s72, v161
    v_mul_f32 v162, s72, v162
    v_mfma_f32_16x16x32_bf16 a[112:115], a[200:203], a[240:243], a[112:115]
    ds_read_b64_tr_b16 a[196:197], v249 offset:256
    buffer_load_dwordx4 v27, s[16:19], s67 offen offset:3072 lds
    s_add_u32 m0, m0, 4096
    v_mfma_f32_16x16x32_bf16 a[116:119], a[200:203], a[244:247], a[116:119]
    ds_read_b64_tr_b16 a[198:199], v249 offset:1792
    v_mul_f32 v163, s72, v163
    s_waitcnt lgkmcnt(8)
    v_mfma_f32_16x16x32_bf16 a[124:127], a[204:207], a[244:247], a[124:127]
    ds_read_b64_tr_b16 a[200:201], v250 offset:256
    v_mul_f32 v164, s72, v164
    v_mfma_f32_16x16x32_bf16 a[120:123], a[204:207], a[240:243], a[120:123]
    ds_read_b64_tr_b16 a[202:203], v250 offset:1792
    v_mul_f32 v165, s72, v165
    v_mul_f32 v166, s72, v166
    v_mfma_f32_16x16x32_bf16 a[128:131], a[208:211], a[240:243], a[128:131]
    ds_read_b64_tr_b16 a[204:205], v251 offset:256
    v_mul_f32 v167, s72, v167
    v_mul_f32 v168, s72, v168
    v_mfma_f32_16x16x32_bf16 a[132:135], a[208:211], a[244:247], a[132:135]
    ds_read_b64_tr_b16 a[206:207], v251 offset:1792
    buffer_load_dwordx4 v28, s[16:19], s67 offen offset:0 lds
    v_mfma_f32_16x16x32_bf16 a[140:143], a[212:215], a[244:247], a[140:143]
    ds_read_b64_tr_b16 a[208:209], v248 offset:12288
    v_mul_f32 v169, s72, v169
    v_mul_f32 v170, s72, v170
    v_mfma_f32_16x16x32_bf16 a[136:139], a[212:215], a[240:243], a[136:139]
    ds_read_b64_tr_b16 a[210:211], v248 offset:13824
    v_mul_f32 v171, s72, v171
    v_mul_f32 v172, s72, v172
    s_waitcnt lgkmcnt(8)
    v_mfma_f32_16x16x32_bf16 a[144:147], a[216:219], a[240:243], a[144:147]
    ds_read_b64_tr_b16 a[212:213], v249 offset:12288
    v_mul_f32 v173, s72, v173
    v_mfma_f32_16x16x32_bf16 a[148:151], a[216:219], a[244:247], a[148:151]
    ds_read_b64_tr_b16 a[214:215], v249 offset:13824
    v_mul_f32 v174, s72, v174
    v_mul_f32 v175, s72, v175
    v_mfma_f32_16x16x32_bf16 a[156:159], a[220:223], a[244:247], a[156:159]
    ds_read_b64_tr_b16 a[216:217], v250 offset:12288
    buffer_load_dwordx4 v29, s[16:19], s67 offen offset:1024 lds
    s_add_u32 m0, s57, s49
    v_mfma_f32_16x16x32_bf16 a[152:155], a[220:223], a[240:243], a[152:155]
    ds_read_b64_tr_b16 a[218:219], v250 offset:13824
    v_cvt_pk_bf16_f32 v232, v160, v161
    v_mfma_f32_16x16x32_bf16 a[160:163], a[192:195], a[240:243], a[160:163]
    ds_read_b64_tr_b16 a[220:221], v251 offset:12288
    v_cvt_pk_bf16_f32 v233, v162, v163
    v_cvt_pk_bf16_f32 v234, v168, v169
    v_mfma_f32_16x16x32_bf16 a[164:167], a[192:195], a[244:247], a[164:167]
    ds_read_b64_tr_b16 a[222:223], v251 offset:13824
    v_cvt_pk_bf16_f32 v235, v170, v171
    v_cvt_pk_bf16_f32 v236, v164, v165
    s_waitcnt lgkmcnt(8)
    v_mfma_f32_16x16x32_bf16 a[172:175], a[196:199], a[244:247], a[172:175]
    ds_read_b64_tr_b16 a[192:193], v248 offset:12416
    v_cvt_pk_bf16_f32 v237, v166, v167
    v_mfma_f32_16x16x32_bf16 a[168:171], a[196:199], a[240:243], a[168:171]
    ds_read_b64_tr_b16 a[194:195], v248 offset:13952
    buffer_load_dwordx4 v18, s[12:15], s77 offen offset:0 nt lds
    v_mfma_f32_16x16x32_bf16 a[176:179], a[200:203], a[240:243], a[176:179]
    ds_read_b64_tr_b16 a[196:197], v249 offset:12416
    v_cvt_pk_bf16_f32 v238, v172, v173
    v_cvt_pk_bf16_f32 v239, v174, v175
    v_mfma_f32_16x16x32_bf16 a[180:183], a[200:203], a[244:247], a[180:183]
    ds_read_b64_tr_b16 a[198:199], v249 offset:13952
    v_permlane32_swap_b32 v232, v234
    v_permlane32_swap_b32 v233, v235
    v_mfma_f32_16x16x32_bf16 a[188:191], a[204:207], a[244:247], a[188:191]
    ds_read_b64_tr_b16 a[200:201], v250 offset:12416
    v_permlane32_swap_b32 v236, v238
    v_permlane32_swap_b32 v237, v239
    v_mfma_f32_16x16x32_bf16 a[184:187], a[204:207], a[240:243], a[184:187]
    ds_read_b64_tr_b16 a[202:203], v250 offset:13952
    v_permlane16_swap_b32 v232, v234
    v_permlane16_swap_b32 v233, v235
    s_waitcnt lgkmcnt(8)
    v_mfma_f32_16x16x32_bf16 a[96:99], a[208:211], a[248:251], a[96:99]
    ds_read_b64_tr_b16 a[204:205], v251 offset:12416
    buffer_load_dwordx4 v19, s[12:15], s77 offen offset:1024 nt lds
    v_mfma_f32_16x16x32_bf16 a[100:103], a[208:211], a[252:255], a[100:103]
    ds_read_b64_tr_b16 a[206:207], v251 offset:13952
    v_permlane16_swap_b32 v236, v238
    v_mfma_f32_16x16x32_bf16 a[108:111], a[212:215], a[252:255], a[108:111]
    ds_read_b64_tr_b16 a[208:209], v248 offset:12544
    v_permlane16_swap_b32 v237, v239
    v_accvgpr_write_b32 a24, v232
    v_mfma_f32_16x16x32_bf16 a[104:107], a[212:215], a[248:251], a[104:107]
    ds_read_b64_tr_b16 a[210:211], v248 offset:14080
    v_accvgpr_write_b32 a25, v233
    v_accvgpr_write_b32 a26, v234
    v_mfma_f32_16x16x32_bf16 a[112:115], a[216:219], a[248:251], a[112:115]
    ds_read_b64_tr_b16 a[212:213], v249 offset:12544
    v_accvgpr_write_b32 a27, v235
    v_accvgpr_write_b32 a28, v236
    v_mfma_f32_16x16x32_bf16 a[116:119], a[216:219], a[252:255], a[116:119]
    ds_read_b64_tr_b16 a[214:215], v249 offset:14080
    buffer_load_dwordx4 v20, s[12:15], s77 offen offset:2048 nt lds
    s_waitcnt lgkmcnt(8)
    v_mfma_f32_16x16x32_bf16 a[124:127], a[220:223], a[252:255], a[124:127]
    ds_read_b64_tr_b16 a[216:217], v250 offset:12544
    v_accvgpr_write_b32 a29, v237
    v_mfma_f32_16x16x32_bf16 a[120:123], a[220:223], a[248:251], a[120:123]
    ds_read_b64_tr_b16 a[218:219], v250 offset:14080
    v_accvgpr_write_b32 a30, v238
    v_accvgpr_write_b32 a31, v239
    v_mfma_f32_16x16x32_bf16 a[128:131], a[192:195], a[248:251], a[128:131]
    ds_read_b64_tr_b16 a[220:221], v251 offset:12544
    v_mul_f32 v176, s72, v176
    v_mul_f32 v177, s72, v177
    v_mfma_f32_16x16x32_bf16 a[132:135], a[192:195], a[252:255], a[132:135]
    ds_read_b64_tr_b16 a[222:223], v251 offset:14080
    v_mul_f32 v178, s72, v178
    v_mul_f32 v179, s72, v179
    v_mfma_f32_16x16x32_bf16 a[140:143], a[196:199], a[252:255], a[140:143]
    s_waitcnt vmcnt(21)
    s_barrier
    ds_read_b128 a[192:195], v36 offset:0
    buffer_load_dwordx4 v21, s[12:15], s77 offen offset:3072 nt lds
    s_add_u32 m0, m0, 4096
    v_mfma_f32_16x16x32_bf16 a[136:139], a[196:199], a[248:251], a[136:139]
    s_waitcnt lgkmcnt(7)
    v_mfma_f32_16x16x32_bf16 a[144:147], a[200:203], a[248:251], a[144:147]
    ds_read_b128 a[196:199], v36 offset:6144
    v_mul_f32 v180, s72, v180
    v_mfma_f32_16x16x32_bf16 a[148:151], a[200:203], a[252:255], a[148:151]
    v_mul_f32 v181, s72, v181
    v_mul_f32 v182, s72, v182
    v_mul_f32 v183, s72, v183
    v_mfma_f32_16x16x32_bf16 a[156:159], a[204:207], a[252:255], a[156:159]
    ds_read_b128 a[200:203], v36 offset:12288
    v_mul_f32 v184, s72, v184
    v_mul_f32 v185, s72, v185
    v_mfma_f32_16x16x32_bf16 a[152:155], a[204:207], a[248:251], a[152:155]
    buffer_load_dwordx4 v22, s[12:15], s77 offen offset:0 nt lds
    v_mul_f32 v186, s72, v186
    v_mfma_f32_16x16x32_bf16 a[160:163], a[208:211], a[248:251], a[160:163]
    ds_read_b128 a[204:207], v36 offset:18432
    v_mul_f32 v187, s72, v187
    v_mul_f32 v188, s72, v188
    v_mfma_f32_16x16x32_bf16 a[164:167], a[208:211], a[252:255], a[164:167]
    v_mul_f32 v189, s72, v189
    v_mul_f32 v190, s72, v190
    v_mul_f32 v191, s72, v191
    s_waitcnt lgkmcnt(4)
    v_mfma_f32_16x16x32_bf16 a[172:175], a[212:215], a[252:255], a[172:175]
    ds_read_b128 a[208:211], v37 offset:0
    v_cvt_pk_bf16_f32 v208, v176, v177
    v_mfma_f32_16x16x32_bf16 a[168:171], a[212:215], a[248:251], a[168:171]
    v_cvt_pk_bf16_f32 v209, v178, v179
    v_cvt_pk_bf16_f32 v210, v184, v185
    v_cvt_pk_bf16_f32 v211, v186, v187
    v_mfma_f32_16x16x32_bf16 a[176:179], a[216:219], a[248:251], a[176:179]
    ds_read_b128 a[212:215], v37 offset:6144
    buffer_load_dwordx4 v23, s[12:15], s77 offen offset:1024 nt lds
    v_mfma_f32_16x16x32_bf16 a[180:183], a[216:219], a[252:255], a[180:183]
    s_xor_b32 s57, s57, 81920
    s_add_u32 s77, s77, 24576
    s_cmp_eq_u32 s77, s63
    s_cselect_b32 s52, 393216, 0
    v_mfma_f32_16x16x32_bf16 a[188:191], a[220:223], a[252:255], a[188:191]
    ds_read_b128 a[216:219], v37 offset:12288
    s_sub_u32 s77, s77, s52
    s_add_u32 m0, s57, s49
    v_mfma_f32_16x16x32_bf16 a[184:187], a[220:223], a[248:251], a[184:187]
    v_cvt_pk_bf16_f32 v212, v180, v181
    v_cvt_pk_bf16_f32 v213, v182, v183
    s_waitcnt lgkmcnt(5)
    v_mfma_f32_16x16x32_bf16 v[64:67], a[192:195], a[0:3], 0
    ds_read_b128 a[220:223], v37 offset:18432
    v_cvt_pk_bf16_f32 v214, v188, v189
    v_mfma_f32_16x16x32_bf16 v[68:71], a[192:195], a[4:7], 0
    buffer_load_dwordx4 v18, s[12:15], s77 offen offset:0 nt lds
    v_cvt_pk_bf16_f32 v215, v190, v191
    v_mfma_f32_16x16x32_bf16 v[76:79], a[196:199], a[4:7], 0
    ds_read_b128 a[192:195], v36 offset:128
    v_permlane32_swap_b32 v208, v210
    v_permlane32_swap_b32 v209, v211
    v_mfma_f32_16x16x32_bf16 v[72:75], a[196:199], a[0:3], 0
    v_permlane32_swap_b32 v212, v214
    v_permlane32_swap_b32 v213, v215
    v_permlane16_swap_b32 v208, v210
    s_waitcnt lgkmcnt(5)
    v_mfma_f32_16x16x32_bf16 v[80:83], a[200:203], a[0:3], 0
    ds_read_b128 a[196:199], v36 offset:6272
    v_permlane16_swap_b32 v209, v211
    v_mfma_f32_16x16x32_bf16 v[84:87], a[200:203], a[4:7], 0
    v_permlane16_swap_b32 v212, v214
    v_permlane16_swap_b32 v213, v215
    v_accvgpr_write_b32 a32, v208
    v_mfma_f32_16x16x32_bf16 v[92:95], a[204:207], a[4:7], 0
    ds_read_b128 a[200:203], v36 offset:12416
    buffer_load_dwordx4 v19, s[12:15], s77 offen offset:1024 nt lds
    v_mfma_f32_16x16x32_bf16 v[88:91], a[204:207], a[0:3], 0
    v_accvgpr_write_b32 a33, v209
    v_accvgpr_write_b32 a34, v210
    v_accvgpr_write_b32 a35, v211
    s_waitcnt lgkmcnt(5)
    v_mfma_f32_16x16x32_bf16 v[64:67], a[208:211], a[8:11], v[64:67]
    ds_read_b128 a[204:207], v36 offset:18560
    v_accvgpr_write_b32 a36, v212
    v_mfma_f32_16x16x32_bf16 v[68:71], a[208:211], a[12:15], v[68:71]
    v_accvgpr_write_b32 a37, v213
    v_accvgpr_write_b32 a38, v214
    v_accvgpr_write_b32 a39, v215
    v_mfma_f32_16x16x32_bf16 v[76:79], a[212:215], a[12:15], v[76:79]
    ds_read_b128 a[208:211], v37 offset:128
    v_mul_f32 v192, s72, v192
    v_mul_f32 v193, s72, v193
    v_mfma_f32_16x16x32_bf16 v[72:75], a[212:215], a[8:11], v[72:75]
    buffer_load_dwordx4 v20, s[12:15], s77 offen offset:2048 nt lds
    v_mul_f32 v194, s72, v194
    s_waitcnt lgkmcnt(5)
    v_mfma_f32_16x16x32_bf16 v[80:83], a[216:219], a[8:11], v[80:83]
    ds_read_b128 a[212:215], v37 offset:6272
    v_mul_f32 v195, s72, v195
    v_mfma_f32_16x16x32_bf16 v[84:87], a[216:219], a[12:15], v[84:87]
    v_mul_f32 v196, s72, v196
    v_mul_f32 v197, s72, v197
    v_mul_f32 v198, s72, v198
    v_mfma_f32_16x16x32_bf16 v[92:95], a[220:223], a[12:15], v[92:95]
    ds_read_b128 a[216:219], v37 offset:12416
    v_mul_f32 v199, s72, v199
    v_mul_f32 v200, s72, v200
    v_mfma_f32_16x16x32_bf16 v[88:91], a[220:223], a[8:11], v[88:91]
    v_mul_f32 v201, s72, v201
    v_mul_f32 v202, s72, v202
    v_mul_f32 v203, s72, v203
    s_waitcnt lgkmcnt(5)
    v_mfma_f32_16x16x32_bf16 v[64:67], a[192:195], a[16:19], v[64:67]
    ds_read_b128 a[220:223], v37 offset:18560
    buffer_load_dwordx4 v21, s[12:15], s77 offen offset:3072 nt lds
    s_add_u32 m0, m0, 4096
    v_mfma_f32_16x16x32_bf16 v[68:71], a[192:195], a[20:23], v[68:71]
    v_mul_f32 v204, s72, v204
    v_mfma_f32_16x16x32_bf16 v[76:79], a[196:199], a[20:23], v[76:79]
    ds_read_b128 a[192:195], v36 offset:256
    v_mul_f32 v205, s72, v205
    v_mul_f32 v206, s72, v206
    v_mfma_f32_16x16x32_bf16 v[72:75], a[196:199], a[16:19], v[72:75]
    v_mul_f32 v207, s72, v207
    v_cvt_pk_bf16_f32 v216, v192, v193
    v_cvt_pk_bf16_f32 v217, v194, v195
    s_waitcnt lgkmcnt(5)
    v_mfma_f32_16x16x32_bf16 v[80:83], a[200:203], a[16:19], v[80:83]
    ds_read_b128 a[196:199], v36 offset:6400
    v_cvt_pk_bf16_f32 v218, v200, v201
    v_mfma_f32_16x16x32_bf16 v[84:87], a[200:203], a[20:23], v[84:87]
    buffer_load_dwordx4 v22, s[12:15], s77 offen offset:0 nt lds
    v_cvt_pk_bf16_f32 v219, v202, v203
    v_mfma_f32_16x16x32_bf16 v[92:95], a[204:207], a[20:23], v[92:95]
    ds_read_b128 a[200:203], v36 offset:12544
    v_cvt_pk_bf16_f32 v220, v196, v197
    v_cvt_pk_bf16_f32 v221, v198, v199
    v_mfma_f32_16x16x32_bf16 v[88:91], a[204:207], a[16:19], v[88:91]
    v_cvt_pk_bf16_f32 v222, v204, v205
    v_cvt_pk_bf16_f32 v223, v206, v207
    v_permlane32_swap_b32 v216, v218
    s_waitcnt lgkmcnt(5)
    v_mfma_f32_16x16x32_bf16 v[64:67], a[208:211], a[24:27], v[64:67]
    ds_read_b128 a[204:207], v36 offset:18688
    v_permlane32_swap_b32 v217, v219
    v_mfma_f32_16x16x32_bf16 v[68:71], a[208:211], a[28:31], v[68:71]
    v_permlane32_swap_b32 v220, v222
    v_permlane32_swap_b32 v221, v223
    v_permlane16_swap_b32 v216, v218
    v_mfma_f32_16x16x32_bf16 v[76:79], a[212:215], a[28:31], v[76:79]
    ds_read_b128 a[208:211], v37 offset:256
    buffer_load_dwordx4 v23, s[12:15], s77 offen offset:1024 nt lds
    v_mfma_f32_16x16x32_bf16 v[72:75], a[212:215], a[24:27], v[72:75]
    s_xor_b32 s57, s57, 81920
    s_add_u32 s77, s77, 24576
    s_cmp_eq_u32 s77, s63
    s_cselect_b32 s52, 393216, 0
    s_waitcnt lgkmcnt(5)
    v_mfma_f32_16x16x32_bf16 v[80:83], a[216:219], a[24:27], v[80:83]
    ds_read_b128 a[212:215], v37 offset:6400
    v_mfma_f32_16x16x32_bf16 v[84:87], a[216:219], a[28:31], v[84:87]
    s_sub_u32 s77, s77, s52
    v_permlane16_swap_b32 v217, v219
    v_permlane16_swap_b32 v220, v222
    v_mfma_f32_16x16x32_bf16 v[92:95], a[220:223], a[28:31], v[92:95]
    ds_read_b128 a[216:219], v37 offset:12544
    v_permlane16_swap_b32 v221, v223
    v_accvgpr_write_b32 a40, v216
    v_mfma_f32_16x16x32_bf16 v[88:91], a[220:223], a[24:27], v[88:91]
    v_accvgpr_write_b32 a41, v217
    v_accvgpr_write_b32 a42, v218
    v_accvgpr_write_b32 a43, v219
    s_waitcnt lgkmcnt(5)
    v_mfma_f32_16x16x32_bf16 v[64:67], a[192:195], a[32:35], v[64:67]
    ds_read_b128 a[220:223], v37 offset:18688
    v_accvgpr_write_b32 a44, v220
    v_mfma_f32_16x16x32_bf16 v[68:71], a[192:195], a[36:39], v[68:71]
    v_accvgpr_write_b32 a45, v221
    v_accvgpr_write_b32 a46, v222
    v_accvgpr_write_b32 a47, v223
    v_mfma_f32_16x16x32_bf16 v[76:79], a[196:199], a[36:39], v[76:79]
    v_mov_b64 v[112:113], 0
    v_mov_b64 v[114:115], 0
    v_mov_b64 v[116:117], 0
    v_mfma_f32_16x16x32_bf16 v[72:75], a[196:199], a[32:35], v[72:75]
    v_mov_b64 v[118:119], 0
    v_mov_b64 v[120:121], 0
    v_mov_b64 v[122:123], 0
    s_waitcnt lgkmcnt(4)
    v_mfma_f32_16x16x32_bf16 v[80:83], a[200:203], a[32:35], v[80:83]
    v_mov_b64 v[124:125], 0
    v_mov_b64 v[126:127], 0
    v_mfma_f32_16x16x32_bf16 v[84:87], a[200:203], a[36:39], v[84:87]
    v_mov_b64 v[128:129], 0
    v_mov_b64 v[130:131], 0
    v_mov_b64 v[132:133], 0
    v_mfma_f32_16x16x32_bf16 v[92:95], a[204:207], a[36:39], v[92:95]
    s_waitcnt vmcnt(12) lgkmcnt(0)
    s_barrier
    ds_read_b64_tr_b16 a[192:193], v248 offset:24576
    ds_read_b64_tr_b16 a[194:195], v248 offset:26112
    ds_read_b64_tr_b16 a[196:197], v249 offset:24576
    v_mfma_f32_16x16x32_bf16 v[88:91], a[204:207], a[32:35], v[88:91]
    ds_read_b64_tr_b16 a[198:199], v249 offset:26112
    ds_read_b64_tr_b16 a[200:201], v250 offset:24576
    ds_read_b64_tr_b16 a[202:203], v250 offset:26112
    v_mfma_f32_16x16x32_bf16 v[64:67], a[208:211], a[40:43], v[64:67]
    ds_read_b64_tr_b16 a[204:205], v251 offset:24576
    v_mfma_f32_16x16x32_bf16 v[68:71], a[208:211], a[44:47], v[68:71]
    ds_read_b64_tr_b16 a[206:207], v251 offset:26112
    s_add_u32 m0, s56, s49
    s_nop 0
    buffer_load_dwordx4 v12, s[8:11], s50 offen offset:0 nt lds
    v_mfma_f32_16x16x32_bf16 v[76:79], a[212:215], a[44:47], v[76:79]
    ds_read_b64_tr_b16 a[208:209], v248 offset:24704
    v_mov_b64 v[134:135], 0
    v_mfma_f32_16x16x32_bf16 v[72:75], a[212:215], a[40:43], v[72:75]
    ds_read_b64_tr_b16 a[210:211], v248 offset:26240
    v_mov_b64 v[136:137], 0
    v_mov_b64 v[138:139], 0
    v_mfma_f32_16x16x32_bf16 v[80:83], a[216:219], a[40:43], v[80:83]
    ds_read_b64_tr_b16 a[212:213], v249 offset:24704
    v_mov_b64 v[140:141], 0
    v_mov_b64 v[142:143], 0
    v_mfma_f32_16x16x32_bf16 v[84:87], a[216:219], a[44:47], v[84:87]
    ds_read_b64_tr_b16 a[214:215], v249 offset:26240
    v_xor_b32 v36, 49152, v36
    v_xor_b32 v37, 49152, v37
    v_mfma_f32_16x16x32_bf16 v[92:95], a[220:223], a[44:47], v[92:95]
    ds_read_b64_tr_b16 a[216:217], v250 offset:24704
    buffer_load_dwordx4 v13, s[8:11], s50 offen offset:1024 nt lds
    v_mfma_f32_16x16x32_bf16 v[88:91], a[220:223], a[40:43], v[88:91]
    ds_read_b64_tr_b16 a[218:219], v250 offset:26240
    v_mov_b64 v[144:145], 0
    v_mov_b64 v[146:147], 0
    s_waitcnt lgkmcnt(8)
    v_mfma_f32_16x16x32_bf16 a[96:99], a[192:195], a[224:227], a[96:99]
    ds_read_b64_tr_b16 a[220:221], v251 offset:24704
    v_mov_b64 v[148:149], 0
    v_mfma_f32_16x16x32_bf16 a[100:103], a[192:195], a[228:231], a[100:103]
    ds_read_b64_tr_b16 a[222:223], v251 offset:26240
    v_mov_b64 v[150:151], 0
    v_mov_b64 v[152:153], 0
    v_mfma_f32_16x16x32_bf16 a[108:111], a[196:199], a[228:231], a[108:111]
    ds_read_b64_tr_b16 a[192:193], v248 offset:24832
    v_mov_b64 v[154:155], 0
    v_mov_b64 v[156:157], 0
    v_mfma_f32_16x16x32_bf16 a[104:107], a[196:199], a[224:227], a[104:107]
    ds_read_b64_tr_b16 a[194:195], v248 offset:26368
    buffer_load_dwordx4 v14, s[8:11], s50 offen offset:2048 nt lds
    v_mfma_f32_16x16x32_bf16 a[112:115], a[200:203], a[224:227], a[112:115]
    ds_read_b64_tr_b16 a[196:197], v249 offset:24832
    s_nop 3
    s_branch L_rare1
L_retA0:
    v_mfma_f32_16x16x32_bf16 a[116:119], a[200:203], a[228:231], a[116:119]
    ds_read_b64_tr_b16 a[198:199], v249 offset:26368
    v_exp_f32 v208, v64
    s_waitcnt lgkmcnt(8)
    v_mfma_f32_16x16x32_bf16 a[124:127], a[204:207], a[228:231], a[124:127]
    ds_read_b64_tr_b16 a[200:201], v250 offset:24832
    v_exp_f32 v209, v65
    v_mfma_f32_16x16x32_bf16 a[120:123], a[204:207], a[224:227], a[120:123]
    ds_read_b64_tr_b16 a[202:203], v250 offset:26368
    v_exp_f32 v210, v66
    v_mfma_f32_16x16x32_bf16 a[128:131], a[208:211], a[224:227], a[128:131]
    ds_read_b64_tr_b16 a[204:205], v251 offset:24832
    buffer_load_dwordx4 v15, s[8:11], s50 offen offset:3072 nt lds
    s_add_u32 m0, m0, 4096
    v_mfma_f32_16x16x32_bf16 a[132:135], a[208:211], a[228:231], a[132:135]
    ds_read_b64_tr_b16 a[206:207], v251 offset:26368
    v_mfma_f32_16x16x32_bf16 a[140:143], a[212:215], a[228:231], a[140:143]
    ds_read_b64_tr_b16 a[208:209], v248 offset:36864
    v_exp_f32 v211, v67
    v_mfma_f32_16x16x32_bf16 a[136:139], a[212:215], a[224:227], a[136:139]
    ds_read_b64_tr_b16 a[210:211], v248 offset:38400
    v_exp_f32 v212, v68
    s_waitcnt lgkmcnt(8)
    v_mfma_f32_16x16x32_bf16 a[144:147], a[216:219], a[224:227], a[144:147]
    ds_read_b64_tr_b16 a[212:213], v249 offset:36864
    v_exp_f32 v213, v69
    v_mfma_f32_16x16x32_bf16 a[148:151], a[216:219], a[228:231], a[148:151]
    ds_read_b64_tr_b16 a[214:215], v249 offset:38400
    buffer_load_dwordx4 v16, s[8:11], s50 offen offset:0 nt lds
    v_mfma_f32_16x16x32_bf16 a[156:159], a[220:223], a[228:231], a[156:159]
    ds_read_b64_tr_b16 a[216:217], v250 offset:36864
    v_exp_f32 v214, v70
    v_mfma_f32_16x16x32_bf16 a[152:155], a[220:223], a[224:227], a[152:155]
    ds_read_b64_tr_b16 a[218:219], v250 offset:38400
    v_exp_f32 v215, v71
    v_mfma_f32_16x16x32_bf16 a[160:163], a[192:195], a[224:227], a[160:163]
    ds_read_b64_tr_b16 a[220:221], v251 offset:36864
    v_exp_f32 v216, v72
    v_mfma_f32_16x16x32_bf16 a[164:167], a[192:195], a[228:231], a[164:167]
    ds_read_b64_tr_b16 a[222:223], v251 offset:38400
    v_exp_f32 v217, v73
    s_waitcnt lgkmcnt(8)
    v_mfma_f32_16x16x32_bf16 a[172:175], a[196:199], a[228:231], a[172:175]
    ds_read_b64_tr_b16 a[192:193], v248 offset:36992
    buffer_load_dwordx4 v17, s[8:11], s50 offen offset:1024 nt lds
    v_mfma_f32_16x16x32_bf16 a[168:171], a[196:199], a[224:227], a[168:171]
    ds_read_b64_tr_b16 a[194:195], v248 offset:38528
    v_mfma_f32_16x16x32_bf16 a[176:179], a[200:203], a[224:227], a[176:179]
    ds_read_b64_tr_b16 a[196:197], v249 offset:36992
    s_xor_b32 s56, s56, 49152
    s_mov_b32 s80, s50
    v_mfma_f32_16x16x32_bf16 a[180:183], a[200:203], a[228:231], a[180:183]
    ds_read_b64_tr_b16 a[198:199], v249 offset:38528
    s_add_u32 s51, s51, 1
    s_add_u32 s50, s50, 24576
    v_mfma_f32_16x16x32_bf16 a[188:191], a[204:207], a[228:231], a[188:191]
    ds_read_b64_tr_b16 a[200:201], v250 offset:36992
    s_cmp_eq_u32 s50, s63
    s_cselect_b32 s52, 393216, 0
    v_mfma_f32_16x16x32_bf16 a[184:187], a[204:207], a[224:227], a[184:187]
    ds_read_b64_tr_b16 a[202:203], v250 offset:38528
    s_sub_u32 s50, s50, s52
    s_cmp_eq_u32 s51, 16
    s_cselect_b32 s52, 6291456, 0
    s_waitcnt lgkmcnt(8)
    v_mfma_f32_16x16x32_bf16 a[96:99], a[208:211], a[232:235], a[96:99]
    ds_read_b64_tr_b16 a[204:205], v251 offset:36992
    v_mfma_f32_16x16x32_bf16 a[100:103], a[208:211], a[236:239], a[100:103]
    ds_read_b64_tr_b16 a[206:207], v251 offset:38528
    s_add_u32 s50, s50, s52
    s_add_u32 s63, s63, s52
    v_mfma_f32_16x16x32_bf16 a[108:111], a[212:215], a[236:239], a[108:111]
    ds_read_b64_tr_b16 a[208:209], v248 offset:37120
    s_add_u32 m0, 98304, s49
    s_add_u32 s67, s54, 4724736
    buffer_load_dwordx4 v24, s[16:19], s67 offen offset:0 lds
    v_mfma_f32_16x16x32_bf16 a[104:107], a[212:215], a[232:235], a[104:107]
    ds_read_b64_tr_b16 a[210:211], v248 offset:38656
    v_mfma_f32_16x16x32_bf16 a[112:115], a[216:219], a[232:235], a[112:115]
    ds_read_b64_tr_b16 a[212:213], v249 offset:37120
    v_exp_f32 v218, v74
    v_mfma_f32_16x16x32_bf16 a[116:119], a[216:219], a[236:239], a[116:119]
    ds_read_b64_tr_b16 a[214:215], v249 offset:38656
    v_exp_f32 v219, v75
    s_waitcnt lgkmcnt(8)
    v_mfma_f32_16x16x32_bf16 a[124:127], a[220:223], a[236:239], a[124:127]
    ds_read_b64_tr_b16 a[216:217], v250 offset:37120
    v_exp_f32 v220, v76
    v_mfma_f32_16x16x32_bf16 a[120:123], a[220:223], a[232:235], a[120:123]
    ds_read_b64_tr_b16 a[218:219], v250 offset:38656
    buffer_load_dwordx4 v25, s[16:19], s67 offen offset:1024 lds
    v_mfma_f32_16x16x32_bf16 a[128:131], a[192:195], a[232:235], a[128:131]
    ds_read_b64_tr_b16 a[220:221], v251 offset:37120
    v_exp_f32 v221, v77
    v_mfma_f32_16x16x32_bf16 a[132:135], a[192:195], a[236:239], a[132:135]
    ds_read_b64_tr_b16 a[222:223], v251 offset:38656
    v_exp_f32 v222, v78
    v_mfma_f32_16x16x32_bf16 a[140:143], a[196:199], a[236:239], a[140:143]
    v_exp_f32 v223, v79
    v_mfma_f32_16x16x32_bf16 a[136:139], a[196:199], a[232:235], a[136:139]
    v_cvt_pk_bf16_f32 v96, v208, v209
    v_cvt_pk_bf16_f32 v97, v210, v211
    v_cvt_pk_bf16_f32 v100, v212, v213
    s_waitcnt lgkmcnt(6)
    v_mfma_f32_16x16x32_bf16 a[144:147], a[200:203], a[232:235], a[144:147]
    buffer_load_dwordx4 v26, s[16:19], s67 offen offset:2048 lds
    v_mfma_f32_16x16x32_bf16 a[148:151], a[200:203], a[236:239], a[148:151]
    v_cvt_pk_bf16_f32 v101, v214, v215
    v_cvt_pk_bf16_f32 v98, v216, v217
    v_cvt_pk_bf16_f32 v99, v218, v219
    v_mfma_f32_16x16x32_bf16 a[156:159], a[204:207], a[236:239], a[156:159]
    s_waitcnt vmcnt(27) lgkmcnt(0)
    s_barrier
    ds_read_b128 a[192:195], v36 offset:0
    ds_read_b128 a[196:199], v36 offset:6144
    v_mfma_f32_16x16x32_bf16 a[152:155], a[204:207], a[232:235], a[152:155]
    ds_read_b128 a[200:203], v37 offset:0
    v_cvt_pk_bf16_f32 v102, v220, v221
    v_mfma_f32_16x16x32_bf16 a[160:163], a[208:211], a[232:235], a[160:163]
    ds_read_b128 a[204:207], v37 offset:6144
    v_cvt_pk_bf16_f32 v103, v222, v223
    v_mov_b64 v[158:159], 0
    v_mfma_f32_16x16x32_bf16 a[164:167], a[208:211], a[236:239], a[164:167]
    buffer_load_dwordx4 v27, s[16:19], s67 offen offset:3072 lds
    s_add_u32 m0, m0, 4096
    v_mfma_f32_16x16x32_bf16 a[172:175], a[212:215], a[236:239], a[172:175]
    ds_read_b128 a[208:211], v36 offset:128
    v_mov_b64 v[160:161], 0
    v_mov_b64 v[162:163], 0
    v_mfma_f32_16x16x32_bf16 a[168:171], a[212:215], a[232:235], a[168:171]
    v_mov_b64 v[164:165], 0
    v_mov_b64 v[166:167], 0
    v_mov_b64 v[168:169], 0
    v_mfma_f32_16x16x32_bf16 a[176:179], a[216:219], a[232:235], a[176:179]
    ds_read_b128 a[212:215], v36 offset:6272
    v_mov_b64 v[170:171], 0
    v_mov_b64 v[172:173], 0
    v_mfma_f32_16x16x32_bf16 a[180:183], a[216:219], a[236:239], a[180:183]
    v_mov_b64 v[174:175], 0
    v_mov_b64 v[176:177], 0
    v_mov_b64 v[178:179], 0
    v_mfma_f32_16x16x32_bf16 a[188:191], a[220:223], a[236:239], a[188:191]
    ds_read_b128 a[216:219], v37 offset:128
    buffer_load_dwordx4 v28, s[16:19], s67 offen offset:0 lds
    v_mfma_f32_16x16x32_bf16 a[184:187], a[220:223], a[232:235], a[184:187]
    v_mov_b64 v[180:181], 0
    v_mov_b64 v[182:183], 0
    v_mov_b64 v[184:185], 0
    buffer_load_dwordx4 v29, s[16:19], s67 offen offset:1024 lds
    v_mov_b64 v[186:187], 0
    v_mov_b64 v[188:189], 0
    v_mov_b64 v[190:191], 0
    v_mov_b64 v[192:193], 0
    v_mov_b64 v[194:195], 0
    v_mov_b64 v[196:197], 0
    v_mov_b64 v[198:199], 0
    v_mov_b64 v[200:201], 0
    v_mov_b64 v[202:203], 0
    v_mov_b64 v[204:205], 0
    v_mov_b64 v[206:207], 0
L_bodyN:
    s_waitcnt lgkmcnt(5)
    v_mfma_f32_16x16x32_bf16 v[64:67], a[192:195], a[0:3], v[48:51]
    ds_read_b128 a[220:223], v37 offset:6272
    s_mov_b32 s62, 0
    v_mfma_f32_16x16x32_bf16 v[68:71], a[192:195], a[4:7], v[52:55]
    s_cmp_ge_u32 s51, 32
    s_cselect_b32 s50, 0xf0000000, s50
    v_exp_f32 v224, v80
    v_mfma_f32_16x16x32_bf16 v[76:79], a[196:199], a[4:7], v[52:55]
    ds_read_b128 a[192:195], v36 offset:256
    v_exp_f32 v225, v81
    v_mfma_f32_16x16x32_bf16 v[72:75], a[196:199], a[0:3], v[48:51]
    v_exp_f32 v226, v82
    v_add_f32 v2, v2, v208
    s_waitcnt lgkmcnt(5)
    v_mfma_f32_16x16x32_bf16 v[64:67], a[200:203], a[8:11], v[64:67]
    ds_read_b128 a[196:199], v36 offset:6400
    v_add_f32 v3, v3, v212
    v_mfma_f32_16x16x32_bf16 v[68:71], a[200:203], a[12:15], v[68:71]
    v_exp_f32 v227, v83
    v_add_f32 v2, v2, v209
    v_mfma_f32_16x16x32_bf16 v[76:79], a[204:207], a[12:15], v[76:79]
    ds_read_b128 a[200:203], v37 offset:256
    v_exp_f32 v228, v84
    v_mfma_f32_16x16x32_bf16 v[72:75], a[204:207], a[8:11], v[72:75]
    v_exp_f32 v229, v85
    v_exp_f32 v230, v86
    s_waitcnt lgkmcnt(5)
    v_mfma_f32_16x16x32_bf16 v[64:67], a[208:211], a[16:19], v[64:67]
    ds_read_b128 a[204:207], v37 offset:6400
    v_mfma_f32_16x16x32_bf16 v[68:71], a[208:211], a[20:23], v[68:71]
    v_exp_f32 v231, v87
    v_exp_f32 v232, v88
    v_mfma_f32_16x16x32_bf16 v[76:79], a[212:215], a[20:23], v[76:79]
    ds_read_b128 a[208:211], v36 offset:12288
    v_exp_f32 v233, v89
    v_mfma_f32_16x16x32_bf16 v[72:75], a[212:215], a[16:19], v[72:75]
    v_exp_f32 v234, v90
    v_add_f32 v3, v3, v213
    s_waitcnt lgkmcnt(5)
    v_mfma_f32_16x16x32_bf16 v[64:67], a[216:219], a[24:27], v[64:67]
    ds_read_b128 a[212:215], v36 offset:18432
    v_add_f32 v2, v2, v210
    v_mfma_f32_16x16x32_bf16 v[68:71], a[216:219], a[28:31], v[68:71]
    v_exp_f32 v235, v91
    v_add_f32 v3, v3, v214
    v_mfma_f32_16x16x32_bf16 v[76:79], a[220:223], a[28:31], v[76:79]
    ds_read_b128 a[216:219], v37 offset:12288
    v_exp_f32 v236, v92
    v_mfma_f32_16x16x32_bf16 v[72:75], a[220:223], a[24:27], v[72:75]
    v_exp_f32 v237, v93
    v_exp_f32 v238, v94
    s_waitcnt lgkmcnt(5)
    v_mfma_f32_16x16x32_bf16 v[64:67], a[192:195], a[32:35], v[64:67]
    ds_read_b128 a[220:223], v37 offset:18432
    v_mfma_f32_16x16x32_bf16 v[68:71], a[192:195], a[36:39], v[68:71]
    v_exp_f32 v239, v95
    v_add_f32 v2, v2, v211
    v_mfma_f32_16x16x32_bf16 v[76:79], a[196:199], a[36:39], v[76:79]
    ds_read_b128 a[192:195], v36 offset:12416
    v_add_f32 v3, v3, v215
    v_add_f32 v2, v2, v216
    v_mfma_f32_16x16x32_bf16 v[72:75], a[196:199], a[32:35], v[72:75]
    v_add_f32 v3, v3, v220
    v_add_f32 v2, v2, v217
    v_add_f32 v3, v3, v221
    v_add_f32 v2, v2, v218
    s_waitcnt lgkmcnt(5)
    v_mfma_f32_16x16x32_bf16 v[64:67], a[200:203], a[40:43], v[64:67]
    ds_read_b128 a[196:199], v36 offset:18560
    v_add_f32 v3, v3, v222
    v_mfma_f32_16x16x32_bf16 v[68:71], a[200:203], a[44:47], v[68:71]
    v_add_f32 v2, v2, v219
    v_add_f32 v3, v3, v223
    v_mfma_f32_16x16x32_bf16 v[76:79], a[204:207], a[44:47], v[76:79]
    ds_read_b128 a[200:203], v37 offset:12416
    v_mfma_f32_16x16x32_bf16 v[72:75], a[204:207], a[40:43], v[72:75]
    s_waitcnt lgkmcnt(5)
    v_mfma_f32_16x16x32_bf16 v[80:83], a[208:211], a[0:3], v[48:51]
    ds_read_b128 a[204:207], v37 offset:18560
    v_mfma_f32_16x16x32_bf16 v[84:87], a[208:211], a[4:7], v[52:55]
    v_mfma_f32_16x16x32_bf16 v[92:95], a[212:215], a[4:7], v[52:55]
    ds_read_b128 a[208:211], v36 offset:12544
    v_mfma_f32_16x16x32_bf16 v[88:91], a[212:215], a[0:3], v[48:51]
    v_max3_f32 v1, v64, v65, v66
    v_max3_f32 v1, v1, v67, v68
    v_max3_f32 v1, v1, v69, v70
    v_max3_f32 v1, v1, v71, v72
    s_waitcnt lgkmcnt(5)
    v_mfma_f32_16x16x32_bf16 v[80:83], a[216:219], a[8:11], v[80:83]
    ds_read_b128 a[212:215], v36 offset:18688
    v_max3_f32 v1, v1, v73, v74
    v_mfma_f32_16x16x32_bf16 v[84:87], a[216:219], a[12:15], v[84:87]
    v_max3_f32 v1, v1, v75, v76
    v_max3_f32 v1, v1, v77, v78
    v_max_f32 v1, v1, v79
    v_mfma_f32_16x16x32_bf16 v[92:95], a[220:223], a[12:15], v[92:95]
    ds_read_b128 a[216:219], v37 offset:12544
    v_mfma_f32_16x16x32_bf16 v[88:91], a[220:223], a[8:11], v[88:91]
    s_waitcnt lgkmcnt(5)
    v_mfma_f32_16x16x32_bf16 v[80:83], a[192:195], a[16:19], v[80:83]
    ds_read_b128 a[220:223], v37 offset:18688
    v_mfma_f32_16x16x32_bf16 v[84:87], a[192:195], a[20:23], v[84:87]
    v_mfma_f32_16x16x32_bf16 v[92:95], a[196:199], a[20:23], v[92:95]
    v_mfma_f32_16x16x32_bf16 v[88:91], a[196:199], a[16:19], v[88:91]
    v_xor_b32 v36, 49152, v36
    v_xor_b32 v37, 49152, v37
    s_waitcnt lgkmcnt(4)
    v_mfma_f32_16x16x32_bf16 v[80:83], a[200:203], a[24:27], v[80:83]
    v_mfma_f32_16x16x32_bf16 v[84:87], a[200:203], a[28:31], v[84:87]
    v_cvt_pk_bf16_f32 v104, v224, v225
    v_cvt_pk_bf16_f32 v105, v226, v227
    v_cvt_pk_bf16_f32 v108, v228, v229
    v_cvt_pk_bf16_f32 v109, v230, v231
    v_mfma_f32_16x16x32_bf16 v[92:95], a[204:207], a[28:31], v[92:95]
    s_bitcmp1_b64 s[34:35], s51
    s_cbranch_scc1 L_dn_v
    s_waitcnt vmcnt(4)
L_dn_v:
    s_waitcnt vmcnt(12) lgkmcnt(0)
    s_barrier
    ds_read_b64_tr_b16 a[192:193], v40 offset:0
    ds_read_b64_tr_b16 a[194:195], v40 offset:6144
    ds_read_b64_tr_b16 a[196:197], v41 offset:0
    s_add_u32 m0, s56, s49
    v_mfma_f32_16x16x32_bf16 v[88:91], a[204:207], a[24:27], v[88:91]
    ds_read_b64_tr_b16 a[198:199], v41 offset:6144
    ds_read_b64_tr_b16 a[200:201], v42 offset:0
    ds_read_b64_tr_b16 a[202:203], v42 offset:6144
    v_mfma_f32_16x16x32_bf16 v[80:83], a[208:211], a[32:35], v[80:83]
    ds_read_b64_tr_b16 a[204:205], v43 offset:0
    buffer_load_dwordx4 v12, s[8:11], s50 offen offset:0 nt lds
    v_mfma_f32_16x16x32_bf16 v[84:87], a[208:211], a[36:39], v[84:87]
    ds_read_b64_tr_b16 a[206:207], v43 offset:6144
    v_mfma_f32_16x16x32_bf16 v[92:95], a[212:215], a[36:39], v[92:95]
    ds_read_b64_tr_b16 a[208:209], v40 offset:128
    buffer_load_dwordx4 v13, s[8:11], s50 offen offset:1024 nt lds
    v_mfma_f32_16x16x32_bf16 v[88:91], a[212:215], a[32:35], v[88:91]
    ds_read_b64_tr_b16 a[210:211], v40 offset:6272
    v_cvt_pk_bf16_f32 v106, v232, v233
    v_cvt_pk_bf16_f32 v107, v234, v235
    v_mfma_f32_16x16x32_bf16 v[80:83], a[216:219], a[40:43], v[80:83]
    ds_read_b64_tr_b16 a[212:213], v41 offset:128
    buffer_load_dwordx4 v14, s[8:11], s50 offen offset:2048 nt lds
    v_mfma_f32_16x16x32_bf16 v[84:87], a[216:219], a[44:47], v[84:87]
    ds_read_b64_tr_b16 a[214:215], v41 offset:6272
    v_cvt_pk_bf16_f32 v110, v236, v237
    v_cvt_pk_bf16_f32 v111, v238, v239
    v_mfma_f32_16x16x32_bf16 v[92:95], a[220:223], a[44:47], v[92:95]
    ds_read_b64_tr_b16 a[216:217], v42 offset:128
    buffer_load_dwordx4 v15, s[8:11], s50 offen offset:3072 nt lds
    s_add_u32 m0, m0, 4096
    v_mfma_f32_16x16x32_bf16 v[88:91], a[220:223], a[40:43], v[88:91]
    ds_read_b64_tr_b16 a[218:219], v42 offset:6272
    v_add_f32 v2, v2, v224
    s_waitcnt lgkmcnt(10)
    v_mfma_f32_16x16x32_bf16 v[112:115], a[192:195], v[96:99], v[112:115]
    ds_read_b64_tr_b16 a[220:221], v43 offset:128
    buffer_load_dwordx4 v16, s[8:11], s50 offen offset:0 nt lds
    v_mfma_f32_16x16x32_bf16 v[116:119], a[192:195], v[100:103], v[116:119]
    ds_read_b64_tr_b16 a[222:223], v43 offset:6272
    v_add_f32 v3, v3, v228
    v_add_f32 v2, v2, v225
    v_mfma_f32_16x16x32_bf16 v[124:127], a[196:199], v[100:103], v[124:127]
    ds_read_b64_tr_b16 a[192:193], v40 offset:256
    buffer_load_dwordx4 v17, s[8:11], s50 offen offset:1024 nt lds
    s_xor_b32 s56, s56, 49152
    s_mov_b32 s80, s50
    v_mfma_f32_16x16x32_bf16 v[120:123], a[196:199], v[96:99], v[120:123]
    ds_read_b64_tr_b16 a[194:195], v40 offset:6400
    s_add_u32 s51, s51, 1
    s_add_u32 s50, s50, 24576
    s_waitcnt lgkmcnt(10)
    v_mfma_f32_16x16x32_bf16 v[128:131], a[200:203], v[96:99], v[128:131]
    ds_read_b64_tr_b16 a[196:197], v41 offset:256
    s_cmp_eq_u32 s50, s63
    s_cselect_b32 s52, 393216, 0
    v_mfma_f32_16x16x32_bf16 v[132:135], a[200:203], v[100:103], v[132:135]
    ds_read_b64_tr_b16 a[198:199], v41 offset:6400
    s_sub_u32 s50, s50, s52
    s_cmp_eq_u32 s51, 16
    s_cselect_b32 s52, 6291456, 0
    v_mfma_f32_16x16x32_bf16 v[140:143], a[204:207], v[100:103], v[140:143]
    ds_read_b64_tr_b16 a[200:201], v42 offset:256
    s_add_u32 s50, s50, s52
    s_add_u32 s63, s63, s52
    v_mfma_f32_16x16x32_bf16 v[136:139], a[204:207], v[96:99], v[136:139]
    ds_read_b64_tr_b16 a[202:203], v42 offset:6400
    s_waitcnt lgkmcnt(10)
    v_mfma_f32_16x16x32_bf16 v[144:147], a[208:211], v[96:99], v[144:147]
    ds_read_b64_tr_b16 a[204:205], v43 offset:256
    v_mfma_f32_16x16x32_bf16 v[148:151], a[208:211], v[100:103], v[148:151]
    ds_read_b64_tr_b16 a[206:207], v43 offset:6400
    v_max3_f32 v1, v1, v80, v81
    v_max3_f32 v1, v1, v82, v83
    v_max3_f32 v1, v1, v84, v85
    v_mfma_f32_16x16x32_bf16 v[156:159], a[212:215], v[100:103], v[156:159]
    ds_read_b64_tr_b16 a[208:209], v40 offset:12288
    v_max3_f32 v1, v1, v86, v87
    v_max3_f32 v1, v1, v88, v89
    v_mfma_f32_16x16x32_bf16 v[152:155], a[212:215], v[96:99], v[152:155]
    ds_read_b64_tr_b16 a[210:211], v40 offset:18432
    v_max3_f32 v1, v1, v90, v91
    v_max3_f32 v1, v1, v92, v93
    s_waitcnt lgkmcnt(10)
    v_mfma_f32_16x16x32_bf16 v[160:163], a[216:219], v[96:99], v[160:163]
    ds_read_b64_tr_b16 a[212:213], v41 offset:12288
    v_max3_f32 v1, v1, v94, v95
    v_mfma_f32_16x16x32_bf16 v[164:167], a[216:219], v[100:103], v[164:167]
    ds_read_b64_tr_b16 a[214:215], v41 offset:18432
    v_cmp_lt_f32 vcc, s74, v1
    s_cbranch_vccnz L_rare1
L_retN:
    v_mfma_f32_16x16x32_bf16 v[172:175], a[220:223], v[100:103], v[172:175]
    ds_read_b64_tr_b16 a[216:217], v42 offset:12288
    v_exp_f32 v208, v64
    v_mfma_f32_16x16x32_bf16 v[168:171], a[220:223], v[96:99], v[168:171]
    ds_read_b64_tr_b16 a[218:219], v42 offset:18432
    v_exp_f32 v209, v65
    s_waitcnt lgkmcnt(10)
    v_mfma_f32_16x16x32_bf16 v[176:179], a[192:195], v[96:99], v[176:179]
    ds_read_b64_tr_b16 a[220:221], v43 offset:12288
    v_mfma_f32_16x16x32_bf16 v[180:183], a[192:195], v[100:103], v[180:183]
    ds_read_b64_tr_b16 a[222:223], v43 offset:18432
    v_exp_f32 v210, v66
    v_add_f32 v3, v3, v229
    v_mfma_f32_16x16x32_bf16 v[188:191], a[196:199], v[100:103], v[188:191]
    ds_read_b64_tr_b16 a[192:193], v40 offset:12416
    v_exp_f32 v211, v67
    v_mfma_f32_16x16x32_bf16 v[184:187], a[196:199], v[96:99], v[184:187]
    ds_read_b64_tr_b16 a[194:195], v40 offset:18560
    v_exp_f32 v212, v68
    s_waitcnt lgkmcnt(10)
    v_mfma_f32_16x16x32_bf16 v[192:195], a[200:203], v[96:99], v[192:195]
    ds_read_b64_tr_b16 a[196:197], v41 offset:12416
    v_add_f32 v2, v2, v226
    v_mfma_f32_16x16x32_bf16 v[196:199], a[200:203], v[100:103], v[196:199]
    ds_read_b64_tr_b16 a[198:199], v41 offset:18560
    v_exp_f32 v213, v69
    v_mfma_f32_16x16x32_bf16 v[204:207], a[204:207], v[100:103], v[204:207]
    ds_read_b64_tr_b16 a[200:201], v42 offset:12416
    v_exp_f32 v214, v70
    v_mfma_f32_16x16x32_bf16 v[200:203], a[204:207], v[96:99], v[200:203]
    ds_read_b64_tr_b16 a[202:203], v42 offset:18560
    v_exp_f32 v215, v71
    s_waitcnt lgkmcnt(10)
    v_mfma_f32_16x16x32_bf16 v[112:115], a[208:211], v[104:107], v[112:115]
    ds_read_b64_tr_b16 a[204:205], v43 offset:12416
    v_exp_f32 v216, v72
    v_mfma_f32_16x16x32_bf16 v[116:119], a[208:211], v[108:111], v[116:119]
    ds_read_b64_tr_b16 a[206:207], v43 offset:18560
    v_exp_f32 v217, v73
    v_mfma_f32_16x16x32_bf16 v[124:127], a[212:215], v[108:111], v[124:127]
    ds_read_b64_tr_b16 a[208:209], v40 offset:12544
    v_exp_f32 v218, v74
    v_mfma_f32_16x16x32_bf16 v[120:123], a[212:215], v[104:107], v[120:123]
    ds_read_b64_tr_b16 a[210:211], v40 offset:18688
    v_exp_f32 v219, v75
    s_waitcnt lgkmcnt(10)
    v_mfma_f32_16x16x32_bf16 v[128:131], a[216:219], v[104:107], v[128:131]
    ds_read_b64_tr_b16 a[212:213], v41 offset:12544
    v_add_f32 v3, v3, v230
    v_mfma_f32_16x16x32_bf16 v[132:135], a[216:219], v[108:111], v[132:135]
    ds_read_b64_tr_b16 a[214:215], v41 offset:18688
    v_exp_f32 v220, v76
    v_mfma_f32_16x16x32_bf16 v[140:143], a[220:223], v[108:111], v[140:143]
    ds_read_b64_tr_b16 a[216:217], v42 offset:12544
    v_exp_f32 v221, v77
    v_mfma_f32_16x16x32_bf16 v[136:139], a[220:223], v[104:107], v[136:139]
    ds_read_b64_tr_b16 a[218:219], v42 offset:18688
    v_exp_f32 v222, v78
    s_waitcnt lgkmcnt(10)
    v_mfma_f32_16x16x32_bf16 v[144:147], a[192:195], v[104:107], v[144:147]
    ds_read_b64_tr_b16 a[220:221], v43 offset:12544
    v_exp_f32 v223, v79
    v_mfma_f32_16x16x32_bf16 v[148:151], a[192:195], v[108:111], v[148:151]
    ds_read_b64_tr_b16 a[222:223], v43 offset:18688
    v_cvt_pk_bf16_f32 v96, v208, v209
    v_cvt_pk_bf16_f32 v97, v210, v211
    v_mfma_f32_16x16x32_bf16 v[156:159], a[196:199], v[108:111], v[156:159]
    v_cvt_pk_bf16_f32 v100, v212, v213
    v_cvt_pk_bf16_f32 v101, v214, v215
    v_cvt_pk_bf16_f32 v98, v216, v217
    v_mfma_f32_16x16x32_bf16 v[152:155], a[196:199], v[104:107], v[152:155]
    v_cvt_pk_bf16_f32 v99, v218, v219
    v_cvt_pk_bf16_f32 v102, v220, v221
    v_cvt_pk_bf16_f32 v103, v222, v223
    s_waitcnt lgkmcnt(8)
    v_mfma_f32_16x16x32_bf16 v[160:163], a[200:203], v[104:107], v[160:163]
    v_add_f32 v2, v2, v227
    v_add_f32 v3, v3, v231
    v_mfma_f32_16x16x32_bf16 v[164:167], a[200:203], v[108:111], v[164:167]
    v_xor_b32 v40, 81920, v40
    v_xor_b32 v41, 81920, v41
    v_xor_b32 v42, 81920, v42
    v_mfma_f32_16x16x32_bf16 v[172:175], a[204:207], v[108:111], v[172:175]
    s_bitcmp1_b64 s[34:35], s51
    s_cbranch_scc1 L_dn_k
    s_waitcnt vmcnt(4)
L_dn_k:
    s_waitcnt vmcnt(12) lgkmcnt(0)
    s_barrier
    ds_read_b128 a[192:195], v36 offset:0
    ds_read_b128 a[196:199], v36 offset:6144
    s_add_u32 m0, s57, s49
    s_nop 0
    buffer_load_dwordx4 v18, s[12:15], s77 offen offset:0 nt lds
    v_mfma_f32_16x16x32_bf16 v[168:171], a[204:207], v[104:107], v[168:171]
    ds_read_b128 a[200:203], v37 offset:0
    buffer_load_dwordx4 v19, s[12:15], s77 offen offset:1024 nt lds
    v_mfma_f32_16x16x32_bf16 v[176:179], a[208:211], v[104:107], v[176:179]
    ds_read_b128 a[204:207], v37 offset:6144
    buffer_load_dwordx4 v20, s[12:15], s77 offen offset:2048 nt lds
    v_mfma_f32_16x16x32_bf16 v[180:183], a[208:211], v[108:111], v[180:183]
    buffer_load_dwordx4 v21, s[12:15], s77 offen offset:3072 nt lds
    s_add_u32 m0, m0, 4096
    v_mfma_f32_16x16x32_bf16 v[188:191], a[212:215], v[108:111], v[188:191]
    ds_read_b128 a[208:211], v36 offset:128
    buffer_load_dwordx4 v22, s[12:15], s77 offen offset:0 nt lds
    v_mfma_f32_16x16x32_bf16 v[184:187], a[212:215], v[104:107], v[184:187]
    v_xor_b32 v43, 81920, v43
    v_mfma_f32_16x16x32_bf16 v[192:195], a[216:219], v[104:107], v[192:195]
    ds_read_b128 a[212:215], v36 offset:6272
    buffer_load_dwordx4 v23, s[12:15], s77 offen offset:1024 nt lds
    s_xor_b32 s57, s57, 81920
    s_mov_b32 s77, s80
    v_mfma_f32_16x16x32_bf16 v[196:199], a[216:219], v[108:111], v[196:199]
    v_add_f32 v2, v2, v232
    v_mfma_f32_16x16x32_bf16 v[204:207], a[220:223], v[108:111], v[204:207]
    ds_read_b128 a[216:219], v37 offset:128
    v_add_f32 v3, v3, v236
    v_add_f32 v2, v2, v233
    v_mfma_f32_16x16x32_bf16 v[200:203], a[220:223], v[104:107], v[200:203]
    v_add_f32 v3, v3, v237
    v_add_f32 v2, v2, v234
    v_add_f32 v3, v3, v238
    v_add_f32 v2, v2, v235
    v_add_f32 v3, v3, v239
    s_cmp_lg_u32 s76, 0
    s_cbranch_scc1 L_rare2
L_ret2:
    s_bitcmp1_b64 s[32:33], s51
    s_cbranch_scc0 L_bodyN
L_hooks:
    s_cmp_eq_u32 s51, 7
    s_cbranch_scc1 LH_qh_0
    s_cmp_eq_u32 s51, 9
    s_cbranch_scc1 LH_qh_1
    s_cmp_eq_u32 s51, 11
    s_cbranch_scc1 LH_qh_2
    s_cmp_eq_u32 s51, 13
    s_cbranch_scc1 LH_qh_3
    s_cmp_eq_u32 s51, 15
    s_cbranch_scc1 LH_qh_4
    s_cmp_eq_u32 s51, 17
    s_cbranch_scc1 LH_qh_5
    s_cmp_eq_u32 s51, 18
    s_cbranch_scc1 LH_h14
    s_cmp_eq_u32 s51, 19
    s_cbranch_scc1 LH_epi
    s_cmp_eq_u32 s51, 21
    s_cbranch_scc1 LH_g4
    s_cmp_eq_u32 s51, 23
    s_cbranch_scc1 LH_ow_0
    s_cmp_eq_u32 s51, 25
    s_cbranch_scc1 LH_ow_1
    s_cmp_eq_u32 s51, 26
    s_cbranch_scc1 LH_g5
    s_cmp_eq_u32 s51, 27
    s_cbranch_scc1 LH_ow_2
    s_cmp_eq_u32 s51, 29
    s_cbranch_scc1 LH_t4
    s_cmp_eq_u32 s51, 31
    s_cbranch_scc1 LH_t5
    s_branch L_tail
LH_qh_0:
    s_waitcnt lgkmcnt(0)
    ds_read_b64_tr_b16 a[224:225], v248 offset:0
    ds_read_b64_tr_b16 a[226:227], v248 offset:1536
    ds_read_b64_tr_b16 a[228:229], v249 offset:0
    ds_read_b64_tr_b16 a[230:231], v249 offset:1536
    ds_read_b64_tr_b16 a[232:233], v250 offset:0
    ds_read_b64_tr_b16 a[234:235], v250 offset:1536
    ds_read_b64_tr_b16 a[236:237], v251 offset:0
    ds_read_b64_tr_b16 a[238:239], v251 offset:1536
    ds_read_b64_tr_b16 a[240:241], v248 offset:128
    ds_read_b64_tr_b16 a[242:243], v248 offset:1664
    ds_read_b64_tr_b16 a[244:245], v249 offset:128
    ds_read_b64_tr_b16 a[246:247], v249 offset:1664
    ds_read_b64_tr_b16 a[248:249], v250 offset:128
    ds_read_b64_tr_b16 a[250:251], v250 offset:1664
    s_waitcnt lgkmcnt(10)
    v_mfma_f32_16x16x32_bf16 a[96:99], a[224:227], a[48:51], a[96:99]
    ds_read_b64_tr_b16 a[252:253], v251 offset:128
    s_add_u32 m0, 122880, s49
    s_add_u32 s67, s54, 3938304
    buffer_load_dwordx4 v24, s[16:19], s67 offen offset:0 lds
    v_mfma_f32_16x16x32_bf16 a[100:103], a[224:227], a[52:55], a[100:103]
    ds_read_b64_tr_b16 a[254:255], v251 offset:1664
    v_mfma_f32_16x16x32_bf16 a[108:111], a[228:231], a[52:55], a[108:111]
    ds_read_b64_tr_b16 a[224:225], v248 offset:256
    v_mfma_f32_16x16x32_bf16 a[104:107], a[228:231], a[48:51], a[104:107]
    ds_read_b64_tr_b16 a[226:227], v248 offset:1792
    buffer_load_dwordx4 v25, s[16:19], s67 offen offset:1024 lds
    s_waitcnt lgkmcnt(10)
    v_mfma_f32_16x16x32_bf16 a[112:115], a[232:235], a[48:51], a[112:115]
    ds_read_b64_tr_b16 a[228:229], v249 offset:256
    v_mfma_f32_16x16x32_bf16 a[116:119], a[232:235], a[52:55], a[116:119]
    ds_read_b64_tr_b16 a[230:231], v249 offset:1792
    v_mfma_f32_16x16x32_bf16 a[124:127], a[236:239], a[52:55], a[124:127]
    ds_read_b64_tr_b16 a[232:233], v250 offset:256
    buffer_load_dwordx4 v26, s[16:19], s67 offen offset:2048 lds
    v_mfma_f32_16x16x32_bf16 a[120:123], a[236:239], a[48:51], a[120:123]
    ds_read_b64_tr_b16 a[234:235], v250 offset:1792
    s_waitcnt lgkmcnt(10)
    v_mfma_f32_16x16x32_bf16 a[128:131], a[240:243], a[48:51], a[128:131]
    ds_read_b64_tr_b16 a[236:237], v251 offset:256
    v_mfma_f32_16x16x32_bf16 a[132:135], a[240:243], a[52:55], a[132:135]
    ds_read_b64_tr_b16 a[238:239], v251 offset:1792
    buffer_load_dwordx4 v27, s[16:19], s67 offen offset:3072 lds
    v_mfma_f32_16x16x32_bf16 a[140:143], a[244:247], a[52:55], a[140:143]
    v_mfma_f32_16x16x32_bf16 a[136:139], a[244:247], a[48:51], a[136:139]
    s_waitcnt lgkmcnt(8)
    v_mfma_f32_16x16x32_bf16 a[144:147], a[248:251], a[48:51], a[144:147]
    v_mfma_f32_16x16x32_bf16 a[148:151], a[248:251], a[52:55], a[148:151]
    v_mfma_f32_16x16x32_bf16 a[156:159], a[252:255], a[52:55], a[156:159]
    v_mfma_f32_16x16x32_bf16 a[152:155], a[252:255], a[48:51], a[152:155]
    s_waitcnt lgkmcnt(4)
    v_mfma_f32_16x16x32_bf16 a[160:163], a[224:227], a[48:51], a[160:163]
    v_mfma_f32_16x16x32_bf16 a[164:167], a[224:227], a[52:55], a[164:167]
    v_mfma_f32_16x16x32_bf16 a[172:175], a[228:231], a[52:55], a[172:175]
    v_mfma_f32_16x16x32_bf16 a[168:171], a[228:231], a[48:51], a[168:171]
    s_waitcnt lgkmcnt(0)
    v_mfma_f32_16x16x32_bf16 a[176:179], a[232:235], a[48:51], a[176:179]
    v_mfma_f32_16x16x32_bf16 a[180:183], a[232:235], a[52:55], a[180:183]
    v_mfma_f32_16x16x32_bf16 a[188:191], a[236:239], a[52:55], a[188:191]
    v_mfma_f32_16x16x32_bf16 a[184:187], a[236:239], a[48:51], a[184:187]
    s_branch L_bodyN
LH_qh_1:
    s_waitcnt lgkmcnt(0)
    ds_read_b64_tr_b16 a[224:225], v248 offset:12288
    ds_read_b64_tr_b16 a[226:227], v248 offset:13824
    ds_read_b64_tr_b16 a[228:229], v249 offset:12288
    ds_read_b64_tr_b16 a[230:231], v249 offset:13824
    ds_read_b64_tr_b16 a[232:233], v250 offset:12288
    ds_read_b64_tr_b16 a[234:235], v250 offset:13824
    ds_read_b64_tr_b16 a[236:237], v251 offset:12288
    ds_read_b64_tr_b16 a[238:239], v251 offset:13824
    ds_read_b64_tr_b16 a[240:241], v248 offset:12416
    ds_read_b64_tr_b16 a[242:243], v248 offset:13952
    ds_read_b64_tr_b16 a[244:245], v249 offset:12416
    ds_read_b64_tr_b16 a[246:247], v249 offset:13952
    ds_read_b64_tr_b16 a[248:249], v250 offset:12416
    ds_read_b64_tr_b16 a[250:251], v250 offset:13952
    s_waitcnt lgkmcnt(10)
    v_mfma_f32_16x16x32_bf16 a[96:99], a[224:227], a[56:59], a[96:99]
    ds_read_b64_tr_b16 a[252:253], v251 offset:12416
    s_add_u32 m0, 126976, s49
    s_add_u32 s67, s54, 3938304
    buffer_load_dwordx4 v28, s[16:19], s67 offen offset:0 lds
    v_mfma_f32_16x16x32_bf16 a[100:103], a[224:227], a[60:63], a[100:103]
    ds_read_b64_tr_b16 a[254:255], v251 offset:13952
    v_mfma_f32_16x16x32_bf16 a[108:111], a[228:231], a[60:63], a[108:111]
    ds_read_b64_tr_b16 a[224:225], v248 offset:12544
    v_mfma_f32_16x16x32_bf16 a[104:107], a[228:231], a[56:59], a[104:107]
    ds_read_b64_tr_b16 a[226:227], v248 offset:14080
    buffer_load_dwordx4 v29, s[16:19], s67 offen offset:1024 lds
    s_waitcnt lgkmcnt(10)
    v_mfma_f32_16x16x32_bf16 a[112:115], a[232:235], a[56:59], a[112:115]
    ds_read_b64_tr_b16 a[228:229], v249 offset:12544
    v_mfma_f32_16x16x32_bf16 a[116:119], a[232:235], a[60:63], a[116:119]
    ds_read_b64_tr_b16 a[230:231], v249 offset:14080
    v_mfma_f32_16x16x32_bf16 a[124:127], a[236:239], a[60:63], a[124:127]
    ds_read_b64_tr_b16 a[232:233], v250 offset:12544
    v_mfma_f32_16x16x32_bf16 a[120:123], a[236:239], a[56:59], a[120:123]
    ds_read_b64_tr_b16 a[234:235], v250 offset:14080
    s_waitcnt lgkmcnt(10)
    v_mfma_f32_16x16x32_bf16 a[128:131], a[240:243], a[56:59], a[128:131]
    ds_read_b64_tr_b16 a[236:237], v251 offset:12544
    v_mfma_f32_16x16x32_bf16 a[132:135], a[240:243], a[60:63], a[132:135]
    ds_read_b64_tr_b16 a[238:239], v251 offset:14080
    v_mfma_f32_16x16x32_bf16 a[140:143], a[244:247], a[60:63], a[140:143]
    v_mfma_f32_16x16x32_bf16 a[136:139], a[244:247], a[56:59], a[136:139]
    s_waitcnt lgkmcnt(8)
    v_mfma_f32_16x16x32_bf16 a[144:147], a[248:251], a[56:59], a[144:147]
    v_mfma_f32_16x16x32_bf16 a[148:151], a[248:251], a[60:63], a[148:151]
    v_mfma_f32_16x16x32_bf16 a[156:159], a[252:255], a[60:63], a[156:159]
    v_mfma_f32_16x16x32_bf16 a[152:155], a[252:255], a[56:59], a[152:155]
    s_waitcnt lgkmcnt(4)
    v_mfma_f32_16x16x32_bf16 a[160:163], a[224:227], a[56:59], a[160:163]
    v_mfma_f32_16x16x32_bf16 a[164:167], a[224:227], a[60:63], a[164:167]
    v_mfma_f32_16x16x32_bf16 a[172:175], a[228:231], a[60:63], a[172:175]
    v_mfma_f32_16x16x32_bf16 a[168:171], a[228:231], a[56:59], a[168:171]
    s_waitcnt lgkmcnt(0)
    v_mfma_f32_16x16x32_bf16 a[176:179], a[232:235], a[56:59], a[176:179]
    v_mfma_f32_16x16x32_bf16 a[180:183], a[232:235], a[60:63], a[180:183]
    v_mfma_f32_16x16x32_bf16 a[188:191], a[236:239], a[60:63], a[188:191]
    v_mfma_f32_16x16x32_bf16 a[184:187], a[236:239], a[56:59], a[184:187]
    s_branch L_bodyN
LH_qh_2:
    s_waitcnt lgkmcnt(0)
    ds_read_b64_tr_b16 a[224:225], v248 offset:24576
    ds_read_b64_tr_b16 a[226:227], v248 offset:26112
    ds_read_b64_tr_b16 a[228:229], v249 offset:24576
    ds_read_b64_tr_b16 a[230:231], v249 offset:26112
    ds_read_b64_tr_b16 a[232:233], v250 offset:24576
    ds_read_b64_tr_b16 a[234:235], v250 offset:26112
    ds_read_b64_tr_b16 a[236:237], v251 offset:24576
    ds_read_b64_tr_b16 a[238:239], v251 offset:26112
    ds_read_b64_tr_b16 a[240:241], v248 offset:24704
    ds_read_b64_tr_b16 a[242:243], v248 offset:26240
    ds_read_b64_tr_b16 a[244:245], v249 offset:24704
    ds_read_b64_tr_b16 a[246:247], v249 offset:26240
    ds_read_b64_tr_b16 a[248:249], v250 offset:24704
    ds_read_b64_tr_b16 a[250:251], v250 offset:26240
    s_waitcnt lgkmcnt(10)
    v_mfma_f32_16x16x32_bf16 a[96:99], a[224:227], a[64:67], a[96:99]
    ds_read_b64_tr_b16 a[252:253], v251 offset:24704
    s_add_u32 m0, 98304, s49
    s_add_u32 s67, s54, 3151872
    buffer_load_dwordx4 v24, s[16:19], s67 offen offset:0 lds
    v_mfma_f32_16x16x32_bf16 a[100:103], a[224:227], a[68:71], a[100:103]
    ds_read_b64_tr_b16 a[254:255], v251 offset:26240
    v_mfma_f32_16x16x32_bf16 a[108:111], a[228:231], a[68:71], a[108:111]
    ds_read_b64_tr_b16 a[224:225], v248 offset:24832
    v_mfma_f32_16x16x32_bf16 a[104:107], a[228:231], a[64:67], a[104:107]
    ds_read_b64_tr_b16 a[226:227], v248 offset:26368
    buffer_load_dwordx4 v25, s[16:19], s67 offen offset:1024 lds
    s_waitcnt lgkmcnt(10)
    v_mfma_f32_16x16x32_bf16 a[112:115], a[232:235], a[64:67], a[112:115]
    ds_read_b64_tr_b16 a[228:229], v249 offset:24832
    v_mfma_f32_16x16x32_bf16 a[116:119], a[232:235], a[68:71], a[116:119]
    ds_read_b64_tr_b16 a[230:231], v249 offset:26368
    v_mfma_f32_16x16x32_bf16 a[124:127], a[236:239], a[68:71], a[124:127]
    ds_read_b64_tr_b16 a[232:233], v250 offset:24832
    buffer_load_dwordx4 v26, s[16:19], s67 offen offset:2048 lds
    v_mfma_f32_16x16x32_bf16 a[120:123], a[236:239], a[64:67], a[120:123]
    ds_read_b64_tr_b16 a[234:235], v250 offset:26368
    s_waitcnt lgkmcnt(10)
    v_mfma_f32_16x16x32_bf16 a[128:131], a[240:243], a[64:67], a[128:131]
    ds_read_b64_tr_b16 a[236:237], v251 offset:24832
    v_mfma_f32_16x16x32_bf16 a[132:135], a[240:243], a[68:71], a[132:135]
    ds_read_b64_tr_b16 a[238:239], v251 offset:26368
    buffer_load_dwordx4 v27, s[16:19], s67 offen offset:3072 lds
    v_mfma_f32_16x16x32_bf16 a[140:143], a[244:247], a[68:71], a[140:143]
    v_mfma_f32_16x16x32_bf16 a[136:139], a[244:247], a[64:67], a[136:139]
    s_waitcnt lgkmcnt(8)
    v_mfma_f32_16x16x32_bf16 a[144:147], a[248:251], a[64:67], a[144:147]
    v_mfma_f32_16x16x32_bf16 a[148:151], a[248:251], a[68:71], a[148:151]
    v_mfma_f32_16x16x32_bf16 a[156:159], a[252:255], a[68:71], a[156:159]
    v_mfma_f32_16x16x32_bf16 a[152:155], a[252:255], a[64:67], a[152:155]
    s_waitcnt lgkmcnt(4)
    v_mfma_f32_16x16x32_bf16 a[160:163], a[224:227], a[64:67], a[160:163]
    v_mfma_f32_16x16x32_bf16 a[164:167], a[224:227], a[68:71], a[164:167]
    v_mfma_f32_16x16x32_bf16 a[172:175], a[228:231], a[68:71], a[172:175]
    v_mfma_f32_16x16x32_bf16 a[168:171], a[228:231], a[64:67], a[168:171]
    s_waitcnt lgkmcnt(0)
    v_mfma_f32_16x16x32_bf16 a[176:179], a[232:235], a[64:67], a[176:179]
    v_mfma_f32_16x16x32_bf16 a[180:183], a[232:235], a[68:71], a[180:183]
    v_mfma_f32_16x16x32_bf16 a[188:191], a[236:239], a[68:71], a[188:191]
    v_mfma_f32_16x16x32_bf16 a[184:187], a[236:239], a[64:67], a[184:187]
    s_branch L_bodyN
LH_qh_3:
    s_waitcnt lgkmcnt(0)
    ds_read_b64_tr_b16 a[224:225], v248 offset:36864
    ds_read_b64_tr_b16 a[226:227], v248 offset:38400
    ds_read_b64_tr_b16 a[228:229], v249 offset:36864
    ds_read_b64_tr_b16 a[230:231], v249 offset:38400
    ds_read_b64_tr_b16 a[232:233], v250 offset:36864
    ds_read_b64_tr_b16 a[234:235], v250 offset:38400
    ds_read_b64_tr_b16 a[236:237], v251 offset:36864
    ds_read_b64_tr_b16 a[238:239], v251 offset:38400
    ds_read_b64_tr_b16 a[240:241], v248 offset:36992
    ds_read_b64_tr_b16 a[242:243], v248 offset:38528
    ds_read_b64_tr_b16 a[244:245], v249 offset:36992
    ds_read_b64_tr_b16 a[246:247], v249 offset:38528
    ds_read_b64_tr_b16 a[248:249], v250 offset:36992
    ds_read_b64_tr_b16 a[250:251], v250 offset:38528
    s_waitcnt lgkmcnt(10)
    v_mfma_f32_16x16x32_bf16 a[96:99], a[224:227], a[72:75], a[96:99]
    ds_read_b64_tr_b16 a[252:253], v251 offset:36992
    s_add_u32 m0, 102400, s49
    s_add_u32 s67, s54, 3151872
    buffer_load_dwordx4 v28, s[16:19], s67 offen offset:0 lds
    v_mfma_f32_16x16x32_bf16 a[100:103], a[224:227], a[76:79], a[100:103]
    ds_read_b64_tr_b16 a[254:255], v251 offset:38528
    v_mfma_f32_16x16x32_bf16 a[108:111], a[228:231], a[76:79], a[108:111]
    ds_read_b64_tr_b16 a[224:225], v248 offset:37120
    v_mfma_f32_16x16x32_bf16 a[104:107], a[228:231], a[72:75], a[104:107]
    ds_read_b64_tr_b16 a[226:227], v248 offset:38656
    buffer_load_dwordx4 v29, s[16:19], s67 offen offset:1024 lds
    s_waitcnt lgkmcnt(10)
    v_mfma_f32_16x16x32_bf16 a[112:115], a[232:235], a[72:75], a[112:115]
    ds_read_b64_tr_b16 a[228:229], v249 offset:37120
    v_mfma_f32_16x16x32_bf16 a[116:119], a[232:235], a[76:79], a[116:119]
    ds_read_b64_tr_b16 a[230:231], v249 offset:38656
    v_mfma_f32_16x16x32_bf16 a[124:127], a[236:239], a[76:79], a[124:127]
    ds_read_b64_tr_b16 a[232:233], v250 offset:37120
    v_mfma_f32_16x16x32_bf16 a[120:123], a[236:239], a[72:75], a[120:123]
    ds_read_b64_tr_b16 a[234:235], v250 offset:38656
    s_waitcnt lgkmcnt(10)
    v_mfma_f32_16x16x32_bf16 a[128:131], a[240:243], a[72:75], a[128:131]
    ds_read_b64_tr_b16 a[236:237], v251 offset:37120
    v_mfma_f32_16x16x32_bf16 a[132:135], a[240:243], a[76:79], a[132:135]
    ds_read_b64_tr_b16 a[238:239], v251 offset:38656
    v_mfma_f32_16x16x32_bf16 a[140:143], a[244:247], a[76:79], a[140:143]
    v_mfma_f32_16x16x32_bf16 a[136:139], a[244:247], a[72:75], a[136:139]
    s_waitcnt lgkmcnt(8)
    v_mfma_f32_16x16x32_bf16 a[144:147], a[248:251], a[72:75], a[144:147]
    v_mfma_f32_16x16x32_bf16 a[148:151], a[248:251], a[76:79], a[148:151]
    v_mfma_f32_16x16x32_bf16 a[156:159], a[252:255], a[76:79], a[156:159]
    v_mfma_f32_16x16x32_bf16 a[152:155], a[252:255], a[72:75], a[152:155]
    s_waitcnt lgkmcnt(4)
    v_mfma_f32_16x16x32_bf16 a[160:163], a[224:227], a[72:75], a[160:163]
    v_mfma_f32_16x16x32_bf16 a[164:167], a[224:227], a[76:79], a[164:167]
    v_mfma_f32_16x16x32_bf16 a[172:175], a[228:231], a[76:79], a[172:175]
    v_mfma_f32_16x16x32_bf16 a[168:171], a[228:231], a[72:75], a[168:171]
    s_waitcnt lgkmcnt(0)
    v_mfma_f32_16x16x32_bf16 a[176:179], a[232:235], a[72:75], a[176:179]
    v_mfma_f32_16x16x32_bf16 a[180:183], a[232:235], a[76:79], a[180:183]
    v_mfma_f32_16x16x32_bf16 a[188:191], a[236:239], a[76:79], a[188:191]
    v_mfma_f32_16x16x32_bf16 a[184:187], a[236:239], a[72:75], a[184:187]
    s_branch L_bodyN
LH_qh_4:
    s_waitcnt lgkmcnt(0)
    ds_read_b64_tr_b16 a[224:225], v248 offset:0
    ds_read_b64_tr_b16 a[226:227], v248 offset:1536
    ds_read_b64_tr_b16 a[228:229], v249 offset:0
    ds_read_b64_tr_b16 a[230:231], v249 offset:1536
    ds_read_b64_tr_b16 a[232:233], v250 offset:0
    ds_read_b64_tr_b16 a[234:235], v250 offset:1536
    ds_read_b64_tr_b16 a[236:237], v251 offset:0
    ds_read_b64_tr_b16 a[238:239], v251 offset:1536
    ds_read_b64_tr_b16 a[240:241], v248 offset:128
    ds_read_b64_tr_b16 a[242:243], v248 offset:1664
    ds_read_b64_tr_b16 a[244:245], v249 offset:128
    ds_read_b64_tr_b16 a[246:247], v249 offset:1664
    ds_read_b64_tr_b16 a[248:249], v250 offset:128
    ds_read_b64_tr_b16 a[250:251], v250 offset:1664
    s_waitcnt lgkmcnt(10)
    v_mfma_f32_16x16x32_bf16 a[96:99], a[224:227], a[80:83], a[96:99]
    ds_read_b64_tr_b16 a[252:253], v251 offset:128
    v_mfma_f32_16x16x32_bf16 a[100:103], a[224:227], a[84:87], a[100:103]
    ds_read_b64_tr_b16 a[254:255], v251 offset:1664
    v_mfma_f32_16x16x32_bf16 a[108:111], a[228:231], a[84:87], a[108:111]
    ds_read_b64_tr_b16 a[224:225], v248 offset:256
    v_mfma_f32_16x16x32_bf16 a[104:107], a[228:231], a[80:83], a[104:107]
    ds_read_b64_tr_b16 a[226:227], v248 offset:1792
    s_waitcnt lgkmcnt(10)
    v_mfma_f32_16x16x32_bf16 a[112:115], a[232:235], a[80:83], a[112:115]
    ds_read_b64_tr_b16 a[228:229], v249 offset:256
    v_mfma_f32_16x16x32_bf16 a[116:119], a[232:235], a[84:87], a[116:119]
    ds_read_b64_tr_b16 a[230:231], v249 offset:1792
    v_mfma_f32_16x16x32_bf16 a[124:127], a[236:239], a[84:87], a[124:127]
    ds_read_b64_tr_b16 a[232:233], v250 offset:256
    v_mfma_f32_16x16x32_bf16 a[120:123], a[236:239], a[80:83], a[120:123]
    ds_read_b64_tr_b16 a[234:235], v250 offset:1792
    s_waitcnt lgkmcnt(10)
    v_mfma_f32_16x16x32_bf16 a[128:131], a[240:243], a[80:83], a[128:131]
    ds_read_b64_tr_b16 a[236:237], v251 offset:256
    v_mfma_f32_16x16x32_bf16 a[132:135], a[240:243], a[84:87], a[132:135]
    ds_read_b64_tr_b16 a[238:239], v251 offset:1792
    v_mfma_f32_16x16x32_bf16 a[140:143], a[244:247], a[84:87], a[140:143]
    v_mfma_f32_16x16x32_bf16 a[136:139], a[244:247], a[80:83], a[136:139]
    s_waitcnt lgkmcnt(8)
    v_mfma_f32_16x16x32_bf16 a[144:147], a[248:251], a[80:83], a[144:147]
    v_mfma_f32_16x16x32_bf16 a[148:151], a[248:251], a[84:87], a[148:151]
    v_mfma_f32_16x16x32_bf16 a[156:159], a[252:255], a[84:87], a[156:159]
    v_mfma_f32_16x16x32_bf16 a[152:155], a[252:255], a[80:83], a[152:155]
    s_waitcnt lgkmcnt(4)
    v_mfma_f32_16x16x32_bf16 a[160:163], a[224:227], a[80:83], a[160:163]
    v_mfma_f32_16x16x32_bf16 a[164:167], a[224:227], a[84:87], a[164:167]
    v_mfma_f32_16x16x32_bf16 a[172:175], a[228:231], a[84:87], a[172:175]
    v_mfma_f32_16x16x32_bf16 a[168:171], a[228:231], a[80:83], a[168:171]
    s_waitcnt lgkmcnt(0)
    v_mfma_f32_16x16x32_bf16 a[176:179], a[232:235], a[80:83], a[176:179]
    v_mfma_f32_16x16x32_bf16 a[180:183], a[232:235], a[84:87], a[180:183]
    v_mfma_f32_16x16x32_bf16 a[188:191], a[236:239], a[84:87], a[188:191]
    v_mfma_f32_16x16x32_bf16 a[184:187], a[236:239], a[80:83], a[184:187]
    s_branch L_bodyN
LH_qh_5:
    s_waitcnt lgkmcnt(0)
    ds_read_b64_tr_b16 a[224:225], v248 offset:12288
    ds_read_b64_tr_b16 a[226:227], v248 offset:13824
    ds_read_b64_tr_b16 a[228:229], v249 offset:12288
    ds_read_b64_tr_b16 a[230:231], v249 offset:13824
    ds_read_b64_tr_b16 a[232:233], v250 offset:12288
    ds_read_b64_tr_b16 a[234:235], v250 offset:13824
    ds_read_b64_tr_b16 a[236:237], v251 offset:12288
    ds_read_b64_tr_b16 a[238:239], v251 offset:13824
    ds_read_b64_tr_b16 a[240:241], v248 offset:12416
    ds_read_b64_tr_b16 a[242:243], v248 offset:13952
    ds_read_b64_tr_b16 a[244:245], v249 offset:12416
    ds_read_b64_tr_b16 a[246:247], v249 offset:13952
    ds_read_b64_tr_b16 a[248:249], v250 offset:12416
    ds_read_b64_tr_b16 a[250:251], v250 offset:13952
    s_waitcnt lgkmcnt(10)
    v_mfma_f32_16x16x32_bf16 a[96:99], a[224:227], a[88:91], a[96:99]
    ds_read_b64_tr_b16 a[252:253], v251 offset:12416
    v_mfma_f32_16x16x32_bf16 a[100:103], a[224:227], a[92:95], a[100:103]
    ds_read_b64_tr_b16 a[254:255], v251 offset:13952
    v_mfma_f32_16x16x32_bf16 a[108:111], a[228:231], a[92:95], a[108:111]
    ds_read_b64_tr_b16 a[224:225], v248 offset:12544
    v_mfma_f32_16x16x32_bf16 a[104:107], a[228:231], a[88:91], a[104:107]
    ds_read_b64_tr_b16 a[226:227], v248 offset:14080
    s_waitcnt lgkmcnt(10)
    v_mfma_f32_16x16x32_bf16 a[112:115], a[232:235], a[88:91], a[112:115]
    ds_read_b64_tr_b16 a[228:229], v249 offset:12544
    v_mfma_f32_16x16x32_bf16 a[116:119], a[232:235], a[92:95], a[116:119]
    ds_read_b64_tr_b16 a[230:231], v249 offset:14080
    v_mfma_f32_16x16x32_bf16 a[124:127], a[236:239], a[92:95], a[124:127]
    ds_read_b64_tr_b16 a[232:233], v250 offset:12544
    v_mfma_f32_16x16x32_bf16 a[120:123], a[236:239], a[88:91], a[120:123]
    ds_read_b64_tr_b16 a[234:235], v250 offset:14080
    s_waitcnt lgkmcnt(10)
    v_mfma_f32_16x16x32_bf16 a[128:131], a[240:243], a[88:91], a[128:131]
    ds_read_b64_tr_b16 a[236:237], v251 offset:12544
    v_mfma_f32_16x16x32_bf16 a[132:135], a[240:243], a[92:95], a[132:135]
    ds_read_b64_tr_b16 a[238:239], v251 offset:14080
    v_mfma_f32_16x16x32_bf16 a[140:143], a[244:247], a[92:95], a[140:143]
    v_mfma_f32_16x16x32_bf16 a[136:139], a[244:247], a[88:91], a[136:139]
    s_waitcnt lgkmcnt(8)
    v_mfma_f32_16x16x32_bf16 a[144:147], a[248:251], a[88:91], a[144:147]
    v_mfma_f32_16x16x32_bf16 a[148:151], a[248:251], a[92:95], a[148:151]
    v_mfma_f32_16x16x32_bf16 a[156:159], a[252:255], a[92:95], a[156:159]
    v_mfma_f32_16x16x32_bf16 a[152:155], a[252:255], a[88:91], a[152:155]
    s_waitcnt lgkmcnt(4)
    v_mfma_f32_16x16x32_bf16 a[160:163], a[224:227], a[88:91], a[160:163]
    v_mfma_f32_16x16x32_bf16 a[164:167], a[224:227], a[92:95], a[164:167]
    v_mfma_f32_16x16x32_bf16 a[172:175], a[228:231], a[92:95], a[172:175]
    v_mfma_f32_16x16x32_bf16 a[168:171], a[228:231], a[88:91], a[168:171]
    s_waitcnt lgkmcnt(0)
    v_mfma_f32_16x16x32_bf16 a[176:179], a[232:235], a[88:91], a[176:179]
    v_mfma_f32_16x16x32_bf16 a[180:183], a[232:235], a[92:95], a[180:183]
    v_mfma_f32_16x16x32_bf16 a[188:191], a[236:239], a[92:95], a[188:191]
    v_mfma_f32_16x16x32_bf16 a[184:187], a[236:239], a[88:91], a[184:187]
    s_branch L_bodyN
LH_h14:
    s_cmp_lg_u32 s48, 0
    s_cbranch_scc1 L_g4d
    v_mov_b32 v8, 1
    s_mov_b64 exec, 1
    buffer_atomic_add v8, off, s[84:87], 0 sc1
    s_mov_b64 exec, -1
L_g4d:
    s_add_u32 s52, s81, 0
    s_and_b32 s52, s52, 3
    s_lshl_b32 s53, s82, 2
    s_add_u32 s92, s52, s53
    s_add_u32 s52, s81, 1
    s_and_b32 s52, s52, 3
    s_lshl_b32 s53, s82, 2
    s_add_u32 s93, s52, s53
    s_add_u32 s52, s81, 2
    s_and_b32 s52, s52, 3
    s_lshl_b32 s53, s82, 2
    s_add_u32 s94, s52, s53
    s_add_u32 s52, s81, 3
    s_and_b32 s52, s52, 3
    s_lshl_b32 s53, s82, 2
    s_add_u32 s95, s52, s53
    v_accvgpr_read_b32 v224, a96
    v_accvgpr_read_b32 v225, a97
    v_accvgpr_read_b32 v226, a98
    v_accvgpr_read_b32 v227, a99
    v_accvgpr_read_b32 v228, a100
    v_accvgpr_read_b32 v229, a101
    v_accvgpr_read_b32 v230, a102
    v_accvgpr_read_b32 v231, a103
    v_accvgpr_read_b32 v232, a104
    v_accvgpr_read_b32 v233, a105
    v_accvgpr_read_b32 v234, a106
    v_accvgpr_read_b32 v235, a107
    v_accvgpr_read_b32 v236, a108
    v_accvgpr_read_b32 v237, a109
    v_accvgpr_read_b32 v238, a110
    v_accvgpr_read_b32 v239, a111
    v_pk_mul_f32 v[224:225], v[224:225], s[72:73]
    v_pk_mul_f32 v[226:227], v[226:227], s[72:73]
    v_pk_mul_f32 v[228:229], v[228:229], s[72:73]
    v_pk_mul_f32 v[230:231], v[230:231], s[72:73]
    v_pk_mul_f32 v[232:233], v[232:233], s[72:73]
    v_pk_mul_f32 v[234:235], v[234:235], s[72:73]
    v_pk_mul_f32 v[236:237], v[236:237], s[72:73]
    v_pk_mul_f32 v[238:239], v[238:239], s[72:73]
    v_cvt_pk_bf16_f32 v56, v224, v225
    v_cvt_pk_bf16_f32 v57, v226, v227
    v_cvt_pk_bf16_f32 v58, v232, v233
    v_cvt_pk_bf16_f32 v59, v234, v235
    v_cvt_pk_bf16_f32 v60, v228, v229
    v_cvt_pk_bf16_f32 v61, v230, v231
    v_cvt_pk_bf16_f32 v62, v236, v237
    v_cvt_pk_bf16_f32 v63, v238, v239
    v_permlane32_swap_b32 v56, v58
    v_permlane32_swap_b32 v57, v59
    v_permlane32_swap_b32 v60, v62
    v_permlane32_swap_b32 v61, v63
    v_permlane16_swap_b32 v56, v58
    v_permlane16_swap_b32 v57, v59
    v_permlane16_swap_b32 v60, v62
    v_permlane16_swap_b32 v61, v63
    v_accvgpr_write_b32 a0, v56
    v_accvgpr_write_b32 a1, v57
    v_accvgpr_write_b32 a2, v58
    v_accvgpr_write_b32 a3, v59
    v_accvgpr_write_b32 a4, v60
    v_accvgpr_write_b32 a5, v61
    v_accvgpr_write_b32 a6, v62
    v_accvgpr_write_b32 a7, v63
    v_accvgpr_read_b32 v224, a112
    v_accvgpr_read_b32 v225, a113
    v_accvgpr_read_b32 v226, a114
    v_accvgpr_read_b32 v227, a115
    v_accvgpr_read_b32 v228, a116
    v_accvgpr_read_b32 v229, a117
    v_accvgpr_read_b32 v230, a118
    v_accvgpr_read_b32 v231, a119
    v_accvgpr_read_b32 v232, a120
    v_accvgpr_read_b32 v233, a121
    v_accvgpr_read_b32 v234, a122
    v_accvgpr_read_b32 v235, a123
    v_accvgpr_read_b32 v236, a124
    v_accvgpr_read_b32 v237, a125
    v_accvgpr_read_b32 v238, a126
    v_accvgpr_read_b32 v239, a127
    v_pk_mul_f32 v[224:225], v[224:225], s[72:73]
    v_pk_mul_f32 v[226:227], v[226:227], s[72:73]
    v_pk_mul_f32 v[228:229], v[228:229], s[72:73]
    v_pk_mul_f32 v[230:231], v[230:231], s[72:73]
    v_pk_mul_f32 v[232:233], v[232:233], s[72:73]
    v_pk_mul_f32 v[234:235], v[234:235], s[72:73]
    v_pk_mul_f32 v[236:237], v[236:237], s[72:73]
    v_pk_mul_f32 v[238:239], v[238:239], s[72:73]
    v_cvt_pk_bf16_f32 v248, v224, v225
    v_cvt_pk_bf16_f32 v249, v226, v227
    v_cvt_pk_bf16_f32 v250, v232, v233
    v_cvt_pk_bf16_f32 v251, v234, v235
    v_cvt_pk_bf16_f32 v252, v228, v229
    v_cvt_pk_bf16_f32 v253, v230, v231
    v_cvt_pk_bf16_f32 v254, v236, v237
    v_cvt_pk_bf16_f32 v255, v238, v239
    v_permlane32_swap_b32 v248, v250
    v_permlane32_swap_b32 v249, v251
    v_permlane32_swap_b32 v252, v254
    v_permlane32_swap_b32 v253, v255
    v_permlane16_swap_b32 v248, v250
    v_permlane16_swap_b32 v249, v251
    v_permlane16_swap_b32 v252, v254
    v_permlane16_swap_b32 v253, v255
    v_accvgpr_write_b32 a8, v248
    v_accvgpr_write_b32 a9, v249
    v_accvgpr_write_b32 a10, v250
    v_accvgpr_write_b32 a11, v251
    v_accvgpr_write_b32 a12, v252
    v_accvgpr_write_b32 a13, v253
    v_accvgpr_write_b32 a14, v254
    v_accvgpr_write_b32 a15, v255
    v_accvgpr_read_b32 v224, a128
    v_accvgpr_read_b32 v225, a129
    v_accvgpr_read_b32 v226, a130
    v_accvgpr_read_b32 v227, a131
    v_accvgpr_read_b32 v228, a132
    v_accvgpr_read_b32 v229, a133
    v_accvgpr_read_b32 v230, a134
    v_accvgpr_read_b32 v231, a135
    v_accvgpr_read_b32 v232, a136
    v_accvgpr_read_b32 v233, a137
    v_accvgpr_read_b32 v234, a138
    v_accvgpr_read_b32 v235, a139
    v_accvgpr_read_b32 v236, a140
    v_accvgpr_read_b32 v237, a141
    v_accvgpr_read_b32 v238, a142
    v_accvgpr_read_b32 v239, a143
    v_pk_mul_f32 v[224:225], v[224:225], s[72:73]
    v_pk_mul_f32 v[226:227], v[226:227], s[72:73]
    v_pk_mul_f32 v[228:229], v[228:229], s[72:73]
    v_pk_mul_f32 v[230:231], v[230:231], s[72:73]
    v_pk_mul_f32 v[232:233], v[232:233], s[72:73]
    v_pk_mul_f32 v[234:235], v[234:235], s[72:73]
    v_pk_mul_f32 v[236:237], v[236:237], s[72:73]
    v_pk_mul_f32 v[238:239], v[238:239], s[72:73]
    v_cvt_pk_bf16_f32 v56, v224, v225
    v_cvt_pk_bf16_f32 v57, v226, v227
    v_cvt_pk_bf16_f32 v58, v232, v233
    v_cvt_pk_bf16_f32 v59, v234, v235
    v_cvt_pk_bf16_f32 v60, v228, v229
    v_cvt_pk_bf16_f32 v61, v230, v231
    v_cvt_pk_bf16_f32 v62, v236, v237
    v_cvt_pk_bf16_f32 v63, v238, v239
    v_permlane32_swap_b32 v56, v58
    v_permlane32_swap_b32 v57, v59
    v_permlane32_swap_b32 v60, v62
    v_permlane32_swap_b32 v61, v63
    v_permlane16_swap_b32 v56, v58
    v_permlane16_swap_b32 v57, v59
    v_permlane16_swap_b32 v60, v62
    v_permlane16_swap_b32 v61, v63
    v_accvgpr_write_b32 a16, v56
    v_accvgpr_write_b32 a17, v57
    v_accvgpr_write_b32 a18, v58
    v_accvgpr_write_b32 a19, v59
    v_accvgpr_write_b32 a20, v60
    v_accvgpr_write_b32 a21, v61
    v_accvgpr_write_b32 a22, v62
    v_accvgpr_write_b32 a23, v63
    v_accvgpr_read_b32 v224, a144
    v_accvgpr_read_b32 v225, a145
    v_accvgpr_read_b32 v226, a146
    v_accvgpr_read_b32 v227, a147
    v_accvgpr_read_b32 v228, a148
    v_accvgpr_read_b32 v229, a149
    v_accvgpr_read_b32 v230, a150
    v_accvgpr_read_b32 v231, a151
    v_accvgpr_read_b32 v232, a152
    v_accvgpr_read_b32 v233, a153
    v_accvgpr_read_b32 v234, a154
    v_accvgpr_read_b32 v235, a155
    v_accvgpr_read_b32 v236, a156
    v_accvgpr_read_b32 v237, a157
    v_accvgpr_read_b32 v238, a158
    v_accvgpr_read_b32 v239, a159
    v_pk_mul_f32 v[224:225], v[224:225], s[72:73]
    v_pk_mul_f32 v[226:227], v[226:227], s[72:73]
    v_pk_mul_f32 v[228:229], v[228:229], s[72:73]
    v_pk_mul_f32 v[230:231], v[230:231], s[72:73]
    v_pk_mul_f32 v[232:233], v[232:233], s[72:73]
    v_pk_mul_f32 v[234:235], v[234:235], s[72:73]
    v_pk_mul_f32 v[236:237], v[236:237], s[72:73]
    v_pk_mul_f32 v[238:239], v[238:239], s[72:73]
    v_cvt_pk_bf16_f32 v248, v224, v225
    v_cvt_pk_bf16_f32 v249, v226, v227
    v_cvt_pk_bf16_f32 v250, v232, v233
    v_cvt_pk_bf16_f32 v251, v234, v235
    v_cvt_pk_bf16_f32 v252, v228, v229
    v_cvt_pk_bf16_f32 v253, v230, v231
    v_cvt_pk_bf16_f32 v254, v236, v237
    v_cvt_pk_bf16_f32 v255, v238, v239
    v_permlane32_swap_b32 v248, v250
    v_permlane32_swap_b32 v249, v251
    v_permlane32_swap_b32 v252, v254
    v_permlane32_swap_b32 v253, v255
    v_permlane16_swap_b32 v248, v250
    v_permlane16_swap_b32 v249, v251
    v_permlane16_swap_b32 v252, v254
    v_permlane16_swap_b32 v253, v255
    v_accvgpr_write_b32 a24, v248
    v_accvgpr_write_b32 a25, v249
    v_accvgpr_write_b32 a26, v250
    v_accvgpr_write_b32 a27, v251
    v_accvgpr_write_b32 a28, v252
    v_accvgpr_write_b32 a29, v253
    v_accvgpr_write_b32 a30, v254
    v_accvgpr_write_b32 a31, v255
    v_accvgpr_read_b32 v224, a160
    v_accvgpr_read_b32 v225, a161
    v_accvgpr_read_b32 v226, a162
    v_accvgpr_read_b32 v227, a163
    v_accvgpr_read_b32 v228, a164
    v_accvgpr_read_b32 v229, a165
    v_accvgpr_read_b32 v230, a166
    v_accvgpr_read_b32 v231, a167
    v_accvgpr_read_b32 v232, a168
    v_accvgpr_read_b32 v233, a169
    v_accvgpr_read_b32 v234, a170
    v_accvgpr_read_b32 v235, a171
    v_accvgpr_read_b32 v236, a172
    v_accvgpr_read_b32 v237, a173
    v_accvgpr_read_b32 v238, a174
    v_accvgpr_read_b32 v239, a175
    v_pk_mul_f32 v[224:225], v[224:225], s[72:73]
    v_pk_mul_f32 v[226:227], v[226:227], s[72:73]
    v_pk_mul_f32 v[228:229], v[228:229], s[72:73]
    v_pk_mul_f32 v[230:231], v[230:231], s[72:73]
    v_pk_mul_f32 v[232:233], v[232:233], s[72:73]
    v_pk_mul_f32 v[234:235], v[234:235], s[72:73]
    v_pk_mul_f32 v[236:237], v[236:237], s[72:73]
    v_pk_mul_f32 v[238:239], v[238:239], s[72:73]
    v_cvt_pk_bf16_f32 v56, v224, v225
    v_cvt_pk_bf16_f32 v57, v226, v227
    v_cvt_pk_bf16_f32 v58, v232, v233
    v_cvt_pk_bf16_f32 v59, v234, v235
    v_cvt_pk_bf16_f32 v60, v228, v229
    v_cvt_pk_bf16_f32 v61, v230, v231
    v_cvt_pk_bf16_f32 v62, v236, v237
    v_cvt_pk_bf16_f32 v63, v238, v239
    v_permlane32_swap_b32 v56, v58
    v_permlane32_swap_b32 v57, v59
    v_permlane32_swap_b32 v60, v62
    v_permlane32_swap_b32 v61, v63
    v_permlane16_swap_b32 v56, v58
    v_permlane16_swap_b32 v57, v59
    v_permlane16_swap_b32 v60, v62
    v_permlane16_swap_b32 v61, v63
    v_accvgpr_write_b32 a32, v56
    v_accvgpr_write_b32 a33, v57
    v_accvgpr_write_b32 a34, v58
    v_accvgpr_write_b32 a35, v59
    v_accvgpr_write_b32 a36, v60
    v_accvgpr_write_b32 a37, v61
    v_accvgpr_write_b32 a38, v62
    v_accvgpr_write_b32 a39, v63
    v_accvgpr_read_b32 v224, a176
    v_accvgpr_read_b32 v225, a177
    v_accvgpr_read_b32 v226, a178
    v_accvgpr_read_b32 v227, a179
    v_accvgpr_read_b32 v228, a180
    v_accvgpr_read_b32 v229, a181
    v_accvgpr_read_b32 v230, a182
    v_accvgpr_read_b32 v231, a183
    v_accvgpr_read_b32 v232, a184
    v_accvgpr_read_b32 v233, a185
    v_accvgpr_read_b32 v234, a186
    v_accvgpr_read_b32 v235, a187
    v_accvgpr_read_b32 v236, a188
    v_accvgpr_read_b32 v237, a189
    v_accvgpr_read_b32 v238, a190
    v_accvgpr_read_b32 v239, a191
    v_pk_mul_f32 v[224:225], v[224:225], s[72:73]
    v_pk_mul_f32 v[226:227], v[226:227], s[72:73]
    v_pk_mul_f32 v[228:229], v[228:229], s[72:73]
    v_pk_mul_f32 v[230:231], v[230:231], s[72:73]
    v_pk_mul_f32 v[232:233], v[232:233], s[72:73]
    v_pk_mul_f32 v[234:235], v[234:235], s[72:73]
    v_pk_mul_f32 v[236:237], v[236:237], s[72:73]
    v_pk_mul_f32 v[238:239], v[238:239], s[72:73]
    v_cvt_pk_bf16_f32 v248, v224, v225
    v_cvt_pk_bf16_f32 v249, v226, v227
    v_cvt_pk_bf16_f32 v250, v232, v233
    v_cvt_pk_bf16_f32 v251, v234, v235
    v_cvt_pk_bf16_f32 v252, v228, v229
    v_cvt_pk_bf16_f32 v253, v230, v231
    v_cvt_pk_bf16_f32 v254, v236, v237
    v_cvt_pk_bf16_f32 v255, v238, v239
    v_permlane32_swap_b32 v248, v250
    v_permlane32_swap_b32 v249, v251
    v_permlane32_swap_b32 v252, v254
    v_permlane32_swap_b32 v253, v255
    v_permlane16_swap_b32 v248, v250
    v_permlane16_swap_b32 v249, v251
    v_permlane16_swap_b32 v252, v254
    v_permlane16_swap_b32 v253, v255
    v_accvgpr_write_b32 a40, v248
    v_accvgpr_write_b32 a41, v249
    v_accvgpr_write_b32 a42, v250
    v_accvgpr_write_b32 a43, v251
    v_accvgpr_write_b32 a44, v252
    v_accvgpr_write_b32 a45, v253
    v_accvgpr_write_b32 a46, v254
    v_accvgpr_write_b32 a47, v255
    s_mov_b32 s74, 0xff800000
    s_mov_b32 s75, 0xff800000
    s_mov_b32 s61, 0
    s_branch L_bodyN
LH_epi:
    v_mov_b32 v6, v2
    v_mov_b32 v7, v3
    s_nop 0
    v_permlane32_swap_b32 v2, v6
    v_permlane32_swap_b32 v3, v7
    v_add_f32 v2, v2, v6
    v_add_f32 v3, v3, v7
    v_mov_b32 v6, v2
    v_mov_b32 v7, v3
    s_nop 0
    v_permlane16_swap_b32 v2, v6
    v_permlane16_swap_b32 v3, v7
    v_add_f32 v2, v2, v6
    v_add_f32 v3, v3, v7
    v_rcp_f32 v6, v2
    v_rcp_f32 v10, v3
    v_rcp_f32 v7, v2
    v_rcp_f32 v11, v3
    v_pk_mul_f32 v[112:113], v[112:113], v[6:7]
    v_pk_mul_f32 v[114:115], v[114:115], v[6:7]
    v_pk_mul_f32 v[120:121], v[120:121], v[6:7]
    v_pk_mul_f32 v[122:123], v[122:123], v[6:7]
    v_cvt_pk_bf16_f32 v224, v112, v113
    v_cvt_pk_bf16_f32 v225, v114, v115
    v_cvt_pk_bf16_f32 v226, v120, v121
    v_cvt_pk_bf16_f32 v227, v122, v123
    v_accvgpr_write_b32 a48, v224
    v_accvgpr_write_b32 a49, v225
    v_accvgpr_write_b32 a50, v226
    v_accvgpr_write_b32 a51, v227
    v_pk_mul_f32 v[116:117], v[116:117], v[10:11]
    v_pk_mul_f32 v[118:119], v[118:119], v[10:11]
    v_pk_mul_f32 v[124:125], v[124:125], v[10:11]
    v_pk_mul_f32 v[126:127], v[126:127], v[10:11]
    v_cvt_pk_bf16_f32 v228, v116, v117
    v_cvt_pk_bf16_f32 v229, v118, v119
    v_cvt_pk_bf16_f32 v230, v124, v125
    v_cvt_pk_bf16_f32 v231, v126, v127
    v_accvgpr_write_b32 a52, v228
    v_accvgpr_write_b32 a53, v229
    v_accvgpr_write_b32 a54, v230
    v_accvgpr_write_b32 a55, v231
    v_mov_b64 v[112:113], 0
    v_mov_b64 v[114:115], 0
    v_mov_b64 v[116:117], 0
    v_mov_b64 v[118:119], 0
    v_mov_b64 v[120:121], 0
    v_mov_b64 v[122:123], 0
    v_mov_b64 v[124:125], 0
    v_mov_b64 v[126:127], 0
    v_pk_mul_f32 v[128:129], v[128:129], v[6:7]
    v_pk_mul_f32 v[130:131], v[130:131], v[6:7]
    v_pk_mul_f32 v[136:137], v[136:137], v[6:7]
    v_pk_mul_f32 v[138:139], v[138:139], v[6:7]
    v_cvt_pk_bf16_f32 v232, v128, v129
    v_cvt_pk_bf16_f32 v233, v130, v131
    v_cvt_pk_bf16_f32 v234, v136, v137
    v_cvt_pk_bf16_f32 v235, v138, v139
    v_accvgpr_write_b32 a56, v232
    v_accvgpr_write_b32 a57, v233
    v_accvgpr_write_b32 a58, v234
    v_accvgpr_write_b32 a59, v235
    v_pk_mul_f32 v[132:133], v[132:133], v[10:11]
    v_pk_mul_f32 v[134:135], v[134:135], v[10:11]
    v_pk_mul_f32 v[140:141], v[140:141], v[10:11]
    v_pk_mul_f32 v[142:143], v[142:143], v[10:11]
    v_cvt_pk_bf16_f32 v236, v132, v133
    v_cvt_pk_bf16_f32 v237, v134, v135
    v_cvt_pk_bf16_f32 v238, v140, v141
    v_cvt_pk_bf16_f32 v239, v142, v143
    v_accvgpr_write_b32 a60, v236
    v_accvgpr_write_b32 a61, v237
    v_accvgpr_write_b32 a62, v238
    v_accvgpr_write_b32 a63, v239
    v_mov_b64 v[128:129], 0
    v_mov_b64 v[130:131], 0
    v_mov_b64 v[132:133], 0
    v_mov_b64 v[134:135], 0
    v_mov_b64 v[136:137], 0
    v_mov_b64 v[138:139], 0
    v_mov_b64 v[140:141], 0
    v_mov_b64 v[142:143], 0
    v_pk_mul_f32 v[144:145], v[144:145], v[6:7]
    v_pk_mul_f32 v[146:147], v[146:147], v[6:7]
    v_pk_mul_f32 v[152:153], v[152:153], v[6:7]
    v_pk_mul_f32 v[154:155], v[154:155], v[6:7]
    v_cvt_pk_bf16_f32 v224, v144, v145
    v_cvt_pk_bf16_f32 v225, v146, v147
    v_cvt_pk_bf16_f32 v226, v152, v153
    v_cvt_pk_bf16_f32 v227, v154, v155
    v_accvgpr_write_b32 a64, v224
    v_accvgpr_write_b32 a65, v225
    v_accvgpr_write_b32 a66, v226
    v_accvgpr_write_b32 a67, v227
    v_pk_mul_f32 v[148:149], v[148:149], v[10:11]
    v_pk_mul_f32 v[150:151], v[150:151], v[10:11]
    v_pk_mul_f32 v[156:157], v[156:157], v[10:11]
    v_pk_mul_f32 v[158:159], v[158:159], v[10:11]
    v_cvt_pk_bf16_f32 v228, v148, v149
    v_cvt_pk_bf16_f32 v229, v150, v151
    v_cvt_pk_bf16_f32 v230, v156, v157
    v_cvt_pk_bf16_f32 v231, v158, v159
    v_accvgpr_write_b32 a68, v228
    v_accvgpr_write_b32 a69, v229
    v_accvgpr_write_b32 a70, v230
    v_accvgpr_write_b32 a71, v231
    v_mov_b64 v[144:145], 0
    v_mov_b64 v[146:147], 0
    v_mov_b64 v[148:149], 0
    v_mov_b64 v[150:151], 0
    v_mov_b64 v[152:153], 0
    v_mov_b64 v[154:155], 0
    v_mov_b64 v[156:157], 0
    v_mov_b64 v[158:159], 0
    v_pk_mul_f32 v[160:161], v[160:161], v[6:7]
    v_pk_mul_f32 v[162:163], v[162:163], v[6:7]
    v_pk_mul_f32 v[168:169], v[168:169], v[6:7]
    v_pk_mul_f32 v[170:171], v[170:171], v[6:7]
    v_cvt_pk_bf16_f32 v232, v160, v161
    v_cvt_pk_bf16_f32 v233, v162, v163
    v_cvt_pk_bf16_f32 v234, v168, v169
    v_cvt_pk_bf16_f32 v235, v170, v171
    v_accvgpr_write_b32 a72, v232
    v_accvgpr_write_b32 a73, v233
    v_accvgpr_write_b32 a74, v234
    v_accvgpr_write_b32 a75, v235
    v_pk_mul_f32 v[164:165], v[164:165], v[10:11]
    v_pk_mul_f32 v[166:167], v[166:167], v[10:11]
    v_pk_mul_f32 v[172:173], v[172:173], v[10:11]
    v_pk_mul_f32 v[174:175], v[174:175], v[10:11]
    v_cvt_pk_bf16_f32 v236, v164, v165
    v_cvt_pk_bf16_f32 v237, v166, v167
    v_cvt_pk_bf16_f32 v238, v172, v173
    v_cvt_pk_bf16_f32 v239, v174, v175
    v_accvgpr_write_b32 a76, v236
    v_accvgpr_write_b32 a77, v237
    v_accvgpr_write_b32 a78, v238
    v_accvgpr_write_b32 a79, v239
    v_mov_b64 v[160:161], 0
    v_mov_b64 v[162:163], 0
    v_mov_b64 v[164:165], 0
    v_mov_b64 v[166:167], 0
    v_mov_b64 v[168:169], 0
    v_mov_b64 v[170:171], 0
    v_mov_b64 v[172:173], 0
    v_mov_b64 v[174:175], 0
    v_pk_mul_f32 v[176:177], v[176:177], v[6:7]
    v_pk_mul_f32 v[178:179], v[178:179], v[6:7]
    v_pk_mul_f32 v[184:185], v[184:185], v[6:7]
    v_pk_mul_f32 v[186:187], v[186:187], v[6:7]
    v_cvt_pk_bf16_f32 v224, v176, v177
    v_cvt_pk_bf16_f32 v225, v178, v179
    v_cvt_pk_bf16_f32 v226, v184, v185
    v_cvt_pk_bf16_f32 v227, v186, v187
    v_accvgpr_write_b32 a80, v224
    v_accvgpr_write_b32 a81, v225
    v_accvgpr_write_b32 a82, v226
    v_accvgpr_write_b32 a83, v227
    v_pk_mul_f32 v[180:181], v[180:181], v[10:11]
    v_pk_mul_f32 v[182:183], v[182:183], v[10:11]
    v_pk_mul_f32 v[188:189], v[188:189], v[10:11]
    v_pk_mul_f32 v[190:191], v[190:191], v[10:11]
    v_cvt_pk_bf16_f32 v228, v180, v181
    v_cvt_pk_bf16_f32 v229, v182, v183
    v_cvt_pk_bf16_f32 v230, v188, v189
    v_cvt_pk_bf16_f32 v231, v190, v191
    v_accvgpr_write_b32 a84, v228
    v_accvgpr_write_b32 a85, v229
    v_accvgpr_write_b32 a86, v230
    v_accvgpr_write_b32 a87, v231
    v_mov_b64 v[176:177], 0
    v_mov_b64 v[178:179], 0
    v_mov_b64 v[180:181], 0
    v_mov_b64 v[182:183], 0
    v_mov_b64 v[184:185], 0
    v_mov_b64 v[186:187], 0
    v_mov_b64 v[188:189], 0
    v_mov_b64 v[190:191], 0
    v_pk_mul_f32 v[192:193], v[192:193], v[6:7]
    v_pk_mul_f32 v[194:195], v[194:195], v[6:7]
    v_pk_mul_f32 v[200:201], v[200:201], v[6:7]
    v_pk_mul_f32 v[202:203], v[202:203], v[6:7]
    v_cvt_pk_bf16_f32 v232, v192, v193
    v_cvt_pk_bf16_f32 v233, v194, v195
    v_cvt_pk_bf16_f32 v234, v200, v201
    v_cvt_pk_bf16_f32 v235, v202, v203
    v_accvgpr_write_b32 a88, v232
    v_accvgpr_write_b32 a89, v233
    v_accvgpr_write_b32 a90, v234
    v_accvgpr_write_b32 a91, v235
    v_pk_mul_f32 v[196:197], v[196:197], v[10:11]
    v_pk_mul_f32 v[198:199], v[198:199], v[10:11]
    v_pk_mul_f32 v[204:205], v[204:205], v[10:11]
    v_pk_mul_f32 v[206:207], v[206:207], v[10:11]
    v_cvt_pk_bf16_f32 v236, v196, v197
    v_cvt_pk_bf16_f32 v237, v198, v199
    v_cvt_pk_bf16_f32 v238, v204, v205
    v_cvt_pk_bf16_f32 v239, v206, v207
    v_accvgpr_write_b32 a92, v236
    v_accvgpr_write_b32 a93, v237
    v_accvgpr_write_b32 a94, v238
    v_accvgpr_write_b32 a95, v239
    v_mov_b64 v[192:193], 0
    v_mov_b64 v[194:195], 0
    v_mov_b64 v[196:197], 0
    v_mov_b64 v[198:199], 0
    v_mov_b64 v[200:201], 0
    v_mov_b64 v[202:203], 0
    v_mov_b64 v[204:205], 0
    v_mov_b64 v[206:207], 0
    v_mov_b64 v[2:3], 0
    s_branch L_bodyN
LH_g4:
    v_add_u32 v8, 0, v0
    v_mul_u32_u24 v9, 3277, v8
    v_lshrrev_b32 v9, 16, v9
    v_lshlrev_b32 v10, 3, v9
    v_and_b32 v10, 32, v10
    v_xor_b32 v10, v10, v35
    v_mul_u32_u24 v9, 960, v9
    v_add_u32 v24, v9, v10
    v_add_u32 v8, 64, v0
    v_mul_u32_u24 v9, 3277, v8
    v_lshrrev_b32 v9, 16, v9
    v_lshlrev_b32 v10, 3, v9
    v_and_b32 v10, 32, v10
    v_xor_b32 v10, v10, v35
    v_mul_u32_u24 v9, 960, v9
    v_add_u32 v25, v9, v10
    v_add_u32 v8, 128, v0
    v_mul_u32_u24 v9, 3277, v8
    v_lshrrev_b32 v9, 16, v9
    v_lshlrev_b32 v10, 3, v9
    v_and_b32 v10, 32, v10
    v_xor_b32 v10, v10, v35
    v_mul_u32_u24 v9, 960, v9
    v_add_u32 v26, v9, v10
    v_add_u32 v8, 192, v0
    v_mul_u32_u24 v9, 3277, v8
    v_lshrrev_b32 v9, 16, v9
    v_lshlrev_b32 v10, 3, v9
    v_and_b32 v10, 32, v10
    v_xor_b32 v10, v10, v35
    v_mul_u32_u24 v9, 960, v9
    v_add_u32 v27, v9, v10
    v_add_u32 v8, 256, v0
    v_mul_u32_u24 v9, 3277, v8
    v_lshrrev_b32 v9, 16, v9
    v_lshlrev_b32 v10, 3, v9
    v_and_b32 v10, 32, v10
    v_xor_b32 v10, v10, v35
    v_mul_u32_u24 v9, 960, v9
    v_add_u32 v28, v9, v10
    v_add_u32 v28, 4096, v28
    s_mul_i32 s54, s48, 20480
    s_mul_i32 s52, s81, 320
    s_add_u32 s54, s54, s52
    s_mul_i32 s20, s92, 245760
    s_add_u32 s20, s20, s54
    s_mul_i32 s21, s93, 245760
    s_add_u32 s21, s21, s54
    s_mul_i32 s22, s94, 245760
    s_add_u32 s22, s22, s54
    s_mul_i32 s23, s95, 245760
    s_add_u32 s23, s23, s54
    v_lshrrev_b32 v8, 2, v0
    v_mul_u32_u24 v8, 320, v8
    v_and_b32 v9, 3, v0
    v_lshl_add_u32 v8, v9, 3, v8
    v_bfe_u32 v9, v0, 4, 1
    s_lshr_b32 s52, s82, 1
    s_xor_b32 s53, s52, 0
    s_mul_i32 s53, s53, 5
    s_add_u32 s67, s53, 0
    v_xor_b32 v10, s67, v9
    v_lshl_add_u32 v44, v10, 5, v8
    s_add_u32 s67, s53, 1
    v_xor_b32 v10, s67, v9
    v_subrev_u32 v10, 1, v10
    v_lshl_add_u32 v45, v10, 5, v8
    s_xor_b32 s53, s52, 1
    s_mul_i32 s53, s53, 5
    s_add_u32 s67, s53, 0
    v_xor_b32 v10, s67, v9
    v_lshl_add_u32 v46, v10, 5, v8
    s_add_u32 s67, s53, 1
    v_xor_b32 v10, s67, v9
    v_subrev_u32 v10, 1, v10
    v_lshl_add_u32 v47, v10, 5, v8
    s_add_u32 m0, s83, 102400
    s_add_u32 s67, s20, 0
    buffer_load_dwordx4 v24, s[28:31], s67 offen offset:0 lds
    buffer_load_dwordx4 v25, s[28:31], s67 offen offset:1024 lds
    buffer_load_dwordx4 v26, s[28:31], s67 offen offset:2048 lds
    buffer_load_dwordx4 v27, s[28:31], s67 offen offset:3072 lds
    s_add_u32 m0, m0, 4096
    s_nop 0
    buffer_load_dwordx4 v28, s[28:31], s67 offen offset:0 lds
    v_add_u32 v248, 102400, v44
    v_add_u32 v249, 102400, v45
    v_add_u32 v250, 102400, v46
    v_add_u32 v251, 102400, v47
    s_branch L_bodyN
LH_ow_0:
    s_waitcnt lgkmcnt(0)
    ds_read_b64_tr_b16 a[224:225], v248 offset:0
    ds_read_b64_tr_b16 a[226:227], v248 offset:5120
    ds_read_b64_tr_b16 a[228:229], v249 offset:32
    ds_read_b64_tr_b16 a[230:231], v249 offset:5152
    ds_read_b64_tr_b16 a[232:233], v248 offset:64
    ds_read_b64_tr_b16 a[234:235], v248 offset:5184
    ds_read_b64_tr_b16 a[236:237], v249 offset:96
    ds_read_b64_tr_b16 a[238:239], v249 offset:5216
    ds_read_b64_tr_b16 a[240:241], v248 offset:128
    ds_read_b64_tr_b16 a[242:243], v248 offset:5248
    ds_read_b64_tr_b16 a[244:245], v250 offset:0
    ds_read_b64_tr_b16 a[246:247], v250 offset:5120
    ds_read_b64_tr_b16 a[248:249], v251 offset:32
    ds_read_b64_tr_b16 a[250:251], v251 offset:5152
    s_waitcnt lgkmcnt(8)
    v_mfma_f32_16x16x32_bf16 a[96:99], a[224:227], a[48:51], 0
    ds_read_b64_tr_b16 a[252:253], v250 offset:64
    s_add_u32 m0, s83, 122880
    s_add_u32 s67, s20, 81920
    buffer_load_dwordx4 v24, s[28:31], s67 offen offset:0 lds
    v_mfma_f32_16x16x32_bf16 a[100:103], a[224:227], a[52:55], 0
    ds_read_b64_tr_b16 a[254:255], v250 offset:5184
    v_mfma_f32_16x16x32_bf16 a[108:111], a[228:231], a[52:55], 0
    ds_read_b64_tr_b16 a[224:225], v251 offset:96
    v_mfma_f32_16x16x32_bf16 a[104:107], a[228:231], a[48:51], 0
    ds_read_b64_tr_b16 a[226:227], v251 offset:5216
    buffer_load_dwordx4 v25, s[28:31], s67 offen offset:1024 lds
    v_mfma_f32_16x16x32_bf16 a[112:115], a[232:235], a[48:51], 0
    ds_read_b64_tr_b16 a[228:229], v250 offset:128
    v_mfma_f32_16x16x32_bf16 a[116:119], a[232:235], a[52:55], 0
    ds_read_b64_tr_b16 a[230:231], v250 offset:5248
    s_waitcnt lgkmcnt(8)
    v_mfma_f32_16x16x32_bf16 a[124:127], a[236:239], a[52:55], 0
    ds_read_b64_tr_b16 a[232:233], v248 offset:10240
    buffer_load_dwordx4 v26, s[28:31], s67 offen offset:2048 lds
    v_mfma_f32_16x16x32_bf16 a[120:123], a[236:239], a[48:51], 0
    ds_read_b64_tr_b16 a[234:235], v248 offset:15360
    v_mfma_f32_16x16x32_bf16 a[128:131], a[240:243], a[48:51], 0
    ds_read_b64_tr_b16 a[236:237], v249 offset:10272
    v_mfma_f32_16x16x32_bf16 a[132:135], a[240:243], a[52:55], 0
    ds_read_b64_tr_b16 a[238:239], v249 offset:15392
    buffer_load_dwordx4 v27, s[28:31], s67 offen offset:3072 lds
    s_add_u32 m0, m0, 4096
    v_mfma_f32_16x16x32_bf16 a[140:143], a[244:247], a[52:55], 0
    ds_read_b64_tr_b16 a[240:241], v248 offset:10304
    v_mfma_f32_16x16x32_bf16 a[136:139], a[244:247], a[48:51], 0
    ds_read_b64_tr_b16 a[242:243], v248 offset:15424
    s_waitcnt lgkmcnt(8)
    v_mfma_f32_16x16x32_bf16 a[144:147], a[248:251], a[48:51], 0
    ds_read_b64_tr_b16 a[244:245], v249 offset:10336
    buffer_load_dwordx4 v28, s[28:31], s67 offen offset:0 lds
    v_mfma_f32_16x16x32_bf16 a[148:151], a[248:251], a[52:55], 0
    ds_read_b64_tr_b16 a[246:247], v249 offset:15456
    v_mfma_f32_16x16x32_bf16 a[156:159], a[252:255], a[52:55], 0
    ds_read_b64_tr_b16 a[248:249], v248 offset:10368
    v_mfma_f32_16x16x32_bf16 a[152:155], a[252:255], a[48:51], 0
    ds_read_b64_tr_b16 a[250:251], v248 offset:15488
    v_mfma_f32_16x16x32_bf16 a[160:163], a[224:227], a[48:51], 0
    ds_read_b64_tr_b16 a[252:253], v250 offset:10240
    v_mfma_f32_16x16x32_bf16 a[164:167], a[224:227], a[52:55], 0
    ds_read_b64_tr_b16 a[254:255], v250 offset:15360
    s_waitcnt lgkmcnt(8)
    v_mfma_f32_16x16x32_bf16 a[172:175], a[228:231], a[52:55], 0
    ds_read_b64_tr_b16 a[224:225], v251 offset:10272
    v_mfma_f32_16x16x32_bf16 a[168:171], a[228:231], a[48:51], 0
    ds_read_b64_tr_b16 a[226:227], v251 offset:15392
    v_mfma_f32_16x16x32_bf16 a[96:99], a[232:235], a[56:59], a[96:99]
    ds_read_b64_tr_b16 a[228:229], v250 offset:10304
    v_mfma_f32_16x16x32_bf16 a[100:103], a[232:235], a[60:63], a[100:103]
    ds_read_b64_tr_b16 a[230:231], v250 offset:15424
    v_mfma_f32_16x16x32_bf16 a[108:111], a[236:239], a[60:63], a[108:111]
    ds_read_b64_tr_b16 a[232:233], v251 offset:10336
    v_mfma_f32_16x16x32_bf16 a[104:107], a[236:239], a[56:59], a[104:107]
    ds_read_b64_tr_b16 a[234:235], v251 offset:15456
    s_waitcnt lgkmcnt(8)
    v_mfma_f32_16x16x32_bf16 a[112:115], a[240:243], a[56:59], a[112:115]
    ds_read_b64_tr_b16 a[236:237], v250 offset:10368
    v_mfma_f32_16x16x32_bf16 a[116:119], a[240:243], a[60:63], a[116:119]
    ds_read_b64_tr_b16 a[238:239], v250 offset:15488
    v_mfma_f32_16x16x32_bf16 a[124:127], a[244:247], a[60:63], a[124:127]
    v_mfma_f32_16x16x32_bf16 a[120:123], a[244:247], a[56:59], a[120:123]
    v_mfma_f32_16x16x32_bf16 a[128:131], a[248:251], a[56:59], a[128:131]
    v_mfma_f32_16x16x32_bf16 a[132:135], a[248:251], a[60:63], a[132:135]
    s_waitcnt lgkmcnt(4)
    v_mfma_f32_16x16x32_bf16 a[140:143], a[252:255], a[60:63], a[140:143]
    v_mfma_f32_16x16x32_bf16 a[136:139], a[252:255], a[56:59], a[136:139]
    v_mfma_f32_16x16x32_bf16 a[144:147], a[224:227], a[56:59], a[144:147]
    v_mfma_f32_16x16x32_bf16 a[148:151], a[224:227], a[60:63], a[148:151]
    v_mfma_f32_16x16x32_bf16 a[156:159], a[228:231], a[60:63], a[156:159]
    v_mfma_f32_16x16x32_bf16 a[152:155], a[228:231], a[56:59], a[152:155]
    s_waitcnt lgkmcnt(0)
    v_mfma_f32_16x16x32_bf16 a[160:163], a[232:235], a[56:59], a[160:163]
    v_mfma_f32_16x16x32_bf16 a[164:167], a[232:235], a[60:63], a[164:167]
    v_mfma_f32_16x16x32_bf16 a[172:175], a[236:239], a[60:63], a[172:175]
    v_mfma_f32_16x16x32_bf16 a[168:171], a[236:239], a[56:59], a[168:171]
    s_branch L_bodyN
LH_ow_1:
    s_waitcnt lgkmcnt(0)
    ds_read_b64_tr_b16 a[224:225], v248 offset:20480
    ds_read_b64_tr_b16 a[226:227], v248 offset:25600
    ds_read_b64_tr_b16 a[228:229], v249 offset:20512
    ds_read_b64_tr_b16 a[230:231], v249 offset:25632
    ds_read_b64_tr_b16 a[232:233], v248 offset:20544
    ds_read_b64_tr_b16 a[234:235], v248 offset:25664
    ds_read_b64_tr_b16 a[236:237], v249 offset:20576
    ds_read_b64_tr_b16 a[238:239], v249 offset:25696
    ds_read_b64_tr_b16 a[240:241], v248 offset:20608
    ds_read_b64_tr_b16 a[242:243], v248 offset:25728
    ds_read_b64_tr_b16 a[244:245], v250 offset:20480
    ds_read_b64_tr_b16 a[246:247], v250 offset:25600
    ds_read_b64_tr_b16 a[248:249], v251 offset:20512
    ds_read_b64_tr_b16 a[250:251], v251 offset:25632
    s_waitcnt lgkmcnt(8)
    v_mfma_f32_16x16x32_bf16 a[96:99], a[224:227], a[64:67], a[96:99]
    ds_read_b64_tr_b16 a[252:253], v250 offset:20544
    s_add_u32 m0, s83, 143360
    s_add_u32 s67, s20, 163840
    buffer_load_dwordx4 v24, s[28:31], s67 offen offset:0 lds
    v_mfma_f32_16x16x32_bf16 a[100:103], a[224:227], a[68:71], a[100:103]
    ds_read_b64_tr_b16 a[254:255], v250 offset:25664
    v_mfma_f32_16x16x32_bf16 a[108:111], a[228:231], a[68:71], a[108:111]
    ds_read_b64_tr_b16 a[224:225], v251 offset:20576
    v_mfma_f32_16x16x32_bf16 a[104:107], a[228:231], a[64:67], a[104:107]
    ds_read_b64_tr_b16 a[226:227], v251 offset:25696
    buffer_load_dwordx4 v25, s[28:31], s67 offen offset:1024 lds
    v_mfma_f32_16x16x32_bf16 a[112:115], a[232:235], a[64:67], a[112:115]
    ds_read_b64_tr_b16 a[228:229], v250 offset:20608
    v_mfma_f32_16x16x32_bf16 a[116:119], a[232:235], a[68:71], a[116:119]
    ds_read_b64_tr_b16 a[230:231], v250 offset:25728
    s_waitcnt lgkmcnt(8)
    v_mfma_f32_16x16x32_bf16 a[124:127], a[236:239], a[68:71], a[124:127]
    ds_read_b64_tr_b16 a[232:233], v248 offset:30720
    buffer_load_dwordx4 v26, s[28:31], s67 offen offset:2048 lds
    v_mfma_f32_16x16x32_bf16 a[120:123], a[236:239], a[64:67], a[120:123]
    ds_read_b64_tr_b16 a[234:235], v248 offset:35840
    v_mfma_f32_16x16x32_bf16 a[128:131], a[240:243], a[64:67], a[128:131]
    ds_read_b64_tr_b16 a[236:237], v249 offset:30752
    v_mfma_f32_16x16x32_bf16 a[132:135], a[240:243], a[68:71], a[132:135]
    ds_read_b64_tr_b16 a[238:239], v249 offset:35872
    buffer_load_dwordx4 v27, s[28:31], s67 offen offset:3072 lds
    s_add_u32 m0, m0, 4096
    v_mfma_f32_16x16x32_bf16 a[140:143], a[244:247], a[68:71], a[140:143]
    ds_read_b64_tr_b16 a[240:241], v248 offset:30784
    v_mfma_f32_16x16x32_bf16 a[136:139], a[244:247], a[64:67], a[136:139]
    ds_read_b64_tr_b16 a[242:243], v248 offset:35904
    s_waitcnt lgkmcnt(8)
    v_mfma_f32_16x16x32_bf16 a[144:147], a[248:251], a[64:67], a[144:147]
    ds_read_b64_tr_b16 a[244:245], v249 offset:30816
    buffer_load_dwordx4 v28, s[28:31], s67 offen offset:0 lds
    v_mfma_f32_16x16x32_bf16 a[148:151], a[248:251], a[68:71], a[148:151]
    ds_read_b64_tr_b16 a[246:247], v249 offset:35936
    v_mfma_f32_16x16x32_bf16 a[156:159], a[252:255], a[68:71], a[156:159]
    ds_read_b64_tr_b16 a[248:249], v248 offset:30848
    v_mfma_f32_16x16x32_bf16 a[152:155], a[252:255], a[64:67], a[152:155]
    ds_read_b64_tr_b16 a[250:251], v248 offset:35968
    v_mfma_f32_16x16x32_bf16 a[160:163], a[224:227], a[64:67], a[160:163]
    ds_read_b64_tr_b16 a[252:253], v250 offset:30720
    v_mfma_f32_16x16x32_bf16 a[164:167], a[224:227], a[68:71], a[164:167]
    ds_read_b64_tr_b16 a[254:255], v250 offset:35840
    s_waitcnt lgkmcnt(8)
    v_mfma_f32_16x16x32_bf16 a[172:175], a[228:231], a[68:71], a[172:175]
    ds_read_b64_tr_b16 a[224:225], v251 offset:30752
    v_mfma_f32_16x16x32_bf16 a[168:171], a[228:231], a[64:67], a[168:171]
    ds_read_b64_tr_b16 a[226:227], v251 offset:35872
    v_mfma_f32_16x16x32_bf16 a[96:99], a[232:235], a[72:75], a[96:99]
    ds_read_b64_tr_b16 a[228:229], v250 offset:30784
    v_mfma_f32_16x16x32_bf16 a[100:103], a[232:235], a[76:79], a[100:103]
    ds_read_b64_tr_b16 a[230:231], v250 offset:35904
    v_mfma_f32_16x16x32_bf16 a[108:111], a[236:239], a[76:79], a[108:111]
    ds_read_b64_tr_b16 a[232:233], v251 offset:30816
    v_mfma_f32_16x16x32_bf16 a[104:107], a[236:239], a[72:75], a[104:107]
    ds_read_b64_tr_b16 a[234:235], v251 offset:35936
    s_waitcnt lgkmcnt(8)
    v_mfma_f32_16x16x32_bf16 a[112:115], a[240:243], a[72:75], a[112:115]
    ds_read_b64_tr_b16 a[236:237], v250 offset:30848
    v_mfma_f32_16x16x32_bf16 a[116:119], a[240:243], a[76:79], a[116:119]
    ds_read_b64_tr_b16 a[238:239], v250 offset:35968
    v_mfma_f32_16x16x32_bf16 a[124:127], a[244:247], a[76:79], a[124:127]
    v_mfma_f32_16x16x32_bf16 a[120:123], a[244:247], a[72:75], a[120:123]
    v_mfma_f32_16x16x32_bf16 a[128:131], a[248:251], a[72:75], a[128:131]
    v_mfma_f32_16x16x32_bf16 a[132:135], a[248:251], a[76:79], a[132:135]
    s_waitcnt lgkmcnt(4)
    v_mfma_f32_16x16x32_bf16 a[140:143], a[252:255], a[76:79], a[140:143]
    v_mfma_f32_16x16x32_bf16 a[136:139], a[252:255], a[72:75], a[136:139]
    v_mfma_f32_16x16x32_bf16 a[144:147], a[224:227], a[72:75], a[144:147]
    v_mfma_f32_16x16x32_bf16 a[148:151], a[224:227], a[76:79], a[148:151]
    v_mfma_f32_16x16x32_bf16 a[156:159], a[228:231], a[76:79], a[156:159]
    v_mfma_f32_16x16x32_bf16 a[152:155], a[228:231], a[72:75], a[152:155]
    s_waitcnt lgkmcnt(0)
    v_mfma_f32_16x16x32_bf16 a[160:163], a[232:235], a[72:75], a[160:163]
    v_mfma_f32_16x16x32_bf16 a[164:167], a[232:235], a[76:79], a[164:167]
    v_mfma_f32_16x16x32_bf16 a[172:175], a[236:239], a[76:79], a[172:175]
    v_mfma_f32_16x16x32_bf16 a[168:171], a[236:239], a[72:75], a[168:171]
    s_branch L_bodyN
LH_g5:
    s_cmp_lg_u32 s48, 0
    s_cbranch_scc1 L_nopg
    buffer_load_dword v246, off, s[84:87], 0 sc1
L_nopg:
    buffer_load_dword v243, v34, s[4:7], 0 offen
    s_branch L_bodyN
LH_ow_2:
    s_waitcnt lgkmcnt(0)
    ds_read_b64_tr_b16 a[224:225], v248 offset:40960
    ds_read_b64_tr_b16 a[226:227], v248 offset:46080
    ds_read_b64_tr_b16 a[228:229], v249 offset:40992
    ds_read_b64_tr_b16 a[230:231], v249 offset:46112
    ds_read_b64_tr_b16 a[232:233], v248 offset:41024
    ds_read_b64_tr_b16 a[234:235], v248 offset:46144
    ds_read_b64_tr_b16 a[236:237], v249 offset:41056
    ds_read_b64_tr_b16 a[238:239], v249 offset:46176
    ds_read_b64_tr_b16 a[240:241], v248 offset:41088
    ds_read_b64_tr_b16 a[242:243], v248 offset:46208
    ds_read_b64_tr_b16 a[244:245], v250 offset:40960
    ds_read_b64_tr_b16 a[246:247], v250 offset:46080
    ds_read_b64_tr_b16 a[248:249], v251 offset:40992
    ds_read_b64_tr_b16 a[250:251], v251 offset:46112
    s_waitcnt lgkmcnt(8)
    v_mfma_f32_16x16x32_bf16 a[96:99], a[224:227], a[80:83], a[96:99]
    ds_read_b64_tr_b16 a[252:253], v250 offset:41024
    s_add_u32 m0, s83, 102400
    s_add_u32 s67, s20, 3932160
    buffer_load_dwordx4 v24, s[28:31], s67 offen offset:0 lds
    v_mfma_f32_16x16x32_bf16 a[100:103], a[224:227], a[84:87], a[100:103]
    ds_read_b64_tr_b16 a[254:255], v250 offset:46144
    v_mfma_f32_16x16x32_bf16 a[108:111], a[228:231], a[84:87], a[108:111]
    ds_read_b64_tr_b16 a[224:225], v251 offset:41056
    v_mfma_f32_16x16x32_bf16 a[104:107], a[228:231], a[80:83], a[104:107]
    ds_read_b64_tr_b16 a[226:227], v251 offset:46176
    buffer_load_dwordx4 v25, s[28:31], s67 offen offset:1024 lds
    v_mfma_f32_16x16x32_bf16 a[112:115], a[232:235], a[80:83], a[112:115]
    ds_read_b64_tr_b16 a[228:229], v250 offset:41088
    v_mfma_f32_16x16x32_bf16 a[116:119], a[232:235], a[84:87], a[116:119]
    ds_read_b64_tr_b16 a[230:231], v250 offset:46208
    s_waitcnt lgkmcnt(8)
    v_mfma_f32_16x16x32_bf16 a[124:127], a[236:239], a[84:87], a[124:127]
    ds_read_b64_tr_b16 a[232:233], v248 offset:51200
    buffer_load_dwordx4 v26, s[28:31], s67 offen offset:2048 lds
    v_mfma_f32_16x16x32_bf16 a[120:123], a[236:239], a[80:83], a[120:123]
    ds_read_b64_tr_b16 a[234:235], v248 offset:56320
    v_mfma_f32_16x16x32_bf16 a[128:131], a[240:243], a[80:83], a[128:131]
    ds_read_b64_tr_b16 a[236:237], v249 offset:51232
    v_mfma_f32_16x16x32_bf16 a[132:135], a[240:243], a[84:87], a[132:135]
    ds_read_b64_tr_b16 a[238:239], v249 offset:56352
    buffer_load_dwordx4 v27, s[28:31], s67 offen offset:3072 lds
    s_add_u32 m0, m0, 4096
    v_mfma_f32_16x16x32_bf16 a[140:143], a[244:247], a[84:87], a[140:143]
    ds_read_b64_tr_b16 a[240:241], v248 offset:51264
    v_mfma_f32_16x16x32_bf16 a[136:139], a[244:247], a[80:83], a[136:139]
    ds_read_b64_tr_b16 a[242:243], v248 offset:56384
    s_waitcnt lgkmcnt(8)
    v_mfma_f32_16x16x32_bf16 a[144:147], a[248:251], a[80:83], a[144:147]
    ds_read_b64_tr_b16 a[244:245], v249 offset:51296
    buffer_load_dwordx4 v28, s[28:31], s67 offen offset:0 lds
    v_mfma_f32_16x16x32_bf16 a[148:151], a[248:251], a[84:87], a[148:151]
    ds_read_b64_tr_b16 a[246:247], v249 offset:56416
    v_mfma_f32_16x16x32_bf16 a[156:159], a[252:255], a[84:87], a[156:159]
    ds_read_b64_tr_b16 a[248:249], v248 offset:51328
    v_mfma_f32_16x16x32_bf16 a[152:155], a[252:255], a[80:83], a[152:155]
    ds_read_b64_tr_b16 a[250:251], v248 offset:56448
    v_mfma_f32_16x16x32_bf16 a[160:163], a[224:227], a[80:83], a[160:163]
    ds_read_b64_tr_b16 a[252:253], v250 offset:51200
    v_mfma_f32_16x16x32_bf16 a[164:167], a[224:227], a[84:87], a[164:167]
    ds_read_b64_tr_b16 a[254:255], v250 offset:56320
    s_waitcnt lgkmcnt(8)
    v_mfma_f32_16x16x32_bf16 a[172:175], a[228:231], a[84:87], a[172:175]
    ds_read_b64_tr_b16 a[224:225], v251 offset:51232
    v_mfma_f32_16x16x32_bf16 a[168:171], a[228:231], a[80:83], a[168:171]
    ds_read_b64_tr_b16 a[226:227], v251 offset:56352
    v_mfma_f32_16x16x32_bf16 a[96:99], a[232:235], a[88:91], a[96:99]
    ds_read_b64_tr_b16 a[228:229], v250 offset:51264
    v_mfma_f32_16x16x32_bf16 a[100:103], a[232:235], a[92:95], a[100:103]
    ds_read_b64_tr_b16 a[230:231], v250 offset:56384
    v_mfma_f32_16x16x32_bf16 a[108:111], a[236:239], a[92:95], a[108:111]
    ds_read_b64_tr_b16 a[232:233], v251 offset:51296
    v_mfma_f32_16x16x32_bf16 a[104:107], a[236:239], a[88:91], a[104:107]
    ds_read_b64_tr_b16 a[234:235], v251 offset:56416
    s_waitcnt lgkmcnt(8)
    v_mfma_f32_16x16x32_bf16 a[112:115], a[240:243], a[88:91], a[112:115]
    ds_read_b64_tr_b16 a[236:237], v250 offset:51328
    v_mfma_f32_16x16x32_bf16 a[116:119], a[240:243], a[92:95], a[116:119]
    ds_read_b64_tr_b16 a[238:239], v250 offset:56448
    v_mfma_f32_16x16x32_bf16 a[124:127], a[244:247], a[92:95], a[124:127]
    v_mfma_f32_16x16x32_bf16 a[120:123], a[244:247], a[88:91], a[120:123]
    v_mfma_f32_16x16x32_bf16 a[128:131], a[248:251], a[88:91], a[128:131]
    v_mfma_f32_16x16x32_bf16 a[132:135], a[248:251], a[92:95], a[132:135]
    s_waitcnt lgkmcnt(4)
    v_mfma_f32_16x16x32_bf16 a[140:143], a[252:255], a[92:95], a[140:143]
    v_mfma_f32_16x16x32_bf16 a[136:139], a[252:255], a[88:91], a[136:139]
    v_mfma_f32_16x16x32_bf16 a[144:147], a[224:227], a[88:91], a[144:147]
    v_mfma_f32_16x16x32_bf16 a[148:151], a[224:227], a[92:95], a[148:151]
    v_mfma_f32_16x16x32_bf16 a[156:159], a[228:231], a[92:95], a[156:159]
    v_mfma_f32_16x16x32_bf16 a[152:155], a[228:231], a[88:91], a[152:155]
    s_waitcnt lgkmcnt(0)
    v_mfma_f32_16x16x32_bf16 a[160:163], a[232:235], a[88:91], a[160:163]
    v_mfma_f32_16x16x32_bf16 a[164:167], a[232:235], a[92:95], a[164:167]
    v_mfma_f32_16x16x32_bf16 a[172:175], a[236:239], a[92:95], a[172:175]
    v_mfma_f32_16x16x32_bf16 a[168:171], a[236:239], a[88:91], a[168:171]
    s_branch L_bodyN
LH_t4:
    s_add_u32 m0, s83, 122880
    s_add_u32 s67, s20, 4014080
    buffer_load_dwordx4 v24, s[28:31], s67 offen offset:0 lds
    buffer_load_dwordx4 v25, s[28:31], s67 offen offset:1024 lds
    buffer_load_dwordx4 v26, s[28:31], s67 offen offset:2048 lds
    buffer_load_dwordx4 v27, s[28:31], s67 offen offset:3072 lds
    s_add_u32 m0, m0, 4096
    s_nop 0
    buffer_load_dwordx4 v28, s[28:31], s67 offen offset:0 lds
    s_branch L_bodyN
LH_t5:
    s_add_u32 m0, s83, 143360
    s_add_u32 s67, s20, 4096000
    buffer_load_dwordx4 v24, s[28:31], s67 offen offset:0 lds
    buffer_load_dwordx4 v25, s[28:31], s67 offen offset:1024 lds
    buffer_load_dwordx4 v26, s[28:31], s67 offen offset:2048 lds
    buffer_load_dwordx4 v27, s[28:31], s67 offen offset:3072 lds
    s_add_u32 m0, m0, 4096
    s_nop 0
    buffer_load_dwordx4 v28, s[28:31], s67 offen offset:0 lds
    s_branch L_bodyN
L_rare1:
    v_max3_f32 v6, v64, v65, s75
    v_max3_f32 v10, v68, v69, s75
    v_max3_f32 v6, v6, v66, v67
    v_max3_f32 v10, v10, v70, v71
    v_max3_f32 v6, v6, v72, v73
    v_max3_f32 v10, v10, v76, v77
    v_max3_f32 v6, v6, v74, v75
    v_max3_f32 v10, v10, v78, v79
    v_max3_f32 v6, v6, v80, v81
    v_max3_f32 v10, v10, v84, v85
    v_max3_f32 v6, v6, v82, v83
    v_max3_f32 v10, v10, v86, v87
    v_max3_f32 v6, v6, v88, v89
    v_max3_f32 v10, v10, v92, v93
    v_max3_f32 v6, v6, v90, v91
    v_max3_f32 v10, v10, v94, v95
    v_mov_b32 v7, v6
    v_mov_b32 v11, v10
    s_nop 0
    v_permlane32_swap_b32 v6, v7
    v_permlane32_swap_b32 v10, v11
    v_max_f32 v6, v6, v7
    v_max_f32 v10, v10, v11
    v_mov_b32 v7, v6
    v_mov_b32 v11, v10
    s_nop 0
    v_permlane16_swap_b32 v6, v7
    v_permlane16_swap_b32 v10, v11
    v_max_f32 v6, v6, v7
    v_max_f32 v10, v10, v11
    v_sub_f32 v6, 0, v6
    v_sub_f32 v10, 0, v10
    v_mov_b32 v7, v6
    v_mov_b32 v11, v10
    v_exp_f32 v60, v6
    v_exp_f32 v62, v10
    v_exp_f32 v61, v6
    v_exp_f32 v63, v10
    v_pk_add_f32 v[64:65], v[64:65], v[6:7]
    v_pk_add_f32 v[66:67], v[66:67], v[6:7]
    v_pk_add_f32 v[68:69], v[68:69], v[10:11]
    v_pk_add_f32 v[70:71], v[70:71], v[10:11]
    v_pk_add_f32 v[72:73], v[72:73], v[6:7]
    v_pk_add_f32 v[74:75], v[74:75], v[6:7]
    v_pk_add_f32 v[76:77], v[76:77], v[10:11]
    v_pk_add_f32 v[78:79], v[78:79], v[10:11]
    v_pk_add_f32 v[80:81], v[80:81], v[6:7]
    v_pk_add_f32 v[82:83], v[82:83], v[6:7]
    v_pk_add_f32 v[84:85], v[84:85], v[10:11]
    v_pk_add_f32 v[86:87], v[86:87], v[10:11]
    v_pk_add_f32 v[88:89], v[88:89], v[6:7]
    v_pk_add_f32 v[90:91], v[90:91], v[6:7]
    v_pk_add_f32 v[92:93], v[92:93], v[10:11]
    v_pk_add_f32 v[94:95], v[94:95], v[10:11]
    v_pk_add_f32 v[48:49], v[48:49], v[6:7]
    v_pk_add_f32 v[50:51], v[50:51], v[6:7]
    v_pk_add_f32 v[52:53], v[52:53], v[10:11]
    v_pk_add_f32 v[54:55], v[54:55], v[10:11]
    s_mov_b32 s74, 0x41000000
    s_mov_b32 s75, 0
    s_mov_b32 s76, s61
    s_mov_b32 s61, 1
    s_cmp_eq_u32 s62, 0
    s_cbranch_scc1 L_retN
    s_cmp_eq_u32 s62, 2
    s_cbranch_scc1 L_retT
    s_branch L_retA0
L_rare2:
    s_nop 7
    v_pk_mul_f32 v[112:113], v[112:113], v[60:61]
    v_pk_mul_f32 v[114:115], v[114:115], v[60:61]
    v_pk_mul_f32 v[116:117], v[116:117], v[62:63]
    v_pk_mul_f32 v[118:119], v[118:119], v[62:63]
    v_pk_mul_f32 v[120:121], v[120:121], v[60:61]
    v_pk_mul_f32 v[122:123], v[122:123], v[60:61]
    v_pk_mul_f32 v[124:125], v[124:125], v[62:63]
    v_pk_mul_f32 v[126:127], v[126:127], v[62:63]
    v_pk_mul_f32 v[128:129], v[128:129], v[60:61]
    v_pk_mul_f32 v[130:131], v[130:131], v[60:61]
    v_pk_mul_f32 v[132:133], v[132:133], v[62:63]
    v_pk_mul_f32 v[134:135], v[134:135], v[62:63]
    v_pk_mul_f32 v[136:137], v[136:137], v[60:61]
    v_pk_mul_f32 v[138:139], v[138:139], v[60:61]
    v_pk_mul_f32 v[140:141], v[140:141], v[62:63]
    v_pk_mul_f32 v[142:143], v[142:143], v[62:63]
    v_pk_mul_f32 v[144:145], v[144:145], v[60:61]
    v_pk_mul_f32 v[146:147], v[146:147], v[60:61]
    v_pk_mul_f32 v[148:149], v[148:149], v[62:63]
    v_pk_mul_f32 v[150:151], v[150:151], v[62:63]
    v_pk_mul_f32 v[152:153], v[152:153], v[60:61]
    v_pk_mul_f32 v[154:155], v[154:155], v[60:61]
    v_pk_mul_f32 v[156:157], v[156:157], v[62:63]
    v_pk_mul_f32 v[158:159], v[158:159], v[62:63]
    v_pk_mul_f32 v[160:161], v[160:161], v[60:61]
    v_pk_mul_f32 v[162:163], v[162:163], v[60:61]
    v_pk_mul_f32 v[164:165], v[164:165], v[62:63]
    v_pk_mul_f32 v[166:167], v[166:167], v[62:63]
    v_pk_mul_f32 v[168:169], v[168:169], v[60:61]
    v_pk_mul_f32 v[170:171], v[170:171], v[60:61]
    v_pk_mul_f32 v[172:173], v[172:173], v[62:63]
    v_pk_mul_f32 v[174:175], v[174:175], v[62:63]
    v_pk_mul_f32 v[176:177], v[176:177], v[60:61]
    v_pk_mul_f32 v[178:179], v[178:179], v[60:61]
    v_pk_mul_f32 v[180:181], v[180:181], v[62:63]
    v_pk_mul_f32 v[182:183], v[182:183], v[62:63]
    v_pk_mul_f32 v[184:185], v[184:185], v[60:61]
    v_pk_mul_f32 v[186:187], v[186:187], v[60:61]
    v_pk_mul_f32 v[188:189], v[188:189], v[62:63]
    v_pk_mul_f32 v[190:191], v[190:191], v[62:63]
    v_pk_mul_f32 v[192:193], v[192:193], v[60:61]
    v_pk_mul_f32 v[194:195], v[194:195], v[60:61]
    v_pk_mul_f32 v[196:197], v[196:197], v[62:63]
    v_pk_mul_f32 v[198:199], v[198:199], v[62:63]
    v_pk_mul_f32 v[200:201], v[200:201], v[60:61]
    v_pk_mul_f32 v[202:203], v[202:203], v[60:61]
    v_pk_mul_f32 v[204:205], v[204:205], v[62:63]
    v_pk_mul_f32 v[206:207], v[206:207], v[62:63]
    v_mul_f32 v2, v2, v60
    v_mul_f32 v3, v3, v62
    s_mov_b32 s76, 0
    s_nop 1
    s_cmp_eq_u32 s62, 2
    s_cbranch_scc1 L_ret2T
    s_branch L_ret2
L_tail:
    s_cmp_lg_u32 s48, 0
    s_cbranch_scc1 L_gok
L_gchk:
    v_readfirstlane_b32 s52, v246
    s_cmp_ge_u32 s52, 256
    s_cbranch_scc1 L_gok
    buffer_load_dword v246, off, s[84:87], 0 sc1
    s_waitcnt vmcnt(0)
    s_sub_u32 s96, s96, 1
    s_cbranch_scc0 L_gchk
    s_mov_b32 s96, 0
L_gok:
    s_mov_b32 s62, 2
    s_waitcnt lgkmcnt(5)
    v_mfma_f32_16x16x32_bf16 v[64:67], a[192:195], a[0:3], v[48:51]
    ds_read_b128 a[220:223], v37 offset:6272
    v_exp_f32 v224, v80
    v_mfma_f32_16x16x32_bf16 v[68:71], a[192:195], a[4:7], v[52:55]
    v_add_u32 v12, 0, v44
    v_add_u32 v13, 0, v45
    v_mfma_f32_16x16x32_bf16 v[76:79], a[196:199], a[4:7], v[52:55]
    ds_read_b128 a[192:195], v36 offset:256
    v_add_u32 v14, 0, v46
    v_add_u32 v15, 0, v47
    v_mfma_f32_16x16x32_bf16 v[72:75], a[196:199], a[0:3], v[48:51]
    v_add_u32 v16, 49152, v44
    v_add_u32 v17, 49152, v45
    v_add_u32 v18, 49152, v46
    s_waitcnt lgkmcnt(5)
    v_mfma_f32_16x16x32_bf16 v[64:67], a[200:203], a[8:11], v[64:67]
    ds_read_b128 a[196:199], v36 offset:6400
    v_add_u32 v19, 49152, v47
    v_mfma_f32_16x16x32_bf16 v[68:71], a[200:203], a[12:15], v[68:71]
    v_add_u32 v20, 102400, v44
    v_add_u32 v21, 102400, v45
    v_add_u32 v22, 102400, v46
    v_mfma_f32_16x16x32_bf16 v[76:79], a[204:207], a[12:15], v[76:79]
    ds_read_b128 a[200:203], v37 offset:256
    v_add_u32 v23, 102400, v47
    v_exp_f32 v225, v81
    v_mfma_f32_16x16x32_bf16 v[72:75], a[204:207], a[8:11], v[72:75]
    v_exp_f32 v226, v82
    s_waitcnt lgkmcnt(5)
    v_mfma_f32_16x16x32_bf16 v[64:67], a[208:211], a[16:19], v[64:67]
    ds_read_b128 a[204:207], v37 offset:6400
    v_exp_f32 v227, v83
    v_mfma_f32_16x16x32_bf16 v[68:71], a[208:211], a[20:23], v[68:71]
    v_exp_f32 v228, v84
    v_mfma_f32_16x16x32_bf16 v[76:79], a[212:215], a[20:23], v[76:79]
    ds_read_b128 a[208:211], v36 offset:12288
    v_exp_f32 v229, v85
    v_mfma_f32_16x16x32_bf16 v[72:75], a[212:215], a[16:19], v[72:75]
    v_exp_f32 v230, v86
    v_exp_f32 v231, v87
    s_waitcnt lgkmcnt(5)
    v_mfma_f32_16x16x32_bf16 v[64:67], a[216:219], a[24:27], v[64:67]
    ds_read_b128 a[212:215], v36 offset:18432
    v_mfma_f32_16x16x32_bf16 v[68:71], a[216:219], a[28:31], v[68:71]
    v_exp_f32 v232, v88
    v_exp_f32 v233, v89
    v_mfma_f32_16x16x32_bf16 v[76:79], a[220:223], a[28:31], v[76:79]
    ds_read_b128 a[216:219], v37 offset:12288
    v_exp_f32 v234, v90
    v_mfma_f32_16x16x32_bf16 v[72:75], a[220:223], a[24:27], v[72:75]
    v_exp_f32 v235, v91
    s_waitcnt lgkmcnt(5)
    v_mfma_f32_16x16x32_bf16 v[64:67], a[192:195], a[32:35], v[64:67]
    ds_read_b128 a[220:223], v37 offset:18432
    v_exp_f32 v236, v92
    v_mfma_f32_16x16x32_bf16 v[68:71], a[192:195], a[36:39], v[68:71]
    v_exp_f32 v237, v93
    v_mfma_f32_16x16x32_bf16 v[76:79], a[196:199], a[36:39], v[76:79]
    ds_read_b128 a[192:195], v36 offset:12416
    v_exp_f32 v238, v94
    v_mfma_f32_16x16x32_bf16 v[72:75], a[196:199], a[32:35], v[72:75]
    v_exp_f32 v239, v95
    v_add_f32 v2, v2, v208
    s_waitcnt lgkmcnt(5)
    v_mfma_f32_16x16x32_bf16 v[64:67], a[200:203], a[40:43], v[64:67]
    ds_read_b128 a[196:199], v36 offset:18560
    v_add_f32 v3, v3, v212
    v_mfma_f32_16x16x32_bf16 v[68:71], a[200:203], a[44:47], v[68:71]
    v_add_f32 v2, v2, v209
    v_add_f32 v3, v3, v213
    v_add_f32 v2, v2, v210
    v_mfma_f32_16x16x32_bf16 v[76:79], a[204:207], a[44:47], v[76:79]
    ds_read_b128 a[200:203], v37 offset:12416
    v_add_f32 v3, v3, v214
    v_add_f32 v2, v2, v211
    v_mfma_f32_16x16x32_bf16 v[72:75], a[204:207], a[40:43], v[72:75]
    v_add_f32 v3, v3, v215
    v_add_f32 v2, v2, v216
    v_add_f32 v3, v3, v220
    s_waitcnt lgkmcnt(5)
    v_mfma_f32_16x16x32_bf16 v[80:83], a[208:211], a[0:3], v[48:51]
    ds_read_b128 a[204:207], v37 offset:18560
    v_add_f32 v2, v2, v217
    v_mfma_f32_16x16x32_bf16 v[84:87], a[208:211], a[4:7], v[52:55]
    v_add_f32 v3, v3, v221
    v_add_f32 v2, v2, v218
    v_add_f32 v3, v3, v222
    v_mfma_f32_16x16x32_bf16 v[92:95], a[212:215], a[4:7], v[52:55]
    ds_read_b128 a[208:211], v36 offset:12544
    v_add_f32 v2, v2, v219
    v_add_f32 v3, v3, v223
    v_mfma_f32_16x16x32_bf16 v[88:91], a[212:215], a[0:3], v[48:51]
    v_max3_f32 v1, v64, v65, v66
    v_max3_f32 v1, v1, v67, v68
    v_max3_f32 v1, v1, v69, v70
    s_waitcnt lgkmcnt(5)
    v_mfma_f32_16x16x32_bf16 v[80:83], a[216:219], a[8:11], v[80:83]
    ds_read_b128 a[212:215], v36 offset:18688
    v_max3_f32 v1, v1, v71, v72
    v_mfma_f32_16x16x32_bf16 v[84:87], a[216:219], a[12:15], v[84:87]
    v_max3_f32 v1, v1, v73, v74
    v_max3_f32 v1, v1, v75, v76
    v_max3_f32 v1, v1, v77, v78
    v_mfma_f32_16x16x32_bf16 v[92:95], a[220:223], a[12:15], v[92:95]
    ds_read_b128 a[216:219], v37 offset:12544
    v_max_f32 v1, v1, v79
    v_mfma_f32_16x16x32_bf16 v[88:91], a[220:223], a[8:11], v[88:91]
    s_waitcnt lgkmcnt(5)
    v_mfma_f32_16x16x32_bf16 v[80:83], a[192:195], a[16:19], v[80:83]
    ds_read_b128 a[220:223], v37 offset:18688
    v_mfma_f32_16x16x32_bf16 v[84:87], a[192:195], a[20:23], v[84:87]
    v_mfma_f32_16x16x32_bf16 v[92:95], a[196:199], a[20:23], v[92:95]
    v_mfma_f32_16x16x32_bf16 v[88:91], a[196:199], a[16:19], v[88:91]
    s_waitcnt lgkmcnt(4)
    v_mfma_f32_16x16x32_bf16 v[80:83], a[200:203], a[24:27], v[80:83]
    v_mfma_f32_16x16x32_bf16 v[84:87], a[200:203], a[28:31], v[84:87]
    v_cvt_pk_bf16_f32 v104, v224, v225
    v_cvt_pk_bf16_f32 v105, v226, v227
    v_cvt_pk_bf16_f32 v108, v228, v229
    v_cvt_pk_bf16_f32 v109, v230, v231
    v_mfma_f32_16x16x32_bf16 v[92:95], a[204:207], a[28:31], v[92:95]
    s_waitcnt vmcnt(6) lgkmcnt(0)
    s_barrier
    ds_read_b64_tr_b16 a[192:193], v40 offset:0
    ds_read_b64_tr_b16 a[194:195], v40 offset:6144
    ds_read_b64_tr_b16 a[196:197], v41 offset:0
    v_mfma_f32_16x16x32_bf16 v[88:91], a[204:207], a[24:27], v[88:91]
    ds_read_b64_tr_b16 a[198:199], v41 offset:6144
    ds_read_b64_tr_b16 a[200:201], v42 offset:0
    ds_read_b64_tr_b16 a[202:203], v42 offset:6144
    v_mfma_f32_16x16x32_bf16 v[80:83], a[208:211], a[32:35], v[80:83]
    ds_read_b64_tr_b16 a[204:205], v43 offset:0
    v_mfma_f32_16x16x32_bf16 v[84:87], a[208:211], a[36:39], v[84:87]
    ds_read_b64_tr_b16 a[206:207], v43 offset:6144
    s_mul_i32 s53, s92, 49152
    s_add_u32 s53, s53, s66
    buffer_store_dwordx4 a[48:51], v35, s[24:27], s53 offen offset:0 sc1
    v_mfma_f32_16x16x32_bf16 v[92:95], a[212:215], a[36:39], v[92:95]
    ds_read_b64_tr_b16 a[208:209], v40 offset:128
    v_mfma_f32_16x16x32_bf16 v[88:91], a[212:215], a[32:35], v[88:91]
    ds_read_b64_tr_b16 a[210:211], v40 offset:6272
    v_cvt_pk_bf16_f32 v106, v232, v233
    v_cvt_pk_bf16_f32 v107, v234, v235
    v_mfma_f32_16x16x32_bf16 v[80:83], a[216:219], a[40:43], v[80:83]
    ds_read_b64_tr_b16 a[212:213], v41 offset:128
    v_cvt_pk_bf16_f32 v110, v236, v237
    v_cvt_pk_bf16_f32 v111, v238, v239
    v_mfma_f32_16x16x32_bf16 v[84:87], a[216:219], a[44:47], v[84:87]
    ds_read_b64_tr_b16 a[214:215], v41 offset:6272
    v_add_f32 v2, v2, v224
    v_add_f32 v3, v3, v228
    v_mfma_f32_16x16x32_bf16 v[92:95], a[220:223], a[44:47], v[92:95]
    ds_read_b64_tr_b16 a[216:217], v42 offset:128
    v_add_f32 v2, v2, v225
    v_add_f32 v3, v3, v229
    v_mfma_f32_16x16x32_bf16 v[88:91], a[220:223], a[40:43], v[88:91]
    ds_read_b64_tr_b16 a[218:219], v42 offset:6272
    buffer_store_dwordx4 a[52:55], v35, s[24:27], s53 offen offset:1024 sc1
    s_waitcnt lgkmcnt(10)
    v_mfma_f32_16x16x32_bf16 v[112:115], a[192:195], v[96:99], v[112:115]
    ds_read_b64_tr_b16 a[220:221], v43 offset:128
    v_add_f32 v2, v2, v226
    v_mfma_f32_16x16x32_bf16 v[116:119], a[192:195], v[100:103], v[116:119]
    ds_read_b64_tr_b16 a[222:223], v43 offset:6272
    v_add_f32 v3, v3, v230
    v_add_f32 v2, v2, v227
    v_mfma_f32_16x16x32_bf16 v[124:127], a[196:199], v[100:103], v[124:127]
    ds_read_b64_tr_b16 a[192:193], v40 offset:256
    v_add_f32 v3, v3, v231
    v_add_f32 v2, v2, v232
    v_mfma_f32_16x16x32_bf16 v[120:123], a[196:199], v[96:99], v[120:123]
    ds_read_b64_tr_b16 a[194:195], v40 offset:6400
    v_max3_f32 v1, v1, v80, v81
    v_max3_f32 v1, v1, v82, v83
    s_waitcnt lgkmcnt(10)
    v_mfma_f32_16x16x32_bf16 v[128:131], a[200:203], v[96:99], v[128:131]
    ds_read_b64_tr_b16 a[196:197], v41 offset:256
    v_max3_f32 v1, v1, v84, v85
    v_mfma_f32_16x16x32_bf16 v[132:135], a[200:203], v[100:103], v[132:135]
    ds_read_b64_tr_b16 a[198:199], v41 offset:6400
    buffer_store_dwordx4 a[56:59], v35, s[24:27], s53 offen offset:2048 sc1
    v_mfma_f32_16x16x32_bf16 v[140:143], a[204:207], v[100:103], v[140:143]
    ds_read_b64_tr_b16 a[200:201], v42 offset:256
    v_max3_f32 v1, v1, v86, v87
    v_max3_f32 v1, v1, v88, v89
    v_mfma_f32_16x16x32_bf16 v[136:139], a[204:207], v[96:99], v[136:139]
    ds_read_b64_tr_b16 a[202:203], v42 offset:6400
    v_max3_f32 v1, v1, v90, v91
    v_max3_f32 v1, v1, v92, v93
    s_waitcnt lgkmcnt(10)
    v_mfma_f32_16x16x32_bf16 v[144:147], a[208:211], v[96:99], v[144:147]
    ds_read_b64_tr_b16 a[204:205], v43 offset:256
    v_max3_f32 v1, v1, v94, v95
    v_mfma_f32_16x16x32_bf16 v[148:151], a[208:211], v[100:103], v[148:151]
    ds_read_b64_tr_b16 a[206:207], v43 offset:6400
    v_cmp_lt_f32 vcc, s74, v1
    s_cbranch_vccnz L_rare1
L_retT:
    v_mfma_f32_16x16x32_bf16 v[156:159], a[212:215], v[100:103], v[156:159]
    ds_read_b64_tr_b16 a[208:209], v40 offset:12288
    v_exp_f32 v208, v64
    v_mfma_f32_16x16x32_bf16 v[152:155], a[212:215], v[96:99], v[152:155]
    ds_read_b64_tr_b16 a[210:211], v40 offset:18432
    v_exp_f32 v209, v65
    s_waitcnt lgkmcnt(10)
    v_mfma_f32_16x16x32_bf16 v[160:163], a[216:219], v[96:99], v[160:163]
    ds_read_b64_tr_b16 a[212:213], v41 offset:12288
    v_mfma_f32_16x16x32_bf16 v[164:167], a[216:219], v[100:103], v[164:167]
    ds_read_b64_tr_b16 a[214:215], v41 offset:18432
    buffer_store_dwordx4 a[60:63], v35, s[24:27], s53 offen offset:3072 sc1
    v_mfma_f32_16x16x32_bf16 v[172:175], a[220:223], v[100:103], v[172:175]
    ds_read_b64_tr_b16 a[216:217], v42 offset:12288
    v_exp_f32 v210, v66
    v_mfma_f32_16x16x32_bf16 v[168:171], a[220:223], v[96:99], v[168:171]
    ds_read_b64_tr_b16 a[218:219], v42 offset:18432
    v_exp_f32 v211, v67
    s_waitcnt lgkmcnt(10)
    v_mfma_f32_16x16x32_bf16 v[176:179], a[192:195], v[96:99], v[176:179]
    ds_read_b64_tr_b16 a[220:221], v43 offset:12288
    v_exp_f32 v212, v68
    v_mfma_f32_16x16x32_bf16 v[180:183], a[192:195], v[100:103], v[180:183]
    ds_read_b64_tr_b16 a[222:223], v43 offset:18432
    v_exp_f32 v213, v69
    v_mfma_f32_16x16x32_bf16 v[188:191], a[196:199], v[100:103], v[188:191]
    ds_read_b64_tr_b16 a[192:193], v40 offset:12416
    v_exp_f32 v214, v70
    v_mfma_f32_16x16x32_bf16 v[184:187], a[196:199], v[96:99], v[184:187]
    ds_read_b64_tr_b16 a[194:195], v40 offset:18560
    s_add_u32 s53, s53, 4096
    buffer_store_dwordx4 a[64:67], v35, s[24:27], s53 offen offset:0 sc1
    s_waitcnt lgkmcnt(10)
    v_mfma_f32_16x16x32_bf16 v[192:195], a[200:203], v[96:99], v[192:195]
    ds_read_b64_tr_b16 a[196:197], v41 offset:12416
    v_mfma_f32_16x16x32_bf16 v[196:199], a[200:203], v[100:103], v[196:199]
    ds_read_b64_tr_b16 a[198:199], v41 offset:18560
    v_exp_f32 v215, v71
    v_mfma_f32_16x16x32_bf16 v[204:207], a[204:207], v[100:103], v[204:207]
    ds_read_b64_tr_b16 a[200:201], v42 offset:12416
    v_exp_f32 v216, v72
    v_mfma_f32_16x16x32_bf16 v[200:203], a[204:207], v[96:99], v[200:203]
    ds_read_b64_tr_b16 a[202:203], v42 offset:18560
    v_exp_f32 v217, v73
    s_waitcnt lgkmcnt(10)
    v_mfma_f32_16x16x32_bf16 v[112:115], a[208:211], v[104:107], v[112:115]
    ds_read_b64_tr_b16 a[204:205], v43 offset:12416
    v_mfma_f32_16x16x32_bf16 v[116:119], a[208:211], v[108:111], v[116:119]
    ds_read_b64_tr_b16 a[206:207], v43 offset:18560
    buffer_store_dwordx4 a[68:71], v35, s[24:27], s53 offen offset:1024 sc1
    v_mfma_f32_16x16x32_bf16 v[124:127], a[212:215], v[108:111], v[124:127]
    ds_read_b64_tr_b16 a[208:209], v40 offset:12544
    v_exp_f32 v218, v74
    v_mfma_f32_16x16x32_bf16 v[120:123], a[212:215], v[104:107], v[120:123]
    ds_read_b64_tr_b16 a[210:211], v40 offset:18688
    v_exp_f32 v219, v75
    s_waitcnt lgkmcnt(10)
    v_mfma_f32_16x16x32_bf16 v[128:131], a[216:219], v[104:107], v[128:131]
    ds_read_b64_tr_b16 a[212:213], v41 offset:12544
    v_exp_f32 v220, v76
    v_mfma_f32_16x16x32_bf16 v[132:135], a[216:219], v[108:111], v[132:135]
    ds_read_b64_tr_b16 a[214:215], v41 offset:18688
    v_exp_f32 v221, v77
    v_mfma_f32_16x16x32_bf16 v[140:143], a[220:223], v[108:111], v[140:143]
    ds_read_b64_tr_b16 a[216:217], v42 offset:12544
    v_exp_f32 v222, v78
    v_mfma_f32_16x16x32_bf16 v[136:139], a[220:223], v[104:107], v[136:139]
    ds_read_b64_tr_b16 a[218:219], v42 offset:18688
    v_exp_f32 v223, v79
    s_waitcnt lgkmcnt(10)
    v_mfma_f32_16x16x32_bf16 v[144:147], a[192:195], v[104:107], v[144:147]
    ds_read_b64_tr_b16 a[220:221], v43 offset:12544
    v_mfma_f32_16x16x32_bf16 v[148:151], a[192:195], v[108:111], v[148:151]
    ds_read_b64_tr_b16 a[222:223], v43 offset:18688
    buffer_store_dwordx4 a[72:75], v35, s[24:27], s53 offen offset:2048 sc1
    v_mfma_f32_16x16x32_bf16 v[156:159], a[196:199], v[108:111], v[156:159]
    v_cvt_pk_bf16_f32 v96, v208, v209
    v_cvt_pk_bf16_f32 v97, v210, v211
    v_cvt_pk_bf16_f32 v100, v212, v213
    v_mfma_f32_16x16x32_bf16 v[152:155], a[196:199], v[104:107], v[152:155]
    v_cvt_pk_bf16_f32 v101, v214, v215
    v_cvt_pk_bf16_f32 v98, v216, v217
    v_cvt_pk_bf16_f32 v99, v218, v219
    s_waitcnt lgkmcnt(8)
    v_mfma_f32_16x16x32_bf16 v[160:163], a[200:203], v[104:107], v[160:163]
    v_cvt_pk_bf16_f32 v102, v220, v221
    v_cvt_pk_bf16_f32 v103, v222, v223
    v_mfma_f32_16x16x32_bf16 v[164:167], a[200:203], v[108:111], v[164:167]
    v_xor_b32 v40, 81920, v40
    v_xor_b32 v41, 81920, v41
    v_xor_b32 v42, 81920, v42
    v_xor_b32 v43, 81920, v43
    v_mfma_f32_16x16x32_bf16 v[172:175], a[204:207], v[108:111], v[172:175]
    s_waitcnt vmcnt(7) lgkmcnt(0)
    s_barrier
    ds_read_b64_tr_b16 a[192:193], v40 offset:0
    ds_read_b64_tr_b16 a[194:195], v40 offset:6144
    ds_read_b64_tr_b16 a[196:197], v41 offset:0
    v_mfma_f32_16x16x32_bf16 v[168:171], a[204:207], v[104:107], v[168:171]
    ds_read_b64_tr_b16 a[198:199], v41 offset:6144
    ds_read_b64_tr_b16 a[200:201], v42 offset:0
    ds_read_b64_tr_b16 a[202:203], v42 offset:6144
    v_mfma_f32_16x16x32_bf16 v[176:179], a[208:211], v[104:107], v[176:179]
    ds_read_b64_tr_b16 a[204:205], v43 offset:0
    buffer_store_dwordx4 a[76:79], v35, s[24:27], s53 offen offset:3072 sc1
    v_mfma_f32_16x16x32_bf16 v[180:183], a[208:211], v[108:111], v[180:183]
    ds_read_b64_tr_b16 a[206:207], v43 offset:6144
    v_mfma_f32_16x16x32_bf16 v[188:191], a[212:215], v[108:111], v[188:191]
    ds_read_b64_tr_b16 a[208:209], v40 offset:128
    v_add_f32 v3, v3, v236
    v_mfma_f32_16x16x32_bf16 v[184:187], a[212:215], v[104:107], v[184:187]
    ds_read_b64_tr_b16 a[210:211], v40 offset:6272
    v_add_f32 v2, v2, v233
    v_add_f32 v3, v3, v237
    v_mfma_f32_16x16x32_bf16 v[192:195], a[216:219], v[104:107], v[192:195]
    ds_read_b64_tr_b16 a[212:213], v41 offset:128
    v_add_f32 v2, v2, v234
    v_add_f32 v3, v3, v238
    v_mfma_f32_16x16x32_bf16 v[196:199], a[216:219], v[108:111], v[196:199]
    ds_read_b64_tr_b16 a[214:215], v41 offset:6272
    s_add_u32 m0, s83, 0
    s_add_u32 s67, s21, 0
    buffer_load_dwordx4 v24, s[28:31], s67 offen offset:0 lds
    s_add_u32 s53, s53, 4096
    v_mfma_f32_16x16x32_bf16 v[204:207], a[220:223], v[108:111], v[204:207]
    ds_read_b64_tr_b16 a[216:217], v42 offset:128
    buffer_store_dwordx4 a[80:83], v35, s[24:27], s53 offen offset:0 sc1
    v_mfma_f32_16x16x32_bf16 v[200:203], a[220:223], v[104:107], v[200:203]
    ds_read_b64_tr_b16 a[218:219], v42 offset:6272
    v_add_f32 v2, v2, v235
    v_add_f32 v3, v3, v239
    s_cmp_lg_u32 s76, 0
    s_cbranch_scc1 L_rare2
L_ret2T:
    s_waitcnt lgkmcnt(10)
    v_mfma_f32_16x16x32_bf16 v[112:115], a[192:195], v[96:99], v[112:115]
    ds_read_b64_tr_b16 a[220:221], v43 offset:128
    v_mfma_f32_16x16x32_bf16 v[116:119], a[192:195], v[100:103], v[116:119]
    ds_read_b64_tr_b16 a[222:223], v43 offset:6272
    buffer_load_dwordx4 v25, s[28:31], s67 offen offset:1024 lds
    v_mfma_f32_16x16x32_bf16 v[124:127], a[196:199], v[100:103], v[124:127]
    ds_read_b64_tr_b16 a[192:193], v40 offset:256
    v_exp_f32 v224, v80
    v_mfma_f32_16x16x32_bf16 v[120:123], a[196:199], v[96:99], v[120:123]
    ds_read_b64_tr_b16 a[194:195], v40 offset:6400
    v_exp_f32 v225, v81
    s_waitcnt lgkmcnt(10)
    v_mfma_f32_16x16x32_bf16 v[128:131], a[200:203], v[96:99], v[128:131]
    ds_read_b64_tr_b16 a[196:197], v41 offset:256
    v_mfma_f32_16x16x32_bf16 v[132:135], a[200:203], v[100:103], v[132:135]
    ds_read_b64_tr_b16 a[198:199], v41 offset:6400
    buffer_store_dwordx4 a[84:87], v35, s[24:27], s53 offen offset:1024 sc1
    v_mfma_f32_16x16x32_bf16 v[140:143], a[204:207], v[100:103], v[140:143]
    ds_read_b64_tr_b16 a[200:201], v42 offset:256
    v_exp_f32 v226, v82
    v_mfma_f32_16x16x32_bf16 v[136:139], a[204:207], v[96:99], v[136:139]
    ds_read_b64_tr_b16 a[202:203], v42 offset:6400
    buffer_load_dwordx4 v26, s[28:31], s67 offen offset:2048 lds
    s_waitcnt lgkmcnt(10)
    v_mfma_f32_16x16x32_bf16 v[144:147], a[208:211], v[96:99], v[144:147]
    ds_read_b64_tr_b16 a[204:205], v43 offset:256
    v_exp_f32 v227, v83
    v_mfma_f32_16x16x32_bf16 v[148:151], a[208:211], v[100:103], v[148:151]
    ds_read_b64_tr_b16 a[206:207], v43 offset:6400
    v_exp_f32 v228, v84
    v_mfma_f32_16x16x32_bf16 v[156:159], a[212:215], v[100:103], v[156:159]
    ds_read_b64_tr_b16 a[208:209], v40 offset:12288
    v_exp_f32 v229, v85
    v_mfma_f32_16x16x32_bf16 v[152:155], a[212:215], v[96:99], v[152:155]
    ds_read_b64_tr_b16 a[210:211], v40 offset:18432
    buffer_store_dwordx4 a[88:91], v35, s[24:27], s53 offen offset:2048 sc1
    s_waitcnt lgkmcnt(10)
    v_mfma_f32_16x16x32_bf16 v[160:163], a[216:219], v[96:99], v[160:163]
    ds_read_b64_tr_b16 a[212:213], v41 offset:12288
    v_mfma_f32_16x16x32_bf16 v[164:167], a[216:219], v[100:103], v[164:167]
    ds_read_b64_tr_b16 a[214:215], v41 offset:18432
    buffer_load_dwordx4 v27, s[28:31], s67 offen offset:3072 lds
    v_mfma_f32_16x16x32_bf16 v[172:175], a[220:223], v[100:103], v[172:175]
    ds_read_b64_tr_b16 a[216:217], v42 offset:12288
    v_exp_f32 v230, v86
    v_mfma_f32_16x16x32_bf16 v[168:171], a[220:223], v[96:99], v[168:171]
    ds_read_b64_tr_b16 a[218:219], v42 offset:18432
    v_exp_f32 v231, v87
    s_waitcnt lgkmcnt(10)
    v_mfma_f32_16x16x32_bf16 v[176:179], a[192:195], v[96:99], v[176:179]
    ds_read_b64_tr_b16 a[220:221], v43 offset:12288
    v_exp_f32 v232, v88
    v_mfma_f32_16x16x32_bf16 v[180:183], a[192:195], v[100:103], v[180:183]
    ds_read_b64_tr_b16 a[222:223], v43 offset:18432
    buffer_store_dwordx4 a[92:95], v35, s[24:27], s53 offen offset:3072 sc1
    v_mfma_f32_16x16x32_bf16 v[188:191], a[196:199], v[100:103], v[188:191]
    ds_read_b64_tr_b16 a[192:193], v40 offset:12416
    v_exp_f32 v233, v89
    v_mfma_f32_16x16x32_bf16 v[184:187], a[196:199], v[96:99], v[184:187]
    ds_read_b64_tr_b16 a[194:195], v40 offset:18560
    s_add_u32 m0, m0, 4096
    s_nop 0
    buffer_load_dwordx4 v28, s[28:31], s67 offen offset:0 lds
    s_waitcnt lgkmcnt(10)
    v_mfma_f32_16x16x32_bf16 v[192:195], a[200:203], v[96:99], v[192:195]
    ds_read_b64_tr_b16 a[196:197], v41 offset:12416
    v_mfma_f32_16x16x32_bf16 v[196:199], a[200:203], v[100:103], v[196:199]
    ds_read_b64_tr_b16 a[198:199], v41 offset:18560
    v_exp_f32 v234, v90
    v_mfma_f32_16x16x32_bf16 v[204:207], a[204:207], v[100:103], v[204:207]
    ds_read_b64_tr_b16 a[200:201], v42 offset:12416
    v_exp_f32 v235, v91
    v_mfma_f32_16x16x32_bf16 v[200:203], a[204:207], v[96:99], v[200:203]
    ds_read_b64_tr_b16 a[202:203], v42 offset:18560
    v_exp_f32 v236, v92
    v_exp_f32 v237, v93
    v_exp_f32 v238, v94
    v_exp_f32 v239, v95
    v_cvt_pk_bf16_f32 v104, v224, v225
    v_cvt_pk_bf16_f32 v105, v226, v227
    v_cvt_pk_bf16_f32 v108, v228, v229
    v_cvt_pk_bf16_f32 v109, v230, v231
    v_cvt_pk_bf16_f32 v106, v232, v233
    v_cvt_pk_bf16_f32 v107, v234, v235
    v_cvt_pk_bf16_f32 v110, v236, v237
    v_cvt_pk_bf16_f32 v111, v238, v239
    s_waitcnt lgkmcnt(10)
    v_mfma_f32_16x16x32_bf16 v[112:115], a[208:211], v[104:107], v[112:115]
    ds_read_b64_tr_b16 a[204:205], v43 offset:12416
    v_mfma_f32_16x16x32_bf16 v[116:119], a[208:211], v[108:111], v[116:119]
    ds_read_b64_tr_b16 a[206:207], v43 offset:18560
    s_add_u32 m0, s83, 49152
    s_add_u32 s67, s21, 81920
    buffer_load_dwordx4 v24, s[28:31], s67 offen offset:0 lds
    v_mfma_f32_16x16x32_bf16 v[124:127], a[212:215], v[108:111], v[124:127]
    ds_read_b64_tr_b16 a[208:209], v40 offset:12544
    v_mfma_f32_16x16x32_bf16 v[120:123], a[212:215], v[104:107], v[120:123]
    ds_read_b64_tr_b16 a[210:211], v40 offset:18688
    v_add_f32 v2, v2, v208
    s_waitcnt lgkmcnt(10)
    v_mfma_f32_16x16x32_bf16 v[128:131], a[216:219], v[104:107], v[128:131]
    ds_read_b64_tr_b16 a[212:213], v41 offset:12544
    v_add_f32 v3, v3, v212
    v_mfma_f32_16x16x32_bf16 v[132:135], a[216:219], v[108:111], v[132:135]
    ds_read_b64_tr_b16 a[214:215], v41 offset:18688
    v_add_f32 v2, v2, v209
    v_add_f32 v3, v3, v213
    v_mfma_f32_16x16x32_bf16 v[140:143], a[220:223], v[108:111], v[140:143]
    ds_read_b64_tr_b16 a[216:217], v42 offset:12544
    v_add_f32 v2, v2, v210
    v_add_f32 v3, v3, v214
    v_mfma_f32_16x16x32_bf16 v[136:139], a[220:223], v[104:107], v[136:139]
    ds_read_b64_tr_b16 a[218:219], v42 offset:18688
    buffer_load_dwordx4 v25, s[28:31], s67 offen offset:1024 lds
    s_waitcnt lgkmcnt(10)
    v_mfma_f32_16x16x32_bf16 v[144:147], a[192:195], v[104:107], v[144:147]
    ds_read_b64_tr_b16 a[220:221], v43 offset:12544
    v_add_f32 v2, v2, v211
    v_mfma_f32_16x16x32_bf16 v[148:151], a[192:195], v[108:111], v[148:151]
    ds_read_b64_tr_b16 a[222:223], v43 offset:18688
    v_add_f32 v3, v3, v215
    v_add_f32 v2, v2, v216
    v_mfma_f32_16x16x32_bf16 v[156:159], a[196:199], v[108:111], v[156:159]
    v_add_f32 v3, v3, v220
    v_add_f32 v2, v2, v217
    v_add_f32 v3, v3, v221
    v_mfma_f32_16x16x32_bf16 v[152:155], a[196:199], v[104:107], v[152:155]
    v_add_f32 v2, v2, v218
    v_add_f32 v3, v3, v222
    v_add_f32 v2, v2, v219
    s_waitcnt lgkmcnt(8)
    v_mfma_f32_16x16x32_bf16 v[160:163], a[200:203], v[104:107], v[160:163]
    v_add_f32 v3, v3, v223
    v_add_f32 v2, v2, v224
    v_mfma_f32_16x16x32_bf16 v[164:167], a[200:203], v[108:111], v[164:167]
    v_add_f32 v3, v3, v228
    v_add_f32 v2, v2, v225
    v_add_f32 v3, v3, v229
    v_mfma_f32_16x16x32_bf16 v[172:175], a[204:207], v[108:111], v[172:175]
    s_waitcnt vmcnt(62) lgkmcnt(0)
    s_barrier
    ds_read_b64_tr_b16 a[192:193], v20 offset:0
    ds_read_b64_tr_b16 a[194:195], v20 offset:5120
    ds_read_b64_tr_b16 a[196:197], v21 offset:32
    v_mfma_f32_16x16x32_bf16 v[168:171], a[204:207], v[104:107], v[168:171]
    ds_read_b64_tr_b16 a[198:199], v21 offset:5152
    ds_read_b64_tr_b16 a[200:201], v20 offset:64
    ds_read_b64_tr_b16 a[202:203], v20 offset:5184
    buffer_load_dwordx4 v26, s[28:31], s67 offen offset:2048 lds
    v_mfma_f32_16x16x32_bf16 v[176:179], a[208:211], v[104:107], v[176:179]
    ds_read_b64_tr_b16 a[204:205], v21 offset:96
    v_mfma_f32_16x16x32_bf16 v[180:183], a[208:211], v[108:111], v[180:183]
    ds_read_b64_tr_b16 a[206:207], v21 offset:5216
    v_add_f32 v2, v2, v226
    v_mfma_f32_16x16x32_bf16 v[188:191], a[212:215], v[108:111], v[188:191]
    ds_read_b64_tr_b16 a[208:209], v20 offset:128
    v_add_f32 v3, v3, v230
    v_add_f32 v2, v2, v227
    v_mfma_f32_16x16x32_bf16 v[184:187], a[212:215], v[104:107], v[184:187]
    ds_read_b64_tr_b16 a[210:211], v20 offset:5248
    v_add_f32 v3, v3, v231
    v_add_f32 v2, v2, v232
    v_mfma_f32_16x16x32_bf16 v[192:195], a[216:219], v[104:107], v[192:195]
    ds_read_b64_tr_b16 a[212:213], v22 offset:0
    v_add_f32 v3, v3, v236
    v_add_f32 v2, v2, v233
    v_mfma_f32_16x16x32_bf16 v[196:199], a[216:219], v[108:111], v[196:199]
    ds_read_b64_tr_b16 a[214:215], v22 offset:5120
    buffer_load_dwordx4 v27, s[28:31], s67 offen offset:3072 lds
    v_mfma_f32_16x16x32_bf16 v[204:207], a[220:223], v[108:111], v[204:207]
    ds_read_b64_tr_b16 a[216:217], v23 offset:32
    v_add_f32 v3, v3, v237
    v_add_f32 v2, v2, v234
    v_mfma_f32_16x16x32_bf16 v[200:203], a[220:223], v[104:107], v[200:203]
    ds_read_b64_tr_b16 a[218:219], v23 offset:5152
    v_add_f32 v3, v3, v238
    v_add_f32 v2, v2, v235
    v_add_f32 v3, v3, v239
    v_mov_b32 v6, v2
    v_mov_b32 v7, v3
    s_nop 0
    v_permlane32_swap_b32 v2, v6
    v_permlane32_swap_b32 v3, v7
    v_add_f32 v2, v2, v6
    v_add_f32 v3, v3, v7
    v_mov_b32 v6, v2
    v_mov_b32 v7, v3
    s_nop 0
    v_permlane16_swap_b32 v2, v6
    v_permlane16_swap_b32 v3, v7
    v_add_f32 v2, v2, v6
    v_add_f32 v3, v3, v7
    v_rcp_f32 v6, v2
    v_rcp_f32 v10, v3
    v_rcp_f32 v7, v2
    v_rcp_f32 v11, v3
    s_mul_i32 s80, s92, 49152
    s_add_u32 s80, s80, s66
    s_add_u32 s80, s80, 786432
    v_mul_f32 v112, v6, v112
    v_mul_f32 v113, v6, v113
    v_mul_f32 v114, v6, v114
    v_mul_f32 v115, v6, v115
    v_mul_f32 v120, v6, v120
    v_mul_f32 v121, v6, v121
    v_mul_f32 v122, v6, v122
    v_mul_f32 v123, v6, v123
    v_cvt_pk_bf16_f32 v112, v112, v113
    v_cvt_pk_bf16_f32 v113, v114, v115
    v_cvt_pk_bf16_f32 v114, v120, v121
    v_cvt_pk_bf16_f32 v115, v122, v123
    v_mul_f32 v116, v10, v116
    v_mul_f32 v117, v10, v117
    v_mul_f32 v118, v10, v118
    v_mul_f32 v119, v10, v119
    v_mul_f32 v124, v10, v124
    v_mul_f32 v125, v10, v125
    v_mul_f32 v126, v10, v126
    v_mul_f32 v127, v10, v127
    v_cvt_pk_bf16_f32 v116, v116, v117
    v_cvt_pk_bf16_f32 v117, v118, v119
    v_cvt_pk_bf16_f32 v118, v124, v125
    v_cvt_pk_bf16_f32 v119, v126, v127
    s_waitcnt lgkmcnt(8)
    v_mfma_f32_16x16x32_bf16 a[96:99], a[192:195], v[112:115], a[96:99]
    ds_read_b64_tr_b16 a[220:221], v22 offset:64
    v_mfma_f32_16x16x32_bf16 a[100:103], a[192:195], v[116:119], a[100:103]
    ds_read_b64_tr_b16 a[222:223], v22 offset:5184
    v_mul_f32 v128, v6, v128
    v_mfma_f32_16x16x32_bf16 a[108:111], a[196:199], v[116:119], a[108:111]
    ds_read_b64_tr_b16 a[192:193], v23 offset:96
    v_mul_f32 v129, v6, v129
    v_mul_f32 v130, v6, v130
    v_mfma_f32_16x16x32_bf16 a[104:107], a[196:199], v[112:115], a[104:107]
    ds_read_b64_tr_b16 a[194:195], v23 offset:5216
    v_mul_f32 v131, v6, v131
    v_mul_f32 v136, v6, v136
    v_mfma_f32_16x16x32_bf16 a[112:115], a[200:203], v[112:115], a[112:115]
    ds_read_b64_tr_b16 a[196:197], v22 offset:128
    v_mul_f32 v137, v6, v137
    v_mul_f32 v138, v6, v138
    v_mfma_f32_16x16x32_bf16 a[116:119], a[200:203], v[116:119], a[116:119]
    ds_read_b64_tr_b16 a[198:199], v22 offset:5248
    s_add_u32 m0, m0, 4096
    s_nop 0
    buffer_load_dwordx4 v28, s[28:31], s67 offen offset:0 lds
    s_waitcnt lgkmcnt(8)
    v_mfma_f32_16x16x32_bf16 a[124:127], a[204:207], v[116:119], a[124:127]
    ds_read_b64_tr_b16 a[200:201], v20 offset:10240
    v_mfma_f32_16x16x32_bf16 a[120:123], a[204:207], v[112:115], a[120:123]
    ds_read_b64_tr_b16 a[202:203], v20 offset:15360
    v_mul_f32 v139, v6, v139
    v_cvt_pk_bf16_f32 v128, v128, v129
    v_mfma_f32_16x16x32_bf16 a[128:131], a[208:211], v[112:115], a[128:131]
    ds_read_b64_tr_b16 a[204:205], v21 offset:10272
    v_cvt_pk_bf16_f32 v129, v130, v131
    v_cvt_pk_bf16_f32 v130, v136, v137
    v_mfma_f32_16x16x32_bf16 a[132:135], a[208:211], v[116:119], a[132:135]
    ds_read_b64_tr_b16 a[206:207], v21 offset:15392
    v_cvt_pk_bf16_f32 v131, v138, v139
    v_mul_f32 v132, v10, v132
    v_mfma_f32_16x16x32_bf16 a[140:143], a[212:215], v[116:119], a[140:143]
    ds_read_b64_tr_b16 a[208:209], v20 offset:10304
    v_mul_f32 v133, v10, v133
    v_mul_f32 v134, v10, v134
    v_mfma_f32_16x16x32_bf16 a[136:139], a[212:215], v[112:115], a[136:139]
    ds_read_b64_tr_b16 a[210:211], v20 offset:15424
    v_mul_f32 v135, v10, v135
    v_mul_f32 v140, v10, v140
    s_waitcnt lgkmcnt(8)
    v_mfma_f32_16x16x32_bf16 a[144:147], a[216:219], v[112:115], a[144:147]
    ds_read_b64_tr_b16 a[212:213], v21 offset:10336
    v_mul_f32 v141, v10, v141
    v_mfma_f32_16x16x32_bf16 a[148:151], a[216:219], v[116:119], a[148:151]
    ds_read_b64_tr_b16 a[214:215], v21 offset:15456
    s_add_u32 m0, s83, 24576
    s_add_u32 s67, s21, 163840
    buffer_load_dwordx4 v24, s[28:31], s67 offen offset:0 lds
    v_mfma_f32_16x16x32_bf16 a[156:159], a[220:223], v[116:119], a[156:159]
    ds_read_b64_tr_b16 a[216:217], v20 offset:10368
    v_mfma_f32_16x16x32_bf16 a[152:155], a[220:223], v[112:115], a[152:155]
    ds_read_b64_tr_b16 a[218:219], v20 offset:15488
    s_waitcnt vmcnt(7)
    v_mov_b32 v8, 1
    s_mov_b64 exec, 1
    buffer_store_dword v8, off, s[24:27], s97 sc1
    s_mov_b64 exec, -1
    v_mfma_f32_16x16x32_bf16 a[160:163], a[192:195], v[112:115], a[160:163]
    ds_read_b64_tr_b16 a[220:221], v22 offset:10240
    v_mul_f32 v142, v10, v142
    v_mfma_f32_16x16x32_bf16 a[164:167], a[192:195], v[116:119], a[164:167]
    ds_read_b64_tr_b16 a[222:223], v22 offset:15360
    buffer_store_dwordx4 v[112:115], v35, s[24:27], s80 offen offset:0 sc1
    s_waitcnt lgkmcnt(8)
    v_mfma_f32_16x16x32_bf16 a[172:175], a[196:199], v[116:119], a[172:175]
    ds_read_b64_tr_b16 a[192:193], v23 offset:10272
    v_mul_f32 v143, v10, v143
    v_mfma_f32_16x16x32_bf16 a[168:171], a[196:199], v[112:115], a[168:171]
    ds_read_b64_tr_b16 a[194:195], v23 offset:15392
    v_cvt_pk_bf16_f32 v132, v132, v133
    v_cvt_pk_bf16_f32 v133, v134, v135
    v_cvt_pk_bf16_f32 v134, v140, v141
    v_cvt_pk_bf16_f32 v135, v142, v143
    v_mfma_f32_16x16x32_bf16 a[96:99], a[200:203], v[128:131], a[96:99]
    ds_read_b64_tr_b16 a[196:197], v22 offset:10304
    v_mfma_f32_16x16x32_bf16 a[100:103], a[200:203], v[132:135], a[100:103]
    ds_read_b64_tr_b16 a[198:199], v22 offset:15424
    buffer_load_dwordx4 v25, s[28:31], s67 offen offset:1024 lds
    v_mfma_f32_16x16x32_bf16 a[108:111], a[204:207], v[132:135], a[108:111]
    ds_read_b64_tr_b16 a[200:201], v23 offset:10336
    buffer_load_dwordx4 v[252:255], off, s[24:27], s98 sc1
    v_mfma_f32_16x16x32_bf16 a[104:107], a[204:207], v[128:131], a[104:107]
    ds_read_b64_tr_b16 a[202:203], v23 offset:15456
    v_mul_f32 v144, v6, v144
    v_mul_f32 v145, v6, v145
    s_waitcnt lgkmcnt(8)
    v_mfma_f32_16x16x32_bf16 a[112:115], a[208:211], v[128:131], a[112:115]
    ds_read_b64_tr_b16 a[204:205], v22 offset:10368
    v_mul_f32 v146, v6, v146
    v_mfma_f32_16x16x32_bf16 a[116:119], a[208:211], v[132:135], a[116:119]
    ds_read_b64_tr_b16 a[206:207], v22 offset:15488
    v_mul_f32 v147, v6, v147
    v_mul_f32 v152, v6, v152
    v_mfma_f32_16x16x32_bf16 a[124:127], a[212:215], v[132:135], a[124:127]
    ds_read_b64_tr_b16 a[208:209], v20 offset:20480
    v_mul_f32 v153, v6, v153
    v_mul_f32 v154, v6, v154
    v_mfma_f32_16x16x32_bf16 a[120:123], a[212:215], v[128:131], a[120:123]
    ds_read_b64_tr_b16 a[210:211], v20 offset:25600
    v_mul_f32 v155, v6, v155
    v_cvt_pk_bf16_f32 v144, v144, v145
    v_mfma_f32_16x16x32_bf16 a[128:131], a[216:219], v[128:131], a[128:131]
    ds_read_b64_tr_b16 a[212:213], v21 offset:20512
    v_cvt_pk_bf16_f32 v145, v146, v147
    v_cvt_pk_bf16_f32 v146, v152, v153
    v_mfma_f32_16x16x32_bf16 a[132:135], a[216:219], v[132:135], a[132:135]
    ds_read_b64_tr_b16 a[214:215], v21 offset:25632
    buffer_load_dwordx4 v26, s[28:31], s67 offen offset:2048 lds
    s_waitcnt lgkmcnt(8)
    v_mfma_f32_16x16x32_bf16 a[140:143], a[220:223], v[132:135], a[140:143]
    ds_read_b64_tr_b16 a[216:217], v20 offset:20544
    v_cvt_pk_bf16_f32 v147, v154, v155
    v_mfma_f32_16x16x32_bf16 a[136:139], a[220:223], v[128:131], a[136:139]
    ds_read_b64_tr_b16 a[218:219], v20 offset:25664
    v_mul_f32 v148, v10, v148
    v_mul_f32 v149, v10, v149
    v_mfma_f32_16x16x32_bf16 a[144:147], a[192:195], v[128:131], a[144:147]
    ds_read_b64_tr_b16 a[220:221], v21 offset:20576
    v_mul_f32 v150, v10, v150
    v_mul_f32 v151, v10, v151
    v_mfma_f32_16x16x32_bf16 a[148:151], a[192:195], v[132:135], a[148:151]
    ds_read_b64_tr_b16 a[222:223], v21 offset:25696
    buffer_store_dwordx4 v[116:119], v35, s[24:27], s80 offen offset:1024 sc1
    v_mfma_f32_16x16x32_bf16 a[156:159], a[196:199], v[132:135], a[156:159]
    ds_read_b64_tr_b16 a[192:193], v20 offset:20608
    v_mul_f32 v156, v10, v156
    v_mul_f32 v157, v10, v157
    v_mfma_f32_16x16x32_bf16 a[152:155], a[196:199], v[128:131], a[152:155]
    ds_read_b64_tr_b16 a[194:195], v20 offset:25728
    v_mul_f32 v158, v10, v158
    v_mul_f32 v159, v10, v159
    s_waitcnt lgkmcnt(8)
    v_mfma_f32_16x16x32_bf16 a[160:163], a[200:203], v[128:131], a[160:163]
    ds_read_b64_tr_b16 a[196:197], v22 offset:20480
    v_cvt_pk_bf16_f32 v148, v148, v149
    v_mfma_f32_16x16x32_bf16 a[164:167], a[200:203], v[132:135], a[164:167]
    ds_read_b64_tr_b16 a[198:199], v22 offset:25600
    buffer_load_dwordx4 v27, s[28:31], s67 offen offset:3072 lds
    v_mfma_f32_16x16x32_bf16 a[172:175], a[204:207], v[132:135], a[172:175]
    ds_read_b64_tr_b16 a[200:201], v23 offset:20512
    v_cvt_pk_bf16_f32 v149, v150, v151
    v_cvt_pk_bf16_f32 v150, v156, v157
    v_mfma_f32_16x16x32_bf16 a[168:171], a[204:207], v[128:131], a[168:171]
    ds_read_b64_tr_b16 a[202:203], v23 offset:25632
    v_cvt_pk_bf16_f32 v151, v158, v159
    v_mul_f32 v160, v6, v160
    v_mfma_f32_16x16x32_bf16 a[96:99], a[208:211], v[144:147], a[96:99]
    ds_read_b64_tr_b16 a[204:205], v22 offset:20544
    v_mul_f32 v161, v6, v161
    v_mul_f32 v162, v6, v162
    v_mfma_f32_16x16x32_bf16 a[100:103], a[208:211], v[148:151], a[100:103]
    ds_read_b64_tr_b16 a[206:207], v22 offset:25664
    v_mul_f32 v163, v6, v163
    v_mul_f32 v168, v6, v168
    s_waitcnt lgkmcnt(8)
    v_mfma_f32_16x16x32_bf16 a[108:111], a[212:215], v[148:151], a[108:111]
    ds_read_b64_tr_b16 a[208:209], v23 offset:20576
    v_mul_f32 v169, v6, v169
    v_mfma_f32_16x16x32_bf16 a[104:107], a[212:215], v[144:147], a[104:107]
    ds_read_b64_tr_b16 a[210:211], v23 offset:25696
    v_mul_f32 v170, v6, v170
    v_mul_f32 v171, v6, v171
    v_mfma_f32_16x16x32_bf16 a[112:115], a[216:219], v[144:147], a[112:115]
    ds_read_b64_tr_b16 a[212:213], v22 offset:20608
    v_cvt_pk_bf16_f32 v160, v160, v161
    v_cvt_pk_bf16_f32 v161, v162, v163
    v_mfma_f32_16x16x32_bf16 a[116:119], a[216:219], v[148:151], a[116:119]
    ds_read_b64_tr_b16 a[214:215], v22 offset:25728
    s_add_u32 m0, m0, 4096
    s_nop 0
    buffer_load_dwordx4 v28, s[28:31], s67 offen offset:0 lds
    v_mfma_f32_16x16x32_bf16 a[124:127], a[220:223], v[148:151], a[124:127]
    ds_read_b64_tr_b16 a[216:217], v20 offset:30720
    v_cvt_pk_bf16_f32 v162, v168, v169
    v_mfma_f32_16x16x32_bf16 a[120:123], a[220:223], v[144:147], a[120:123]
    ds_read_b64_tr_b16 a[218:219], v20 offset:35840
    v_cvt_pk_bf16_f32 v163, v170, v171
    v_mul_f32 v164, v10, v164
    s_waitcnt lgkmcnt(8)
    v_mfma_f32_16x16x32_bf16 a[128:131], a[192:195], v[144:147], a[128:131]
    ds_read_b64_tr_b16 a[220:221], v21 offset:30752
    v_mul_f32 v165, v10, v165
    v_mfma_f32_16x16x32_bf16 a[132:135], a[192:195], v[148:151], a[132:135]
    ds_read_b64_tr_b16 a[222:223], v21 offset:35872
    buffer_store_dwordx4 v[128:131], v35, s[24:27], s80 offen offset:2048 sc1
    v_mfma_f32_16x16x32_bf16 a[140:143], a[196:199], v[148:151], a[140:143]
    ds_read_b64_tr_b16 a[192:193], v20 offset:30784
    v_mul_f32 v166, v10, v166
    v_mul_f32 v167, v10, v167
    v_mfma_f32_16x16x32_bf16 a[136:139], a[196:199], v[144:147], a[136:139]
    ds_read_b64_tr_b16 a[194:195], v20 offset:35904
    v_mul_f32 v172, v10, v172
    v_mul_f32 v173, v10, v173
    v_mfma_f32_16x16x32_bf16 a[144:147], a[200:203], v[144:147], a[144:147]
    ds_read_b64_tr_b16 a[196:197], v21 offset:30816
    v_mul_f32 v174, v10, v174
    v_mul_f32 v175, v10, v175
    v_mfma_f32_16x16x32_bf16 a[148:151], a[200:203], v[148:151], a[148:151]
    ds_read_b64_tr_b16 a[198:199], v21 offset:35936
    v_cvt_pk_bf16_f32 v164, v164, v165
    v_cvt_pk_bf16_f32 v165, v166, v167
    s_waitcnt lgkmcnt(8)
    v_mfma_f32_16x16x32_bf16 a[156:159], a[204:207], v[148:151], a[156:159]
    ds_read_b64_tr_b16 a[200:201], v20 offset:30848
    v_cvt_pk_bf16_f32 v166, v172, v173
    v_mfma_f32_16x16x32_bf16 a[152:155], a[204:207], v[144:147], a[152:155]
    ds_read_b64_tr_b16 a[202:203], v20 offset:35968
    v_cvt_pk_bf16_f32 v167, v174, v175
    v_mul_f32 v176, v6, v176
    v_mfma_f32_16x16x32_bf16 a[160:163], a[208:211], v[144:147], a[160:163]
    ds_read_b64_tr_b16 a[204:205], v22 offset:30720
    v_mul_f32 v177, v6, v177
    v_mul_f32 v178, v6, v178
    v_mfma_f32_16x16x32_bf16 a[164:167], a[208:211], v[148:151], a[164:167]
    ds_read_b64_tr_b16 a[206:207], v22 offset:35840
    s_add_u32 m0, s83, 73728
    s_add_u32 s67, s22, 0
    buffer_load_dwordx4 v24, s[28:31], s67 offen offset:0 lds
    v_mfma_f32_16x16x32_bf16 a[172:175], a[212:215], v[148:151], a[172:175]
    ds_read_b64_tr_b16 a[208:209], v23 offset:30752
    v_mfma_f32_16x16x32_bf16 a[168:171], a[212:215], v[144:147], a[168:171]
    ds_read_b64_tr_b16 a[210:211], v23 offset:35872
    v_mul_f32 v179, v6, v179
    v_mul_f32 v184, v6, v184
    s_waitcnt lgkmcnt(8)
    v_mfma_f32_16x16x32_bf16 a[96:99], a[216:219], v[160:163], a[96:99]
    ds_read_b64_tr_b16 a[212:213], v22 offset:30784
    v_mul_f32 v185, v6, v185
    v_mfma_f32_16x16x32_bf16 a[100:103], a[216:219], v[164:167], a[100:103]
    ds_read_b64_tr_b16 a[214:215], v22 offset:35904
    s_waitcnt vmcnt(6)
L_c1:
    v_and_b32 v252, v252, v253
    v_and_b32 v254, v254, v255
    v_and_b32 v252, v252, v254
    s_nop 0
    v_readfirstlane_b32 s52, v252
    s_cmp_eq_u32 s52, 1
    s_cbranch_scc1 L_c1d
    buffer_load_dwordx4 v[252:255], off, s[24:27], s98 sc1
    s_waitcnt vmcnt(0)
    s_sub_u32 s96, s96, 1
    s_cbranch_scc0 L_c1
    s_mov_b32 s96, 0
L_c1d:
    v_mfma_f32_16x16x32_bf16 a[108:111], a[220:223], v[164:167], a[108:111]
    ds_read_b64_tr_b16 a[216:217], v23 offset:30816
    s_mul_i32 s53, s93, 49152
    s_add_u32 s53, s53, s66
    buffer_load_dwordx4 a[0:3], v35, s[24:27], s53 offen offset:0 sc1
    v_mfma_f32_16x16x32_bf16 a[104:107], a[220:223], v[160:163], a[104:107]
    ds_read_b64_tr_b16 a[218:219], v23 offset:35936
    v_mfma_f32_16x16x32_bf16 a[112:115], a[192:195], v[160:163], a[112:115]
    ds_read_b64_tr_b16 a[220:221], v22 offset:30848
    v_mul_f32 v186, v6, v186
    v_mfma_f32_16x16x32_bf16 a[116:119], a[192:195], v[164:167], a[116:119]
    ds_read_b64_tr_b16 a[222:223], v22 offset:35968
    buffer_load_dwordx4 v25, s[28:31], s67 offen offset:1024 lds
    s_waitcnt lgkmcnt(8)
    v_mfma_f32_16x16x32_bf16 a[124:127], a[196:199], v[164:167], a[124:127]
    s_waitcnt vmcnt(17)
    s_barrier
    ds_read_b64_tr_b16 a[192:193], v20 offset:40960
    buffer_load_dwordx4 a[4:7], v35, s[24:27], s53 offen offset:1024 sc1
    v_mfma_f32_16x16x32_bf16 a[120:123], a[196:199], v[160:163], a[120:123]
    ds_read_b64_tr_b16 a[194:195], v20 offset:46080
    v_mfma_f32_16x16x32_bf16 a[128:131], a[200:203], v[160:163], a[128:131]
    ds_read_b64_tr_b16 a[196:197], v21 offset:40992
    buffer_store_dwordx4 v[132:135], v35, s[24:27], s80 offen offset:3072 sc1
    v_mfma_f32_16x16x32_bf16 a[132:135], a[200:203], v[164:167], a[132:135]
    ds_read_b64_tr_b16 a[198:199], v21 offset:46112
    s_add_u32 s80, s80, 4096
    v_mfma_f32_16x16x32_bf16 a[140:143], a[204:207], v[164:167], a[140:143]
    ds_read_b64_tr_b16 a[200:201], v20 offset:41024
    v_mul_f32 v187, v6, v187
    v_cvt_pk_bf16_f32 v176, v176, v177
    v_mfma_f32_16x16x32_bf16 a[136:139], a[204:207], v[160:163], a[136:139]
    ds_read_b64_tr_b16 a[202:203], v20 offset:46144
    buffer_load_dwordx4 a[8:11], v35, s[24:27], s53 offen offset:2048 sc1
    s_waitcnt lgkmcnt(8)
    v_mfma_f32_16x16x32_bf16 a[144:147], a[208:211], v[160:163], a[144:147]
    ds_read_b64_tr_b16 a[204:205], v21 offset:41056
    v_cvt_pk_bf16_f32 v177, v178, v179
    v_mfma_f32_16x16x32_bf16 a[148:151], a[208:211], v[164:167], a[148:151]
    ds_read_b64_tr_b16 a[206:207], v21 offset:46176
    buffer_load_dwordx4 v26, s[28:31], s67 offen offset:2048 lds
    v_mfma_f32_16x16x32_bf16 a[156:159], a[212:215], v[164:167], a[156:159]
    ds_read_b64_tr_b16 a[208:209], v20 offset:41088
    v_cvt_pk_bf16_f32 v178, v184, v185
    v_cvt_pk_bf16_f32 v179, v186, v187
    v_mfma_f32_16x16x32_bf16 a[152:155], a[212:215], v[160:163], a[152:155]
    ds_read_b64_tr_b16 a[210:211], v20 offset:46208
    buffer_load_dwordx4 a[12:15], v35, s[24:27], s53 offen offset:3072 sc1
    v_mfma_f32_16x16x32_bf16 a[160:163], a[216:219], v[160:163], a[160:163]
    ds_read_b64_tr_b16 a[212:213], v22 offset:40960
    v_mul_f32 v180, v10, v180
    v_mul_f32 v181, v10, v181
    v_mfma_f32_16x16x32_bf16 a[164:167], a[216:219], v[164:167], a[164:167]
    ds_read_b64_tr_b16 a[214:215], v22 offset:46080
    v_mul_f32 v182, v10, v182
    v_mul_f32 v183, v10, v183
    s_waitcnt lgkmcnt(8)
    v_mfma_f32_16x16x32_bf16 a[172:175], a[220:223], v[164:167], a[172:175]
    ds_read_b64_tr_b16 a[216:217], v23 offset:40992
    v_mul_f32 v188, v10, v188
    v_mfma_f32_16x16x32_bf16 a[168:171], a[220:223], v[160:163], a[168:171]
    ds_read_b64_tr_b16 a[218:219], v23 offset:46112
    v_mul_f32 v189, v10, v189
    v_mul_f32 v190, v10, v190
    v_mul_f32 v191, v10, v191
    v_cvt_pk_bf16_f32 v180, v180, v181
    v_cvt_pk_bf16_f32 v181, v182, v183
    v_cvt_pk_bf16_f32 v182, v188, v189
    v_cvt_pk_bf16_f32 v183, v190, v191
    v_mfma_f32_16x16x32_bf16 a[96:99], a[192:195], v[176:179], a[96:99]
    ds_read_b64_tr_b16 a[220:221], v22 offset:41024
    v_mfma_f32_16x16x32_bf16 a[100:103], a[192:195], v[180:183], a[100:103]
    ds_read_b64_tr_b16 a[222:223], v22 offset:46144
    buffer_load_dwordx4 v27, s[28:31], s67 offen offset:3072 lds
    s_add_u32 s53, s53, 4096
    v_mfma_f32_16x16x32_bf16 a[108:111], a[196:199], v[180:183], a[108:111]
    ds_read_b64_tr_b16 a[192:193], v23 offset:41056
    buffer_load_dwordx4 a[16:19], v35, s[24:27], s53 offen offset:0 sc1
    v_mfma_f32_16x16x32_bf16 a[104:107], a[196:199], v[176:179], a[104:107]
    ds_read_b64_tr_b16 a[194:195], v23 offset:46176
    s_waitcnt lgkmcnt(8)
    v_mfma_f32_16x16x32_bf16 a[112:115], a[200:203], v[176:179], a[112:115]
    ds_read_b64_tr_b16 a[196:197], v22 offset:41088
    buffer_store_dwordx4 v[144:147], v35, s[24:27], s80 offen offset:0 sc1
    v_mfma_f32_16x16x32_bf16 a[116:119], a[200:203], v[180:183], a[116:119]
    ds_read_b64_tr_b16 a[198:199], v22 offset:46208
    v_mul_f32 v192, v6, v192
    v_mfma_f32_16x16x32_bf16 a[124:127], a[204:207], v[180:183], a[124:127]
    ds_read_b64_tr_b16 a[200:201], v20 offset:51200
    buffer_load_dwordx4 a[20:23], v35, s[24:27], s53 offen offset:1024 sc1
    v_mfma_f32_16x16x32_bf16 a[120:123], a[204:207], v[176:179], a[120:123]
    ds_read_b64_tr_b16 a[202:203], v20 offset:56320
    v_mul_f32 v193, v6, v193
    v_mul_f32 v194, v6, v194
    v_mfma_f32_16x16x32_bf16 a[128:131], a[208:211], v[176:179], a[128:131]
    ds_read_b64_tr_b16 a[204:205], v21 offset:51232
    v_mul_f32 v195, v6, v195
    v_mul_f32 v200, v6, v200
    v_mfma_f32_16x16x32_bf16 a[132:135], a[208:211], v[180:183], a[132:135]
    ds_read_b64_tr_b16 a[206:207], v21 offset:56352
    s_add_u32 m0, m0, 4096
    s_nop 0
    buffer_load_dwordx4 v28, s[28:31], s67 offen offset:0 lds
    s_waitcnt lgkmcnt(8)
    v_mfma_f32_16x16x32_bf16 a[140:143], a[212:215], v[180:183], a[140:143]
    ds_read_b64_tr_b16 a[208:209], v20 offset:51264
    v_mfma_f32_16x16x32_bf16 a[136:139], a[212:215], v[176:179], a[136:139]
    ds_read_b64_tr_b16 a[210:211], v20 offset:56384
    buffer_load_dwordx4 a[24:27], v35, s[24:27], s53 offen offset:2048 sc1
    v_mfma_f32_16x16x32_bf16 a[144:147], a[216:219], v[176:179], a[144:147]
    ds_read_b64_tr_b16 a[212:213], v21 offset:51296
    v_mul_f32 v201, v6, v201
    v_mul_f32 v202, v6, v202
    v_mfma_f32_16x16x32_bf16 a[148:151], a[216:219], v[180:183], a[148:151]
    ds_read_b64_tr_b16 a[214:215], v21 offset:56416
    v_mul_f32 v203, v6, v203
    v_cvt_pk_bf16_f32 v192, v192, v193
    v_mfma_f32_16x16x32_bf16 a[156:159], a[220:223], v[180:183], a[156:159]
    ds_read_b64_tr_b16 a[216:217], v20 offset:51328
    v_cvt_pk_bf16_f32 v193, v194, v195
    v_cvt_pk_bf16_f32 v194, v200, v201
    v_mfma_f32_16x16x32_bf16 a[152:155], a[220:223], v[176:179], a[152:155]
    ds_read_b64_tr_b16 a[218:219], v20 offset:56448
    buffer_load_dwordx4 a[28:31], v35, s[24:27], s53 offen offset:3072 sc1
    s_waitcnt lgkmcnt(8)
    v_mfma_f32_16x16x32_bf16 a[160:163], a[192:195], v[176:179], a[160:163]
    ds_read_b64_tr_b16 a[220:221], v22 offset:51200
    v_cvt_pk_bf16_f32 v195, v202, v203
    v_mfma_f32_16x16x32_bf16 a[164:167], a[192:195], v[180:183], a[164:167]
    ds_read_b64_tr_b16 a[222:223], v22 offset:56320
    v_mul_f32 v196, v10, v196
    v_mul_f32 v197, v10, v197
    v_mfma_f32_16x16x32_bf16 a[172:175], a[196:199], v[180:183], a[172:175]
    ds_read_b64_tr_b16 a[192:193], v23 offset:51232
    v_mul_f32 v198, v10, v198
    v_mul_f32 v199, v10, v199
    v_mfma_f32_16x16x32_bf16 a[168:171], a[196:199], v[176:179], a[168:171]
    ds_read_b64_tr_b16 a[194:195], v23 offset:56352
    buffer_store_dwordx4 v[148:151], v35, s[24:27], s80 offen offset:1024 sc1
    v_mul_f32 v204, v10, v204
    v_mul_f32 v205, v10, v205
    v_mul_f32 v206, v10, v206
    v_mul_f32 v207, v10, v207
    v_cvt_pk_bf16_f32 v196, v196, v197
    v_cvt_pk_bf16_f32 v197, v198, v199
    v_cvt_pk_bf16_f32 v198, v204, v205
    v_cvt_pk_bf16_f32 v199, v206, v207
    v_mfma_f32_16x16x32_bf16 a[96:99], a[200:203], v[192:195], a[96:99]
    ds_read_b64_tr_b16 a[196:197], v22 offset:51264
    v_mfma_f32_16x16x32_bf16 a[100:103], a[200:203], v[196:199], a[100:103]
    ds_read_b64_tr_b16 a[198:199], v22 offset:56384
    s_add_u32 s53, s53, 4096
    buffer_load_dwordx4 a[32:35], v35, s[24:27], s53 offen offset:0 sc1
    s_waitcnt lgkmcnt(8)
    v_mfma_f32_16x16x32_bf16 a[108:111], a[204:207], v[196:199], a[108:111]
    ds_read_b64_tr_b16 a[200:201], v23 offset:51296
    v_mfma_f32_16x16x32_bf16 a[104:107], a[204:207], v[192:195], a[104:107]
    ds_read_b64_tr_b16 a[202:203], v23 offset:56416
    v_mfma_f32_16x16x32_bf16 a[112:115], a[208:211], v[192:195], a[112:115]
    ds_read_b64_tr_b16 a[204:205], v22 offset:51328
    v_mfma_f32_16x16x32_bf16 a[116:119], a[208:211], v[196:199], a[116:119]
    ds_read_b64_tr_b16 a[206:207], v22 offset:56448
    buffer_load_dwordx4 a[36:39], v35, s[24:27], s53 offen offset:1024 sc1
    v_mfma_f32_16x16x32_bf16 a[124:127], a[212:215], v[196:199], a[124:127]
    ds_read_b64_tr_b16 a[208:209], v12 offset:0
    v_mfma_f32_16x16x32_bf16 a[120:123], a[212:215], v[192:195], a[120:123]
    ds_read_b64_tr_b16 a[210:211], v12 offset:5120
    s_waitcnt lgkmcnt(8)
    v_mfma_f32_16x16x32_bf16 a[128:131], a[216:219], v[192:195], a[128:131]
    ds_read_b64_tr_b16 a[212:213], v13 offset:32
    v_mfma_f32_16x16x32_bf16 a[132:135], a[216:219], v[196:199], a[132:135]
    ds_read_b64_tr_b16 a[214:215], v13 offset:5152
    v_mfma_f32_16x16x32_bf16 a[140:143], a[220:223], v[196:199], a[140:143]
    ds_read_b64_tr_b16 a[216:217], v12 offset:64
    v_mfma_f32_16x16x32_bf16 a[136:139], a[220:223], v[192:195], a[136:139]
    ds_read_b64_tr_b16 a[218:219], v12 offset:5184
    buffer_load_dwordx4 a[40:43], v35, s[24:27], s53 offen offset:2048 sc1
    v_mfma_f32_16x16x32_bf16 a[144:147], a[192:195], v[192:195], a[144:147]
    ds_read_b64_tr_b16 a[220:221], v13 offset:96
    v_mfma_f32_16x16x32_bf16 a[148:151], a[192:195], v[196:199], a[148:151]
    ds_read_b64_tr_b16 a[222:223], v13 offset:5216
    s_add_u32 m0, s83, 102400
    s_add_u32 s67, s22, 81920
    buffer_load_dwordx4 v24, s[28:31], s67 offen offset:0 lds
    s_waitcnt lgkmcnt(8)
    v_mfma_f32_16x16x32_bf16 a[156:159], a[196:199], v[196:199], a[156:159]
    ds_read_b64_tr_b16 a[192:193], v12 offset:128
    v_mfma_f32_16x16x32_bf16 a[152:155], a[196:199], v[192:195], a[152:155]
    ds_read_b64_tr_b16 a[194:195], v12 offset:5248
    buffer_load_dwordx4 a[44:47], v35, s[24:27], s53 offen offset:3072 sc1
    v_mfma_f32_16x16x32_bf16 a[160:163], a[200:203], v[192:195], a[160:163]
    ds_read_b64_tr_b16 a[196:197], v14 offset:0
    v_mfma_f32_16x16x32_bf16 a[164:167], a[200:203], v[196:199], a[164:167]
    ds_read_b64_tr_b16 a[198:199], v14 offset:5120
    s_waitcnt vmcnt(13)
    buffer_store_dwordx4 v[160:163], v35, s[24:27], s80 offen offset:2048 sc1
    v_mfma_f32_16x16x32_bf16 a[172:175], a[204:207], v[196:199], a[172:175]
    ds_read_b64_tr_b16 a[200:201], v15 offset:32
    v_mfma_f32_16x16x32_bf16 a[168:171], a[204:207], v[192:195], a[168:171]
    ds_read_b64_tr_b16 a[202:203], v15 offset:5152
    s_waitcnt lgkmcnt(8)
    v_mfma_f32_16x16x32_bf16 a[96:99], a[208:211], a[0:3], a[96:99]
    ds_read_b64_tr_b16 a[204:205], v14 offset:64
    v_mfma_f32_16x16x32_bf16 a[100:103], a[208:211], a[4:7], a[100:103]
    ds_read_b64_tr_b16 a[206:207], v14 offset:5184
    buffer_load_dwordx4 v25, s[28:31], s67 offen offset:1024 lds
    s_mul_i32 s53, s94, 49152
    s_add_u32 s53, s53, s66
    v_mfma_f32_16x16x32_bf16 a[108:111], a[212:215], a[4:7], a[108:111]
    ds_read_b64_tr_b16 a[208:209], v15 offset:96
    buffer_load_dwordx4 a[176:179], v35, s[24:27], s53 offen offset:0 sc1
    v_mfma_f32_16x16x32_bf16 a[104:107], a[212:215], a[0:3], a[104:107]
    ds_read_b64_tr_b16 a[210:211], v15 offset:5216
    v_mfma_f32_16x16x32_bf16 a[112:115], a[216:219], a[0:3], a[112:115]
    ds_read_b64_tr_b16 a[212:213], v14 offset:128
    v_mfma_f32_16x16x32_bf16 a[116:119], a[216:219], a[4:7], a[116:119]
    ds_read_b64_tr_b16 a[214:215], v14 offset:5248
    buffer_load_dwordx4 a[180:183], v35, s[24:27], s53 offen offset:1024 sc1
    s_waitcnt lgkmcnt(8)
    v_mfma_f32_16x16x32_bf16 a[124:127], a[220:223], a[4:7], a[124:127]
    ds_read_b64_tr_b16 a[216:217], v12 offset:10240
    v_mfma_f32_16x16x32_bf16 a[120:123], a[220:223], a[0:3], a[120:123]
    ds_read_b64_tr_b16 a[218:219], v12 offset:15360
    v_mfma_f32_16x16x32_bf16 a[128:131], a[192:195], a[0:3], a[128:131]
    ds_read_b64_tr_b16 a[220:221], v13 offset:10272
    v_mfma_f32_16x16x32_bf16 a[132:135], a[192:195], a[4:7], a[132:135]
    ds_read_b64_tr_b16 a[222:223], v13 offset:15392
    buffer_load_dwordx4 v26, s[28:31], s67 offen offset:2048 lds
    v_mfma_f32_16x16x32_bf16 a[140:143], a[196:199], a[4:7], a[140:143]
    ds_read_b64_tr_b16 a[192:193], v12 offset:10304
    v_mfma_f32_16x16x32_bf16 a[136:139], a[196:199], a[0:3], a[136:139]
    ds_read_b64_tr_b16 a[194:195], v12 offset:15424
    buffer_load_dwordx4 a[184:187], v35, s[24:27], s53 offen offset:2048 sc1
    s_waitcnt lgkmcnt(8)
    v_mfma_f32_16x16x32_bf16 a[144:147], a[200:203], a[0:3], a[144:147]
    ds_read_b64_tr_b16 a[196:197], v13 offset:10336
    v_mfma_f32_16x16x32_bf16 a[148:151], a[200:203], a[4:7], a[148:151]
    ds_read_b64_tr_b16 a[198:199], v13 offset:15456
    buffer_store_dwordx4 v[164:167], v35, s[24:27], s80 offen offset:3072 sc1
    s_add_u32 s80, s80, 4096
    v_mfma_f32_16x16x32_bf16 a[156:159], a[204:207], a[4:7], a[156:159]
    ds_read_b64_tr_b16 a[200:201], v12 offset:10368
    v_mfma_f32_16x16x32_bf16 a[152:155], a[204:207], a[0:3], a[152:155]
    ds_read_b64_tr_b16 a[202:203], v12 offset:15488
    buffer_load_dwordx4 a[188:191], v35, s[24:27], s53 offen offset:3072 sc1
    v_mfma_f32_16x16x32_bf16 a[160:163], a[208:211], a[0:3], a[160:163]
    ds_read_b64_tr_b16 a[204:205], v14 offset:10240
    v_mfma_f32_16x16x32_bf16 a[164:167], a[208:211], a[4:7], a[164:167]
    ds_read_b64_tr_b16 a[206:207], v14 offset:15360
    buffer_load_dwordx4 v27, s[28:31], s67 offen offset:3072 lds
    s_waitcnt lgkmcnt(8)
    v_mfma_f32_16x16x32_bf16 a[172:175], a[212:215], a[4:7], a[172:175]
    ds_read_b64_tr_b16 a[208:209], v15 offset:10272
    v_mfma_f32_16x16x32_bf16 a[168:171], a[212:215], a[0:3], a[168:171]
    ds_read_b64_tr_b16 a[210:211], v15 offset:15392
    v_mfma_f32_16x16x32_bf16 a[96:99], a[216:219], a[8:11], a[96:99]
    ds_read_b64_tr_b16 a[212:213], v14 offset:10304
    v_mfma_f32_16x16x32_bf16 a[100:103], a[216:219], a[12:15], a[100:103]
    ds_read_b64_tr_b16 a[214:215], v14 offset:15424
    s_add_u32 s53, s53, 4096
    buffer_load_dwordx4 a[224:227], v35, s[24:27], s53 offen offset:0 sc1
    v_mfma_f32_16x16x32_bf16 a[108:111], a[220:223], a[12:15], a[108:111]
    ds_read_b64_tr_b16 a[216:217], v15 offset:10336
    v_mfma_f32_16x16x32_bf16 a[104:107], a[220:223], a[8:11], a[104:107]
    ds_read_b64_tr_b16 a[218:219], v15 offset:15456
    s_waitcnt lgkmcnt(8)
    v_mfma_f32_16x16x32_bf16 a[112:115], a[192:195], a[8:11], a[112:115]
    ds_read_b64_tr_b16 a[220:221], v14 offset:10368
    v_mfma_f32_16x16x32_bf16 a[116:119], a[192:195], a[12:15], a[116:119]
    ds_read_b64_tr_b16 a[222:223], v14 offset:15488
    s_add_u32 m0, m0, 4096
    s_nop 0
    buffer_load_dwordx4 v28, s[28:31], s67 offen offset:0 lds
    v_mfma_f32_16x16x32_bf16 a[124:127], a[196:199], a[12:15], a[124:127]
    s_waitcnt vmcnt(17)
    s_barrier
    ds_read_b64_tr_b16 a[192:193], v16 offset:0
    v_mfma_f32_16x16x32_bf16 a[120:123], a[196:199], a[8:11], a[120:123]
    ds_read_b64_tr_b16 a[194:195], v16 offset:5120
    v_mfma_f32_16x16x32_bf16 a[128:131], a[200:203], a[8:11], a[128:131]
    ds_read_b64_tr_b16 a[196:197], v17 offset:32
    v_mfma_f32_16x16x32_bf16 a[132:135], a[200:203], a[12:15], a[132:135]
    ds_read_b64_tr_b16 a[198:199], v17 offset:5152
    buffer_store_dwordx4 v[176:179], v35, s[24:27], s80 offen offset:0 sc1
    s_waitcnt lgkmcnt(8)
    v_mfma_f32_16x16x32_bf16 a[140:143], a[204:207], a[12:15], a[140:143]
    ds_read_b64_tr_b16 a[200:201], v16 offset:64
    v_mfma_f32_16x16x32_bf16 a[136:139], a[204:207], a[8:11], a[136:139]
    ds_read_b64_tr_b16 a[202:203], v16 offset:5184
    buffer_load_dwordx4 a[228:231], v35, s[24:27], s53 offen offset:1024 sc1
    v_mfma_f32_16x16x32_bf16 a[144:147], a[208:211], a[8:11], a[144:147]
    ds_read_b64_tr_b16 a[204:205], v17 offset:96
    v_mfma_f32_16x16x32_bf16 a[148:151], a[208:211], a[12:15], a[148:151]
    ds_read_b64_tr_b16 a[206:207], v17 offset:5216
    s_add_u32 m0, s83, 122880
    s_add_u32 s67, s22, 163840
    buffer_load_dwordx4 v24, s[28:31], s67 offen offset:0 lds
    v_mfma_f32_16x16x32_bf16 a[156:159], a[212:215], a[12:15], a[156:159]
    ds_read_b64_tr_b16 a[208:209], v16 offset:128
    v_mfma_f32_16x16x32_bf16 a[152:155], a[212:215], a[8:11], a[152:155]
    ds_read_b64_tr_b16 a[210:211], v16 offset:5248
    s_waitcnt lgkmcnt(8)
    v_mfma_f32_16x16x32_bf16 a[160:163], a[216:219], a[8:11], a[160:163]
    ds_read_b64_tr_b16 a[212:213], v18 offset:0
    v_mfma_f32_16x16x32_bf16 a[164:167], a[216:219], a[12:15], a[164:167]
    ds_read_b64_tr_b16 a[214:215], v18 offset:5120
    v_mfma_f32_16x16x32_bf16 a[172:175], a[220:223], a[12:15], a[172:175]
    ds_read_b64_tr_b16 a[216:217], v19 offset:32
    v_mfma_f32_16x16x32_bf16 a[168:171], a[220:223], a[8:11], a[168:171]
    ds_read_b64_tr_b16 a[218:219], v19 offset:5152
    v_mfma_f32_16x16x32_bf16 a[96:99], a[192:195], a[16:19], a[96:99]
    ds_read_b64_tr_b16 a[220:221], v18 offset:64
    v_mfma_f32_16x16x32_bf16 a[100:103], a[192:195], a[20:23], a[100:103]
    ds_read_b64_tr_b16 a[222:223], v18 offset:5184
    buffer_load_dwordx4 v25, s[28:31], s67 offen offset:1024 lds
    s_waitcnt lgkmcnt(8)
    v_mfma_f32_16x16x32_bf16 a[108:111], a[196:199], a[20:23], a[108:111]
    ds_read_b64_tr_b16 a[192:193], v19 offset:96
    buffer_load_dwordx4 a[232:235], v35, s[24:27], s53 offen offset:2048 sc1
    v_mfma_f32_16x16x32_bf16 a[104:107], a[196:199], a[16:19], a[104:107]
    ds_read_b64_tr_b16 a[194:195], v19 offset:5216
    v_mfma_f32_16x16x32_bf16 a[112:115], a[200:203], a[16:19], a[112:115]
    ds_read_b64_tr_b16 a[196:197], v18 offset:128
    v_mfma_f32_16x16x32_bf16 a[116:119], a[200:203], a[20:23], a[116:119]
    ds_read_b64_tr_b16 a[198:199], v18 offset:5248
    v_mfma_f32_16x16x32_bf16 a[124:127], a[204:207], a[20:23], a[124:127]
    ds_read_b64_tr_b16 a[200:201], v16 offset:10240
    v_mfma_f32_16x16x32_bf16 a[120:123], a[204:207], a[16:19], a[120:123]
    ds_read_b64_tr_b16 a[202:203], v16 offset:15360
    buffer_store_dwordx4 v[180:183], v35, s[24:27], s80 offen offset:1024 sc1
    s_waitcnt lgkmcnt(8)
    v_mfma_f32_16x16x32_bf16 a[128:131], a[208:211], a[16:19], a[128:131]
    ds_read_b64_tr_b16 a[204:205], v17 offset:10272
    v_mfma_f32_16x16x32_bf16 a[132:135], a[208:211], a[20:23], a[132:135]
    ds_read_b64_tr_b16 a[206:207], v17 offset:15392
    buffer_load_dwordx4 v26, s[28:31], s67 offen offset:2048 lds
    v_mfma_f32_16x16x32_bf16 a[140:143], a[212:215], a[20:23], a[140:143]
    ds_read_b64_tr_b16 a[208:209], v16 offset:10304
    v_mfma_f32_16x16x32_bf16 a[136:139], a[212:215], a[16:19], a[136:139]
    ds_read_b64_tr_b16 a[210:211], v16 offset:15424
    buffer_load_dwordx4 a[236:239], v35, s[24:27], s53 offen offset:3072 sc1
    v_mfma_f32_16x16x32_bf16 a[144:147], a[216:219], a[16:19], a[144:147]
    ds_read_b64_tr_b16 a[212:213], v17 offset:10336
    v_mfma_f32_16x16x32_bf16 a[148:151], a[216:219], a[20:23], a[148:151]
    ds_read_b64_tr_b16 a[214:215], v17 offset:15456
    s_waitcnt lgkmcnt(8)
    v_mfma_f32_16x16x32_bf16 a[156:159], a[220:223], a[20:23], a[156:159]
    ds_read_b64_tr_b16 a[216:217], v16 offset:10368
    v_mfma_f32_16x16x32_bf16 a[152:155], a[220:223], a[16:19], a[152:155]
    ds_read_b64_tr_b16 a[218:219], v16 offset:15488
    v_mfma_f32_16x16x32_bf16 a[160:163], a[192:195], a[16:19], a[160:163]
    ds_read_b64_tr_b16 a[220:221], v18 offset:10240
    v_mfma_f32_16x16x32_bf16 a[164:167], a[192:195], a[20:23], a[164:167]
    ds_read_b64_tr_b16 a[222:223], v18 offset:15360
    buffer_load_dwordx4 v27, s[28:31], s67 offen offset:3072 lds
    v_mfma_f32_16x16x32_bf16 a[172:175], a[196:199], a[20:23], a[172:175]
    ds_read_b64_tr_b16 a[192:193], v19 offset:10272
    v_mfma_f32_16x16x32_bf16 a[168:171], a[196:199], a[16:19], a[168:171]
    ds_read_b64_tr_b16 a[194:195], v19 offset:15392
    s_waitcnt lgkmcnt(8)
    v_mfma_f32_16x16x32_bf16 a[96:99], a[200:203], a[24:27], a[96:99]
    ds_read_b64_tr_b16 a[196:197], v18 offset:10304
    v_mfma_f32_16x16x32_bf16 a[100:103], a[200:203], a[28:31], a[100:103]
    ds_read_b64_tr_b16 a[198:199], v18 offset:15424
    s_add_u32 s53, s53, 4096
    buffer_load_dwordx4 a[240:243], v35, s[24:27], s53 offen offset:0 sc1
    v_mfma_f32_16x16x32_bf16 a[108:111], a[204:207], a[28:31], a[108:111]
    ds_read_b64_tr_b16 a[200:201], v19 offset:10336
    v_mfma_f32_16x16x32_bf16 a[104:107], a[204:207], a[24:27], a[104:107]
    ds_read_b64_tr_b16 a[202:203], v19 offset:15456
    buffer_store_dwordx4 v[192:195], v35, s[24:27], s80 offen offset:2048 sc1
    v_mfma_f32_16x16x32_bf16 a[112:115], a[208:211], a[24:27], a[112:115]
    ds_read_b64_tr_b16 a[204:205], v18 offset:10368
    v_mfma_f32_16x16x32_bf16 a[116:119], a[208:211], a[28:31], a[116:119]
    ds_read_b64_tr_b16 a[206:207], v18 offset:15488
    s_add_u32 m0, m0, 4096
    s_nop 0
    buffer_load_dwordx4 v28, s[28:31], s67 offen offset:0 lds
    s_waitcnt lgkmcnt(8)
    v_mfma_f32_16x16x32_bf16 a[124:127], a[212:215], a[28:31], a[124:127]
    ds_read_b64_tr_b16 a[208:209], v12 offset:24576
    v_mfma_f32_16x16x32_bf16 a[120:123], a[212:215], a[24:27], a[120:123]
    ds_read_b64_tr_b16 a[210:211], v12 offset:29696
    v_mfma_f32_16x16x32_bf16 a[128:131], a[216:219], a[24:27], a[128:131]
    ds_read_b64_tr_b16 a[212:213], v13 offset:24608
    v_mfma_f32_16x16x32_bf16 a[132:135], a[216:219], a[28:31], a[132:135]
    ds_read_b64_tr_b16 a[214:215], v13 offset:29728
    v_mfma_f32_16x16x32_bf16 a[140:143], a[220:223], a[28:31], a[140:143]
    ds_read_b64_tr_b16 a[216:217], v12 offset:24640
    v_mfma_f32_16x16x32_bf16 a[136:139], a[220:223], a[24:27], a[136:139]
    ds_read_b64_tr_b16 a[218:219], v12 offset:29760
    buffer_load_dwordx4 a[244:247], v35, s[24:27], s53 offen offset:1024 sc1
    s_waitcnt lgkmcnt(8)
    v_mfma_f32_16x16x32_bf16 a[144:147], a[192:195], a[24:27], a[144:147]
    ds_read_b64_tr_b16 a[220:221], v13 offset:24672
    v_mfma_f32_16x16x32_bf16 a[148:151], a[192:195], a[28:31], a[148:151]
    ds_read_b64_tr_b16 a[222:223], v13 offset:29792
    s_add_u32 m0, s83, 143360
    s_add_u32 s67, s23, 0
    buffer_load_dwordx4 v24, s[28:31], s67 offen offset:0 lds
    v_mfma_f32_16x16x32_bf16 a[156:159], a[196:199], a[28:31], a[156:159]
    ds_read_b64_tr_b16 a[192:193], v12 offset:24704
    v_mfma_f32_16x16x32_bf16 a[152:155], a[196:199], a[24:27], a[152:155]
    ds_read_b64_tr_b16 a[194:195], v12 offset:29824
    v_mfma_f32_16x16x32_bf16 a[160:163], a[200:203], a[24:27], a[160:163]
    ds_read_b64_tr_b16 a[196:197], v14 offset:24576
    v_mfma_f32_16x16x32_bf16 a[164:167], a[200:203], a[28:31], a[164:167]
    ds_read_b64_tr_b16 a[198:199], v14 offset:29696
    s_waitcnt vmcnt(25)
    s_waitcnt lgkmcnt(8)
    v_mfma_f32_16x16x32_bf16 a[172:175], a[204:207], a[28:31], a[172:175]
    ds_read_b64_tr_b16 a[200:201], v15 offset:24608
    v_mfma_f32_16x16x32_bf16 a[168:171], a[204:207], a[24:27], a[168:171]
    ds_read_b64_tr_b16 a[202:203], v15 offset:29728
    buffer_store_dwordx4 v[196:199], v35, s[24:27], s80 offen offset:3072 sc1
    v_mfma_f32_16x16x32_bf16 a[96:99], a[208:211], a[32:35], a[96:99]
    ds_read_b64_tr_b16 a[204:205], v14 offset:24640
    v_mfma_f32_16x16x32_bf16 a[100:103], a[208:211], a[36:39], a[100:103]
    ds_read_b64_tr_b16 a[206:207], v14 offset:29760
    buffer_load_dwordx4 v25, s[28:31], s67 offen offset:1024 lds
    v_mfma_f32_16x16x32_bf16 a[108:111], a[212:215], a[36:39], a[108:111]
    ds_read_b64_tr_b16 a[208:209], v15 offset:24672
    buffer_load_dwordx4 a[248:251], v35, s[24:27], s53 offen offset:2048 sc1
    v_mfma_f32_16x16x32_bf16 a[104:107], a[212:215], a[32:35], a[104:107]
    ds_read_b64_tr_b16 a[210:211], v15 offset:29792
    s_waitcnt lgkmcnt(8)
    v_mfma_f32_16x16x32_bf16 a[112:115], a[216:219], a[32:35], a[112:115]
    ds_read_b64_tr_b16 a[212:213], v14 offset:24704
    v_mfma_f32_16x16x32_bf16 a[116:119], a[216:219], a[36:39], a[116:119]
    ds_read_b64_tr_b16 a[214:215], v14 offset:29824
    v_mfma_f32_16x16x32_bf16 a[124:127], a[220:223], a[36:39], a[124:127]
    ds_read_b64_tr_b16 a[216:217], v12 offset:34816
    v_mfma_f32_16x16x32_bf16 a[120:123], a[220:223], a[32:35], a[120:123]
    ds_read_b64_tr_b16 a[218:219], v12 offset:39936
    v_mfma_f32_16x16x32_bf16 a[128:131], a[192:195], a[32:35], a[128:131]
    ds_read_b64_tr_b16 a[220:221], v13 offset:34848
    v_mfma_f32_16x16x32_bf16 a[132:135], a[192:195], a[36:39], a[132:135]
    ds_read_b64_tr_b16 a[222:223], v13 offset:39968
    buffer_load_dwordx4 v26, s[28:31], s67 offen offset:2048 lds
    s_waitcnt lgkmcnt(8)
    v_mfma_f32_16x16x32_bf16 a[140:143], a[196:199], a[36:39], a[140:143]
    ds_read_b64_tr_b16 a[192:193], v12 offset:34880
    v_mfma_f32_16x16x32_bf16 a[136:139], a[196:199], a[32:35], a[136:139]
    ds_read_b64_tr_b16 a[194:195], v12 offset:40000
    buffer_load_dwordx4 a[252:255], v35, s[24:27], s53 offen offset:3072 sc1
    v_mfma_f32_16x16x32_bf16 a[144:147], a[200:203], a[32:35], a[144:147]
    ds_read_b64_tr_b16 a[196:197], v13 offset:34912
    v_mfma_f32_16x16x32_bf16 a[148:151], a[200:203], a[36:39], a[148:151]
    ds_read_b64_tr_b16 a[198:199], v13 offset:40032
    v_mfma_f32_16x16x32_bf16 a[156:159], a[204:207], a[36:39], a[156:159]
    ds_read_b64_tr_b16 a[200:201], v12 offset:34944
    v_mfma_f32_16x16x32_bf16 a[152:155], a[204:207], a[32:35], a[152:155]
    ds_read_b64_tr_b16 a[202:203], v12 offset:40064
    s_waitcnt lgkmcnt(8)
    v_mfma_f32_16x16x32_bf16 a[160:163], a[208:211], a[32:35], a[160:163]
    ds_read_b64_tr_b16 a[204:205], v14 offset:34816
    v_mfma_f32_16x16x32_bf16 a[164:167], a[208:211], a[36:39], a[164:167]
    ds_read_b64_tr_b16 a[206:207], v14 offset:39936
    buffer_load_dwordx4 v27, s[28:31], s67 offen offset:3072 lds
    v_mfma_f32_16x16x32_bf16 a[172:175], a[212:215], a[36:39], a[172:175]
    ds_read_b64_tr_b16 a[208:209], v15 offset:34848
    v_mfma_f32_16x16x32_bf16 a[168:171], a[212:215], a[32:35], a[168:171]
    ds_read_b64_tr_b16 a[210:211], v15 offset:39968
    v_mfma_f32_16x16x32_bf16 a[96:99], a[216:219], a[40:43], a[96:99]
    ds_read_b64_tr_b16 a[212:213], v14 offset:34880
    v_mfma_f32_16x16x32_bf16 a[100:103], a[216:219], a[44:47], a[100:103]
    ds_read_b64_tr_b16 a[214:215], v14 offset:40000
    s_mul_i32 s53, s95, 49152
    s_add_u32 s53, s53, s66
    buffer_load_dwordx4 v[48:51], v35, s[24:27], s53 offen offset:0 sc1
    s_waitcnt lgkmcnt(8)
    v_mfma_f32_16x16x32_bf16 a[108:111], a[220:223], a[44:47], a[108:111]
    ds_read_b64_tr_b16 a[216:217], v15 offset:34912
    v_mfma_f32_16x16x32_bf16 a[104:107], a[220:223], a[40:43], a[104:107]
    ds_read_b64_tr_b16 a[218:219], v15 offset:40032
    v_mfma_f32_16x16x32_bf16 a[112:115], a[192:195], a[40:43], a[112:115]
    ds_read_b64_tr_b16 a[220:221], v14 offset:34944
    v_mfma_f32_16x16x32_bf16 a[116:119], a[192:195], a[44:47], a[116:119]
    ds_read_b64_tr_b16 a[222:223], v14 offset:40064
    s_add_u32 m0, m0, 4096
    s_nop 0
    buffer_load_dwordx4 v28, s[28:31], s67 offen offset:0 lds
    v_mfma_f32_16x16x32_bf16 a[124:127], a[196:199], a[44:47], a[124:127]
    s_waitcnt vmcnt(22)
    s_barrier
    ds_read_b64_tr_b16 a[192:193], v16 offset:24576
    v_mfma_f32_16x16x32_bf16 a[120:123], a[196:199], a[40:43], a[120:123]
    ds_read_b64_tr_b16 a[194:195], v16 offset:29696
    s_waitcnt lgkmcnt(8)
    v_mfma_f32_16x16x32_bf16 a[128:131], a[200:203], a[40:43], a[128:131]
    ds_read_b64_tr_b16 a[196:197], v17 offset:24608
    v_mfma_f32_16x16x32_bf16 a[132:135], a[200:203], a[44:47], a[132:135]
    ds_read_b64_tr_b16 a[198:199], v17 offset:29728
    v_mfma_f32_16x16x32_bf16 a[140:143], a[204:207], a[44:47], a[140:143]
    ds_read_b64_tr_b16 a[200:201], v16 offset:24640
    v_mfma_f32_16x16x32_bf16 a[136:139], a[204:207], a[40:43], a[136:139]
    ds_read_b64_tr_b16 a[202:203], v16 offset:29760
    buffer_load_dwordx4 v[52:55], v35, s[24:27], s53 offen offset:1024 sc1
    v_mfma_f32_16x16x32_bf16 a[144:147], a[208:211], a[40:43], a[144:147]
    ds_read_b64_tr_b16 a[204:205], v17 offset:24672
    v_mfma_f32_16x16x32_bf16 a[148:151], a[208:211], a[44:47], a[148:151]
    ds_read_b64_tr_b16 a[206:207], v17 offset:29792
    s_add_u32 m0, s83, 0
    s_add_u32 s67, s23, 81920
    buffer_load_dwordx4 v24, s[28:31], s67 offen offset:0 lds
    s_waitcnt lgkmcnt(8)
    v_mfma_f32_16x16x32_bf16 a[156:159], a[212:215], a[44:47], a[156:159]
    ds_read_b64_tr_b16 a[208:209], v16 offset:24704
    v_mfma_f32_16x16x32_bf16 a[152:155], a[212:215], a[40:43], a[152:155]
    ds_read_b64_tr_b16 a[210:211], v16 offset:29824
    v_mfma_f32_16x16x32_bf16 a[160:163], a[216:219], a[40:43], a[160:163]
    ds_read_b64_tr_b16 a[212:213], v18 offset:24576
    v_mfma_f32_16x16x32_bf16 a[164:167], a[216:219], a[44:47], a[164:167]
    ds_read_b64_tr_b16 a[214:215], v18 offset:29696
    v_mfma_f32_16x16x32_bf16 a[172:175], a[220:223], a[44:47], a[172:175]
    ds_read_b64_tr_b16 a[216:217], v19 offset:24608
    v_mfma_f32_16x16x32_bf16 a[168:171], a[220:223], a[40:43], a[168:171]
    ds_read_b64_tr_b16 a[218:219], v19 offset:29728
    s_waitcnt lgkmcnt(8)
    v_mfma_f32_16x16x32_bf16 a[96:99], a[192:195], a[176:179], a[96:99]
    ds_read_b64_tr_b16 a[220:221], v18 offset:24640
    v_mfma_f32_16x16x32_bf16 a[100:103], a[192:195], a[180:183], a[100:103]
    ds_read_b64_tr_b16 a[222:223], v18 offset:29760
    buffer_load_dwordx4 v25, s[28:31], s67 offen offset:1024 lds
    v_mfma_f32_16x16x32_bf16 a[108:111], a[196:199], a[180:183], a[108:111]
    ds_read_b64_tr_b16 a[192:193], v19 offset:24672
    buffer_load_dwordx4 v[56:59], v35, s[24:27], s53 offen offset:2048 sc1
    v_mfma_f32_16x16x32_bf16 a[104:107], a[196:199], a[176:179], a[104:107]
    ds_read_b64_tr_b16 a[194:195], v19 offset:29792
    v_mfma_f32_16x16x32_bf16 a[112:115], a[200:203], a[176:179], a[112:115]
    ds_read_b64_tr_b16 a[196:197], v18 offset:24704
    v_mfma_f32_16x16x32_bf16 a[116:119], a[200:203], a[180:183], a[116:119]
    ds_read_b64_tr_b16 a[198:199], v18 offset:29824
    s_waitcnt lgkmcnt(8)
    v_mfma_f32_16x16x32_bf16 a[124:127], a[204:207], a[180:183], a[124:127]
    ds_read_b64_tr_b16 a[200:201], v16 offset:34816
    v_mfma_f32_16x16x32_bf16 a[120:123], a[204:207], a[176:179], a[120:123]
    ds_read_b64_tr_b16 a[202:203], v16 offset:39936
    v_mfma_f32_16x16x32_bf16 a[128:131], a[208:211], a[176:179], a[128:131]
    ds_read_b64_tr_b16 a[204:205], v17 offset:34848
    v_mfma_f32_16x16x32_bf16 a[132:135], a[208:211], a[180:183], a[132:135]
    ds_read_b64_tr_b16 a[206:207], v17 offset:39968
    buffer_load_dwordx4 v26, s[28:31], s67 offen offset:2048 lds
    v_mfma_f32_16x16x32_bf16 a[140:143], a[212:215], a[180:183], a[140:143]
    ds_read_b64_tr_b16 a[208:209], v16 offset:34880
    v_mfma_f32_16x16x32_bf16 a[136:139], a[212:215], a[176:179], a[136:139]
    ds_read_b64_tr_b16 a[210:211], v16 offset:40000
    buffer_load_dwordx4 v[60:63], v35, s[24:27], s53 offen offset:3072 sc1
    s_waitcnt lgkmcnt(8)
    v_mfma_f32_16x16x32_bf16 a[144:147], a[216:219], a[176:179], a[144:147]
    ds_read_b64_tr_b16 a[212:213], v17 offset:34912
    v_mfma_f32_16x16x32_bf16 a[148:151], a[216:219], a[180:183], a[148:151]
    ds_read_b64_tr_b16 a[214:215], v17 offset:40032
    v_mfma_f32_16x16x32_bf16 a[156:159], a[220:223], a[180:183], a[156:159]
    ds_read_b64_tr_b16 a[216:217], v16 offset:34944
    v_mfma_f32_16x16x32_bf16 a[152:155], a[220:223], a[176:179], a[152:155]
    ds_read_b64_tr_b16 a[218:219], v16 offset:40064
    v_mfma_f32_16x16x32_bf16 a[160:163], a[192:195], a[176:179], a[160:163]
    ds_read_b64_tr_b16 a[220:221], v18 offset:34816
    v_mfma_f32_16x16x32_bf16 a[164:167], a[192:195], a[180:183], a[164:167]
    ds_read_b64_tr_b16 a[222:223], v18 offset:39936
    buffer_load_dwordx4 v27, s[28:31], s67 offen offset:3072 lds
    s_waitcnt vmcnt(14)
    s_waitcnt lgkmcnt(8)
    v_mfma_f32_16x16x32_bf16 a[172:175], a[196:199], a[180:183], a[172:175]
    ds_read_b64_tr_b16 a[192:193], v19 offset:34848
    s_add_u32 s97, s97, 32768
    v_mov_b32 v8, 1
    s_mov_b64 exec, 1
    buffer_store_dword v8, off, s[24:27], s97 sc1
    s_mov_b64 exec, -1
    v_mfma_f32_16x16x32_bf16 a[168:171], a[196:199], a[176:179], a[168:171]
    ds_read_b64_tr_b16 a[194:195], v19 offset:39968
    v_mfma_f32_16x16x32_bf16 a[96:99], a[200:203], a[184:187], a[96:99]
    ds_read_b64_tr_b16 a[196:197], v18 offset:34880
    v_mfma_f32_16x16x32_bf16 a[100:103], a[200:203], a[188:191], a[100:103]
    ds_read_b64_tr_b16 a[198:199], v18 offset:40000
    s_add_u32 s53, s53, 4096
    buffer_load_dwordx4 v[64:67], v35, s[24:27], s53 offen offset:0 sc1
    v_mfma_f32_16x16x32_bf16 a[108:111], a[204:207], a[188:191], a[108:111]
    ds_read_b64_tr_b16 a[200:201], v19 offset:34912
    v_mfma_f32_16x16x32_bf16 a[104:107], a[204:207], a[184:187], a[104:107]
    ds_read_b64_tr_b16 a[202:203], v19 offset:40032
    s_waitcnt lgkmcnt(8)
    v_mfma_f32_16x16x32_bf16 a[112:115], a[208:211], a[184:187], a[112:115]
    ds_read_b64_tr_b16 a[204:205], v18 offset:34944
    v_mfma_f32_16x16x32_bf16 a[116:119], a[208:211], a[188:191], a[116:119]
    ds_read_b64_tr_b16 a[206:207], v18 offset:40064
    s_add_u32 m0, m0, 4096
    s_nop 0
    buffer_load_dwordx4 v28, s[28:31], s67 offen offset:0 lds
    v_mfma_f32_16x16x32_bf16 a[124:127], a[212:215], a[188:191], a[124:127]
    ds_read_b64_tr_b16 a[208:209], v20 offset:0
    v_mfma_f32_16x16x32_bf16 a[120:123], a[212:215], a[184:187], a[120:123]
    ds_read_b64_tr_b16 a[210:211], v20 offset:5120
    v_mfma_f32_16x16x32_bf16 a[128:131], a[216:219], a[184:187], a[128:131]
    ds_read_b64_tr_b16 a[212:213], v21 offset:32
    v_mfma_f32_16x16x32_bf16 a[132:135], a[216:219], a[188:191], a[132:135]
    ds_read_b64_tr_b16 a[214:215], v21 offset:5152
    s_waitcnt lgkmcnt(8)
    v_mfma_f32_16x16x32_bf16 a[140:143], a[220:223], a[188:191], a[140:143]
    ds_read_b64_tr_b16 a[216:217], v20 offset:64
    v_mfma_f32_16x16x32_bf16 a[136:139], a[220:223], a[184:187], a[136:139]
    ds_read_b64_tr_b16 a[218:219], v20 offset:5184
    buffer_load_dwordx4 v[68:71], v35, s[24:27], s53 offen offset:1024 sc1
    v_mfma_f32_16x16x32_bf16 a[144:147], a[192:195], a[184:187], a[144:147]
    ds_read_b64_tr_b16 a[220:221], v21 offset:96
    v_mfma_f32_16x16x32_bf16 a[148:151], a[192:195], a[188:191], a[148:151]
    ds_read_b64_tr_b16 a[222:223], v21 offset:5216
    s_add_u32 m0, s83, 49152
    s_add_u32 s67, s23, 163840
    buffer_load_dwordx4 v24, s[28:31], s67 offen offset:0 lds
    v_mfma_f32_16x16x32_bf16 a[156:159], a[196:199], a[188:191], a[156:159]
    ds_read_b64_tr_b16 a[192:193], v20 offset:128
    v_mfma_f32_16x16x32_bf16 a[152:155], a[196:199], a[184:187], a[152:155]
    ds_read_b64_tr_b16 a[194:195], v20 offset:5248
    s_waitcnt lgkmcnt(8)
    v_mfma_f32_16x16x32_bf16 a[160:163], a[200:203], a[184:187], a[160:163]
    ds_read_b64_tr_b16 a[196:197], v22 offset:0
    v_mfma_f32_16x16x32_bf16 a[164:167], a[200:203], a[188:191], a[164:167]
    ds_read_b64_tr_b16 a[198:199], v22 offset:5120
    s_waitcnt vmcnt(25)
    v_mfma_f32_16x16x32_bf16 a[172:175], a[204:207], a[188:191], a[172:175]
    ds_read_b64_tr_b16 a[200:201], v23 offset:32
    v_mfma_f32_16x16x32_bf16 a[168:171], a[204:207], a[184:187], a[168:171]
    ds_read_b64_tr_b16 a[202:203], v23 offset:5152
    v_mfma_f32_16x16x32_bf16 a[96:99], a[208:211], a[224:227], a[96:99]
    ds_read_b64_tr_b16 a[204:205], v22 offset:64
    v_mfma_f32_16x16x32_bf16 a[100:103], a[208:211], a[228:231], a[100:103]
    ds_read_b64_tr_b16 a[206:207], v22 offset:5184
    buffer_load_dwordx4 v25, s[28:31], s67 offen offset:1024 lds
    s_waitcnt lgkmcnt(8)
    v_mfma_f32_16x16x32_bf16 a[108:111], a[212:215], a[228:231], a[108:111]
    ds_read_b64_tr_b16 a[208:209], v23 offset:96
    buffer_load_dwordx4 v[72:75], v35, s[24:27], s53 offen offset:2048 sc1
    v_mfma_f32_16x16x32_bf16 a[104:107], a[212:215], a[224:227], a[104:107]
    ds_read_b64_tr_b16 a[210:211], v23 offset:5216
    v_mfma_f32_16x16x32_bf16 a[112:115], a[216:219], a[224:227], a[112:115]
    ds_read_b64_tr_b16 a[212:213], v22 offset:128
    v_mfma_f32_16x16x32_bf16 a[116:119], a[216:219], a[228:231], a[116:119]
    ds_read_b64_tr_b16 a[214:215], v22 offset:5248
    v_mfma_f32_16x16x32_bf16 a[124:127], a[220:223], a[228:231], a[124:127]
    ds_read_b64_tr_b16 a[216:217], v20 offset:10240
    v_mfma_f32_16x16x32_bf16 a[120:123], a[220:223], a[224:227], a[120:123]
    ds_read_b64_tr_b16 a[218:219], v20 offset:15360
    s_waitcnt lgkmcnt(8)
    v_mfma_f32_16x16x32_bf16 a[128:131], a[192:195], a[224:227], a[128:131]
    ds_read_b64_tr_b16 a[220:221], v21 offset:10272
    v_mfma_f32_16x16x32_bf16 a[132:135], a[192:195], a[228:231], a[132:135]
    ds_read_b64_tr_b16 a[222:223], v21 offset:15392
    buffer_load_dwordx4 v26, s[28:31], s67 offen offset:2048 lds
    v_mfma_f32_16x16x32_bf16 a[140:143], a[196:199], a[228:231], a[140:143]
    ds_read_b64_tr_b16 a[192:193], v20 offset:10304
    v_mfma_f32_16x16x32_bf16 a[136:139], a[196:199], a[224:227], a[136:139]
    ds_read_b64_tr_b16 a[194:195], v20 offset:15424
    buffer_load_dwordx4 v[76:79], v35, s[24:27], s53 offen offset:3072 sc1
    v_mfma_f32_16x16x32_bf16 a[144:147], a[200:203], a[224:227], a[144:147]
    ds_read_b64_tr_b16 a[196:197], v21 offset:10336
    v_mfma_f32_16x16x32_bf16 a[148:151], a[200:203], a[228:231], a[148:151]
    ds_read_b64_tr_b16 a[198:199], v21 offset:15456
    s_waitcnt lgkmcnt(8)
    v_mfma_f32_16x16x32_bf16 a[156:159], a[204:207], a[228:231], a[156:159]
    ds_read_b64_tr_b16 a[200:201], v20 offset:10368
    v_mfma_f32_16x16x32_bf16 a[152:155], a[204:207], a[224:227], a[152:155]
    ds_read_b64_tr_b16 a[202:203], v20 offset:15488
    v_mfma_f32_16x16x32_bf16 a[160:163], a[208:211], a[224:227], a[160:163]
    ds_read_b64_tr_b16 a[204:205], v22 offset:10240
    v_mfma_f32_16x16x32_bf16 a[164:167], a[208:211], a[228:231], a[164:167]
    ds_read_b64_tr_b16 a[206:207], v22 offset:15360
    buffer_load_dwordx4 v27, s[28:31], s67 offen offset:3072 lds
    v_mfma_f32_16x16x32_bf16 a[172:175], a[212:215], a[228:231], a[172:175]
    ds_read_b64_tr_b16 a[208:209], v23 offset:10272
    v_mfma_f32_16x16x32_bf16 a[168:171], a[212:215], a[224:227], a[168:171]
    ds_read_b64_tr_b16 a[210:211], v23 offset:15392
    s_waitcnt lgkmcnt(8)
    v_mfma_f32_16x16x32_bf16 a[96:99], a[216:219], a[232:235], a[96:99]
    ds_read_b64_tr_b16 a[212:213], v22 offset:10304
    v_mfma_f32_16x16x32_bf16 a[100:103], a[216:219], a[236:239], a[100:103]
    ds_read_b64_tr_b16 a[214:215], v22 offset:15424
    s_add_u32 s53, s53, 4096
    buffer_load_dwordx4 v[80:83], v35, s[24:27], s53 offen offset:0 sc1
    v_mfma_f32_16x16x32_bf16 a[108:111], a[220:223], a[236:239], a[108:111]
    ds_read_b64_tr_b16 a[216:217], v23 offset:10336
    v_mfma_f32_16x16x32_bf16 a[104:107], a[220:223], a[232:235], a[104:107]
    ds_read_b64_tr_b16 a[218:219], v23 offset:15456
    v_mfma_f32_16x16x32_bf16 a[112:115], a[192:195], a[232:235], a[112:115]
    ds_read_b64_tr_b16 a[220:221], v22 offset:10368
    v_mfma_f32_16x16x32_bf16 a[116:119], a[192:195], a[236:239], a[116:119]
    ds_read_b64_tr_b16 a[222:223], v22 offset:15488
    s_add_u32 m0, m0, 4096
    s_nop 0
    buffer_load_dwordx4 v28, s[28:31], s67 offen offset:0 lds
    s_waitcnt lgkmcnt(8)
    v_mfma_f32_16x16x32_bf16 a[124:127], a[196:199], a[236:239], a[124:127]
    s_waitcnt vmcnt(18)
    s_barrier
    ds_read_b64_tr_b16 a[192:193], v20 offset:20480
    v_mfma_f32_16x16x32_bf16 a[120:123], a[196:199], a[232:235], a[120:123]
    ds_read_b64_tr_b16 a[194:195], v20 offset:25600
    v_mfma_f32_16x16x32_bf16 a[128:131], a[200:203], a[232:235], a[128:131]
    ds_read_b64_tr_b16 a[196:197], v21 offset:20512
    v_mfma_f32_16x16x32_bf16 a[132:135], a[200:203], a[236:239], a[132:135]
    ds_read_b64_tr_b16 a[198:199], v21 offset:25632
    v_mfma_f32_16x16x32_bf16 a[140:143], a[204:207], a[236:239], a[140:143]
    ds_read_b64_tr_b16 a[200:201], v20 offset:20544
    v_mfma_f32_16x16x32_bf16 a[136:139], a[204:207], a[232:235], a[136:139]
    ds_read_b64_tr_b16 a[202:203], v20 offset:25664
    buffer_load_dwordx4 v[84:87], v35, s[24:27], s53 offen offset:1024 sc1
    s_waitcnt lgkmcnt(8)
    v_mfma_f32_16x16x32_bf16 a[144:147], a[208:211], a[232:235], a[144:147]
    ds_read_b64_tr_b16 a[204:205], v21 offset:20576
    v_mfma_f32_16x16x32_bf16 a[148:151], a[208:211], a[236:239], a[148:151]
    ds_read_b64_tr_b16 a[206:207], v21 offset:25696
    s_add_u32 m0, s83, 24576
    s_add_u32 s67, s21, 3932160
    buffer_load_dwordx4 v24, s[28:31], s67 offen offset:0 lds
    v_mfma_f32_16x16x32_bf16 a[156:159], a[212:215], a[236:239], a[156:159]
    ds_read_b64_tr_b16 a[208:209], v20 offset:20608
    v_mfma_f32_16x16x32_bf16 a[152:155], a[212:215], a[232:235], a[152:155]
    ds_read_b64_tr_b16 a[210:211], v20 offset:25728
    v_mfma_f32_16x16x32_bf16 a[160:163], a[216:219], a[232:235], a[160:163]
    ds_read_b64_tr_b16 a[212:213], v22 offset:20480
    v_mfma_f32_16x16x32_bf16 a[164:167], a[216:219], a[236:239], a[164:167]
    ds_read_b64_tr_b16 a[214:215], v22 offset:25600
    s_waitcnt lgkmcnt(8)
    v_mfma_f32_16x16x32_bf16 a[172:175], a[220:223], a[236:239], a[172:175]
    ds_read_b64_tr_b16 a[216:217], v23 offset:20512
    v_mfma_f32_16x16x32_bf16 a[168:171], a[220:223], a[232:235], a[168:171]
    ds_read_b64_tr_b16 a[218:219], v23 offset:25632
    v_mfma_f32_16x16x32_bf16 a[96:99], a[192:195], a[240:243], a[96:99]
    ds_read_b64_tr_b16 a[220:221], v22 offset:20544
    v_mfma_f32_16x16x32_bf16 a[100:103], a[192:195], a[244:247], a[100:103]
    ds_read_b64_tr_b16 a[222:223], v22 offset:25664
    buffer_load_dwordx4 v25, s[28:31], s67 offen offset:1024 lds
    v_mfma_f32_16x16x32_bf16 a[108:111], a[196:199], a[244:247], a[108:111]
    ds_read_b64_tr_b16 a[192:193], v23 offset:20576
    buffer_load_dwordx4 v[88:91], v35, s[24:27], s53 offen offset:2048 sc1
    s_add_u32 s98, s98, 32768
    v_mfma_f32_16x16x32_bf16 a[104:107], a[196:199], a[240:243], a[104:107]
    ds_read_b64_tr_b16 a[194:195], v23 offset:25696
    s_waitcnt lgkmcnt(8)
    v_mfma_f32_16x16x32_bf16 a[112:115], a[200:203], a[240:243], a[112:115]
    ds_read_b64_tr_b16 a[196:197], v22 offset:20608
    buffer_load_dwordx4 v[252:255], off, s[24:27], s98 sc1
    v_mfma_f32_16x16x32_bf16 a[116:119], a[200:203], a[244:247], a[116:119]
    ds_read_b64_tr_b16 a[198:199], v22 offset:25728
    v_mfma_f32_16x16x32_bf16 a[124:127], a[204:207], a[244:247], a[124:127]
    ds_read_b64_tr_b16 a[200:201], v20 offset:30720
    v_mfma_f32_16x16x32_bf16 a[120:123], a[204:207], a[240:243], a[120:123]
    ds_read_b64_tr_b16 a[202:203], v20 offset:35840
    v_mfma_f32_16x16x32_bf16 a[128:131], a[208:211], a[240:243], a[128:131]
    ds_read_b64_tr_b16 a[204:205], v21 offset:30752
    v_mfma_f32_16x16x32_bf16 a[132:135], a[208:211], a[244:247], a[132:135]
    ds_read_b64_tr_b16 a[206:207], v21 offset:35872
    buffer_load_dwordx4 v26, s[28:31], s67 offen offset:2048 lds
    s_waitcnt lgkmcnt(8)
    v_mfma_f32_16x16x32_bf16 a[140:143], a[212:215], a[244:247], a[140:143]
    ds_read_b64_tr_b16 a[208:209], v20 offset:30784
    v_mfma_f32_16x16x32_bf16 a[136:139], a[212:215], a[240:243], a[136:139]
    ds_read_b64_tr_b16 a[210:211], v20 offset:35904
    buffer_load_dwordx4 v[92:95], v35, s[24:27], s53 offen offset:3072 sc1
    v_mfma_f32_16x16x32_bf16 a[144:147], a[216:219], a[240:243], a[144:147]
    ds_read_b64_tr_b16 a[212:213], v21 offset:30816
    v_mfma_f32_16x16x32_bf16 a[148:151], a[216:219], a[244:247], a[148:151]
    ds_read_b64_tr_b16 a[214:215], v21 offset:35936
    v_mfma_f32_16x16x32_bf16 a[156:159], a[220:223], a[244:247], a[156:159]
    ds_read_b64_tr_b16 a[216:217], v20 offset:30848
    v_mfma_f32_16x16x32_bf16 a[152:155], a[220:223], a[240:243], a[152:155]
    ds_read_b64_tr_b16 a[218:219], v20 offset:35968
    s_waitcnt lgkmcnt(8)
    v_mfma_f32_16x16x32_bf16 a[160:163], a[192:195], a[240:243], a[160:163]
    ds_read_b64_tr_b16 a[220:221], v22 offset:30720
    v_mfma_f32_16x16x32_bf16 a[164:167], a[192:195], a[244:247], a[164:167]
    ds_read_b64_tr_b16 a[222:223], v22 offset:35840
    buffer_load_dwordx4 v27, s[28:31], s67 offen offset:3072 lds
    v_mfma_f32_16x16x32_bf16 a[172:175], a[196:199], a[244:247], a[172:175]
    ds_read_b64_tr_b16 a[192:193], v23 offset:30752
    v_mfma_f32_16x16x32_bf16 a[168:171], a[196:199], a[240:243], a[168:171]
    ds_read_b64_tr_b16 a[194:195], v23 offset:35872
    v_mfma_f32_16x16x32_bf16 a[96:99], a[200:203], a[248:251], a[96:99]
    ds_read_b64_tr_b16 a[196:197], v22 offset:30784
    v_mfma_f32_16x16x32_bf16 a[100:103], a[200:203], a[252:255], a[100:103]
    ds_read_b64_tr_b16 a[198:199], v22 offset:35904
    s_waitcnt lgkmcnt(8)
    v_mfma_f32_16x16x32_bf16 a[108:111], a[204:207], a[252:255], a[108:111]
    ds_read_b64_tr_b16 a[200:201], v23 offset:30816
    v_mfma_f32_16x16x32_bf16 a[104:107], a[204:207], a[248:251], a[104:107]
    ds_read_b64_tr_b16 a[202:203], v23 offset:35936
    v_mfma_f32_16x16x32_bf16 a[112:115], a[208:211], a[248:251], a[112:115]
    ds_read_b64_tr_b16 a[204:205], v22 offset:30848
    v_mfma_f32_16x16x32_bf16 a[116:119], a[208:211], a[252:255], a[116:119]
    ds_read_b64_tr_b16 a[206:207], v22 offset:35968
    s_add_u32 m0, m0, 4096
    s_nop 0
    buffer_load_dwordx4 v28, s[28:31], s67 offen offset:0 lds
    v_mfma_f32_16x16x32_bf16 a[124:127], a[212:215], a[252:255], a[124:127]
    ds_read_b64_tr_b16 a[208:209], v20 offset:40960
    v_mfma_f32_16x16x32_bf16 a[120:123], a[212:215], a[248:251], a[120:123]
    ds_read_b64_tr_b16 a[210:211], v20 offset:46080
    s_waitcnt lgkmcnt(8)
    v_mfma_f32_16x16x32_bf16 a[128:131], a[216:219], a[248:251], a[128:131]
    ds_read_b64_tr_b16 a[212:213], v21 offset:40992
    v_mfma_f32_16x16x32_bf16 a[132:135], a[216:219], a[252:255], a[132:135]
    ds_read_b64_tr_b16 a[214:215], v21 offset:46112
    v_mfma_f32_16x16x32_bf16 a[140:143], a[220:223], a[252:255], a[140:143]
    ds_read_b64_tr_b16 a[216:217], v20 offset:41024
    v_mfma_f32_16x16x32_bf16 a[136:139], a[220:223], a[248:251], a[136:139]
    ds_read_b64_tr_b16 a[218:219], v20 offset:46144
    v_mfma_f32_16x16x32_bf16 a[144:147], a[192:195], a[248:251], a[144:147]
    ds_read_b64_tr_b16 a[220:221], v21 offset:41056
    v_mfma_f32_16x16x32_bf16 a[148:151], a[192:195], a[252:255], a[148:151]
    ds_read_b64_tr_b16 a[222:223], v21 offset:46176
    s_add_u32 m0, s83, 73728
    s_add_u32 s67, s21, 4014080
    buffer_load_dwordx4 v24, s[28:31], s67 offen offset:0 lds
    s_waitcnt lgkmcnt(8)
    v_mfma_f32_16x16x32_bf16 a[156:159], a[196:199], a[252:255], a[156:159]
    ds_read_b64_tr_b16 a[192:193], v20 offset:41088
    v_mfma_f32_16x16x32_bf16 a[152:155], a[196:199], a[248:251], a[152:155]
    ds_read_b64_tr_b16 a[194:195], v20 offset:46208
    v_mfma_f32_16x16x32_bf16 a[160:163], a[200:203], a[248:251], a[160:163]
    ds_read_b64_tr_b16 a[196:197], v22 offset:40960
    v_mfma_f32_16x16x32_bf16 a[164:167], a[200:203], a[252:255], a[164:167]
    ds_read_b64_tr_b16 a[198:199], v22 offset:46080
    s_waitcnt vmcnt(22)
    v_mfma_f32_16x16x32_bf16 a[172:175], a[204:207], a[252:255], a[172:175]
    ds_read_b64_tr_b16 a[200:201], v23 offset:40992
    v_mfma_f32_16x16x32_bf16 a[168:171], a[204:207], a[248:251], a[168:171]
    ds_read_b64_tr_b16 a[202:203], v23 offset:46112
    s_waitcnt lgkmcnt(8)
    v_mfma_f32_16x16x32_bf16 a[96:99], a[208:211], v[48:51], a[96:99]
    ds_read_b64_tr_b16 a[204:205], v22 offset:41024
    v_mfma_f32_16x16x32_bf16 a[100:103], a[208:211], v[52:55], a[100:103]
    ds_read_b64_tr_b16 a[206:207], v22 offset:46144
    buffer_load_dwordx4 v25, s[28:31], s67 offen offset:1024 lds
    s_waitcnt vmcnt(6)
    v_mfma_f32_16x16x32_bf16 a[108:111], a[212:215], v[52:55], a[108:111]
    ds_read_b64_tr_b16 a[208:209], v23 offset:41056
L_c2:
    v_and_b32 v252, v252, v253
    v_and_b32 v254, v254, v255
    v_and_b32 v252, v252, v254
    s_nop 0
    v_readfirstlane_b32 s52, v252
    s_cmp_eq_u32 s52, 1
    s_cbranch_scc1 L_c2d
    buffer_load_dwordx4 v[252:255], off, s[24:27], s98 sc1
    s_waitcnt vmcnt(0)
    s_sub_u32 s96, s96, 1
    s_cbranch_scc0 L_c2
    s_mov_b32 s96, 0
L_c2d:
    v_mfma_f32_16x16x32_bf16 a[104:107], a[212:215], v[48:51], a[104:107]
    ds_read_b64_tr_b16 a[210:211], v23 offset:46176
    s_mul_i32 s53, s93, 49152
    s_add_u32 s53, s53, s66
    s_add_u32 s53, s53, 786432
    buffer_load_dwordx4 a[48:51], v35, s[24:27], s53 offen offset:0 sc1
    v_mfma_f32_16x16x32_bf16 a[112:115], a[216:219], v[48:51], a[112:115]
    ds_read_b64_tr_b16 a[212:213], v22 offset:41088
    v_mfma_f32_16x16x32_bf16 a[116:119], a[216:219], v[52:55], a[116:119]
    ds_read_b64_tr_b16 a[214:215], v22 offset:46208
    buffer_load_dwordx4 a[52:55], v35, s[24:27], s53 offen offset:1024 sc1
    s_waitcnt lgkmcnt(8)
    v_mfma_f32_16x16x32_bf16 a[124:127], a[220:223], v[52:55], a[124:127]
    ds_read_b64_tr_b16 a[216:217], v20 offset:51200
    v_mfma_f32_16x16x32_bf16 a[120:123], a[220:223], v[48:51], a[120:123]
    ds_read_b64_tr_b16 a[218:219], v20 offset:56320
    v_mfma_f32_16x16x32_bf16 a[128:131], a[192:195], v[48:51], a[128:131]
    ds_read_b64_tr_b16 a[220:221], v21 offset:51232
    v_mfma_f32_16x16x32_bf16 a[132:135], a[192:195], v[52:55], a[132:135]
    ds_read_b64_tr_b16 a[222:223], v21 offset:56352
    buffer_load_dwordx4 v26, s[28:31], s67 offen offset:2048 lds
    v_mfma_f32_16x16x32_bf16 a[140:143], a[196:199], v[52:55], a[140:143]
    ds_read_b64_tr_b16 a[192:193], v20 offset:51264
    v_mfma_f32_16x16x32_bf16 a[136:139], a[196:199], v[48:51], a[136:139]
    ds_read_b64_tr_b16 a[194:195], v20 offset:56384
    buffer_load_dwordx4 a[56:59], v35, s[24:27], s53 offen offset:2048 sc1
    s_waitcnt lgkmcnt(8)
    v_mfma_f32_16x16x32_bf16 a[144:147], a[200:203], v[48:51], a[144:147]
    ds_read_b64_tr_b16 a[196:197], v21 offset:51296
    v_mfma_f32_16x16x32_bf16 a[148:151], a[200:203], v[52:55], a[148:151]
    ds_read_b64_tr_b16 a[198:199], v21 offset:56416
    v_mfma_f32_16x16x32_bf16 a[156:159], a[204:207], v[52:55], a[156:159]
    ds_read_b64_tr_b16 a[200:201], v20 offset:51328
    v_mfma_f32_16x16x32_bf16 a[152:155], a[204:207], v[48:51], a[152:155]
    ds_read_b64_tr_b16 a[202:203], v20 offset:56448
    buffer_load_dwordx4 a[60:63], v35, s[24:27], s53 offen offset:3072 sc1
    v_mfma_f32_16x16x32_bf16 a[160:163], a[208:211], v[48:51], a[160:163]
    ds_read_b64_tr_b16 a[204:205], v22 offset:51200
    v_mfma_f32_16x16x32_bf16 a[164:167], a[208:211], v[52:55], a[164:167]
    ds_read_b64_tr_b16 a[206:207], v22 offset:56320
    buffer_load_dwordx4 v27, s[28:31], s67 offen offset:3072 lds
    s_waitcnt lgkmcnt(8)
    v_mfma_f32_16x16x32_bf16 a[172:175], a[212:215], v[52:55], a[172:175]
    ds_read_b64_tr_b16 a[208:209], v23 offset:51232
    v_mfma_f32_16x16x32_bf16 a[168:171], a[212:215], v[48:51], a[168:171]
    ds_read_b64_tr_b16 a[210:211], v23 offset:56352
    v_mfma_f32_16x16x32_bf16 a[96:99], a[216:219], v[56:59], a[96:99]
    ds_read_b64_tr_b16 a[212:213], v22 offset:51264
    v_mfma_f32_16x16x32_bf16 a[100:103], a[216:219], v[60:63], a[100:103]
    ds_read_b64_tr_b16 a[214:215], v22 offset:56384
    s_add_u32 s53, s53, 4096
    buffer_load_dwordx4 a[64:67], v35, s[24:27], s53 offen offset:0 sc1
    v_mfma_f32_16x16x32_bf16 a[108:111], a[220:223], v[60:63], a[108:111]
    ds_read_b64_tr_b16 a[216:217], v23 offset:51296
    v_mfma_f32_16x16x32_bf16 a[104:107], a[220:223], v[56:59], a[104:107]
    ds_read_b64_tr_b16 a[218:219], v23 offset:56416
    s_waitcnt lgkmcnt(8)
    v_mfma_f32_16x16x32_bf16 a[112:115], a[192:195], v[56:59], a[112:115]
    ds_read_b64_tr_b16 a[220:221], v22 offset:51328
    v_mfma_f32_16x16x32_bf16 a[116:119], a[192:195], v[60:63], a[116:119]
    ds_read_b64_tr_b16 a[222:223], v22 offset:56448
    s_add_u32 m0, m0, 4096
    s_nop 0
    buffer_load_dwordx4 v28, s[28:31], s67 offen offset:0 lds
    v_mfma_f32_16x16x32_bf16 a[124:127], a[196:199], v[60:63], a[124:127]
    s_waitcnt vmcnt(19)
    s_barrier
    ds_read_b64_tr_b16 a[192:193], v12 offset:0
    v_mfma_f32_16x16x32_bf16 a[120:123], a[196:199], v[56:59], a[120:123]
    ds_read_b64_tr_b16 a[194:195], v12 offset:5120
    v_mfma_f32_16x16x32_bf16 a[128:131], a[200:203], v[56:59], a[128:131]
    ds_read_b64_tr_b16 a[196:197], v13 offset:32
    v_mfma_f32_16x16x32_bf16 a[132:135], a[200:203], v[60:63], a[132:135]
    ds_read_b64_tr_b16 a[198:199], v13 offset:5152
    s_waitcnt lgkmcnt(8)
    v_mfma_f32_16x16x32_bf16 a[140:143], a[204:207], v[60:63], a[140:143]
    ds_read_b64_tr_b16 a[200:201], v12 offset:64
    v_mfma_f32_16x16x32_bf16 a[136:139], a[204:207], v[56:59], a[136:139]
    ds_read_b64_tr_b16 a[202:203], v12 offset:5184
    buffer_load_dwordx4 a[68:71], v35, s[24:27], s53 offen offset:1024 sc1
    v_mfma_f32_16x16x32_bf16 a[144:147], a[208:211], v[56:59], a[144:147]
    ds_read_b64_tr_b16 a[204:205], v13 offset:96
    v_mfma_f32_16x16x32_bf16 a[148:151], a[208:211], v[60:63], a[148:151]
    ds_read_b64_tr_b16 a[206:207], v13 offset:5216
    s_add_u32 m0, s83, 102400
    s_add_u32 s67, s21, 4096000
    buffer_load_dwordx4 v24, s[28:31], s67 offen offset:0 lds
    v_mfma_f32_16x16x32_bf16 a[156:159], a[212:215], v[60:63], a[156:159]
    ds_read_b64_tr_b16 a[208:209], v12 offset:128
    v_mfma_f32_16x16x32_bf16 a[152:155], a[212:215], v[56:59], a[152:155]
    ds_read_b64_tr_b16 a[210:211], v12 offset:5248
    s_waitcnt lgkmcnt(8)
    v_mfma_f32_16x16x32_bf16 a[160:163], a[216:219], v[56:59], a[160:163]
    ds_read_b64_tr_b16 a[212:213], v14 offset:0
    v_mfma_f32_16x16x32_bf16 a[164:167], a[216:219], v[60:63], a[164:167]
    ds_read_b64_tr_b16 a[214:215], v14 offset:5120
    v_mfma_f32_16x16x32_bf16 a[172:175], a[220:223], v[60:63], a[172:175]
    ds_read_b64_tr_b16 a[216:217], v15 offset:32
    v_mfma_f32_16x16x32_bf16 a[168:171], a[220:223], v[56:59], a[168:171]
    ds_read_b64_tr_b16 a[218:219], v15 offset:5152
    v_mfma_f32_16x16x32_bf16 a[96:99], a[192:195], v[64:67], a[96:99]
    ds_read_b64_tr_b16 a[220:221], v14 offset:64
    v_mfma_f32_16x16x32_bf16 a[100:103], a[192:195], v[68:71], a[100:103]
    ds_read_b64_tr_b16 a[222:223], v14 offset:5184
    buffer_load_dwordx4 v25, s[28:31], s67 offen offset:1024 lds
    s_waitcnt lgkmcnt(8)
    v_mfma_f32_16x16x32_bf16 a[108:111], a[196:199], v[68:71], a[108:111]
    ds_read_b64_tr_b16 a[192:193], v15 offset:96
    buffer_load_dwordx4 a[72:75], v35, s[24:27], s53 offen offset:2048 sc1
    v_mfma_f32_16x16x32_bf16 a[104:107], a[196:199], v[64:67], a[104:107]
    ds_read_b64_tr_b16 a[194:195], v15 offset:5216
    v_mfma_f32_16x16x32_bf16 a[112:115], a[200:203], v[64:67], a[112:115]
    ds_read_b64_tr_b16 a[196:197], v14 offset:128
    v_mfma_f32_16x16x32_bf16 a[116:119], a[200:203], v[68:71], a[116:119]
    ds_read_b64_tr_b16 a[198:199], v14 offset:5248
    v_mfma_f32_16x16x32_bf16 a[124:127], a[204:207], v[68:71], a[124:127]
    ds_read_b64_tr_b16 a[200:201], v12 offset:10240
    v_mfma_f32_16x16x32_bf16 a[120:123], a[204:207], v[64:67], a[120:123]
    ds_read_b64_tr_b16 a[202:203], v12 offset:15360
    s_waitcnt lgkmcnt(8)
    v_mfma_f32_16x16x32_bf16 a[128:131], a[208:211], v[64:67], a[128:131]
    ds_read_b64_tr_b16 a[204:205], v13 offset:10272
    v_mfma_f32_16x16x32_bf16 a[132:135], a[208:211], v[68:71], a[132:135]
    ds_read_b64_tr_b16 a[206:207], v13 offset:15392
    buffer_load_dwordx4 v26, s[28:31], s67 offen offset:2048 lds
    v_mfma_f32_16x16x32_bf16 a[140:143], a[212:215], v[68:71], a[140:143]
    ds_read_b64_tr_b16 a[208:209], v12 offset:10304
    v_mfma_f32_16x16x32_bf16 a[136:139], a[212:215], v[64:67], a[136:139]
    ds_read_b64_tr_b16 a[210:211], v12 offset:15424
    buffer_load_dwordx4 a[76:79], v35, s[24:27], s53 offen offset:3072 sc1
    v_mfma_f32_16x16x32_bf16 a[144:147], a[216:219], v[64:67], a[144:147]
    ds_read_b64_tr_b16 a[212:213], v13 offset:10336
    v_mfma_f32_16x16x32_bf16 a[148:151], a[216:219], v[68:71], a[148:151]
    ds_read_b64_tr_b16 a[214:215], v13 offset:15456
    s_waitcnt lgkmcnt(8)
    v_mfma_f32_16x16x32_bf16 a[156:159], a[220:223], v[68:71], a[156:159]
    ds_read_b64_tr_b16 a[216:217], v12 offset:10368
    v_mfma_f32_16x16x32_bf16 a[152:155], a[220:223], v[64:67], a[152:155]
    ds_read_b64_tr_b16 a[218:219], v12 offset:15488
    v_mfma_f32_16x16x32_bf16 a[160:163], a[192:195], v[64:67], a[160:163]
    ds_read_b64_tr_b16 a[220:221], v14 offset:10240
    v_mfma_f32_16x16x32_bf16 a[164:167], a[192:195], v[68:71], a[164:167]
    ds_read_b64_tr_b16 a[222:223], v14 offset:15360
    buffer_load_dwordx4 v27, s[28:31], s67 offen offset:3072 lds
    v_mfma_f32_16x16x32_bf16 a[172:175], a[196:199], v[68:71], a[172:175]
    ds_read_b64_tr_b16 a[192:193], v15 offset:10272
    v_mfma_f32_16x16x32_bf16 a[168:171], a[196:199], v[64:67], a[168:171]
    ds_read_b64_tr_b16 a[194:195], v15 offset:15392
    s_waitcnt lgkmcnt(8)
    v_mfma_f32_16x16x32_bf16 a[96:99], a[200:203], v[72:75], a[96:99]
    ds_read_b64_tr_b16 a[196:197], v14 offset:10304
    v_mfma_f32_16x16x32_bf16 a[100:103], a[200:203], v[76:79], a[100:103]
    ds_read_b64_tr_b16 a[198:199], v14 offset:15424
    s_add_u32 s53, s53, 4096
    buffer_load_dwordx4 a[80:83], v35, s[24:27], s53 offen offset:0 sc1
    v_mfma_f32_16x16x32_bf16 a[108:111], a[204:207], v[76:79], a[108:111]
    ds_read_b64_tr_b16 a[200:201], v15 offset:10336
    v_mfma_f32_16x16x32_bf16 a[104:107], a[204:207], v[72:75], a[104:107]
    ds_read_b64_tr_b16 a[202:203], v15 offset:15456
    v_mfma_f32_16x16x32_bf16 a[112:115], a[208:211], v[72:75], a[112:115]
    ds_read_b64_tr_b16 a[204:205], v14 offset:10368
    v_mfma_f32_16x16x32_bf16 a[116:119], a[208:211], v[76:79], a[116:119]
    ds_read_b64_tr_b16 a[206:207], v14 offset:15488
    s_add_u32 m0, m0, 4096
    s_nop 0
    buffer_load_dwordx4 v28, s[28:31], s67 offen offset:0 lds
    s_waitcnt lgkmcnt(8)
    v_mfma_f32_16x16x32_bf16 a[124:127], a[212:215], v[76:79], a[124:127]
    ds_read_b64_tr_b16 a[208:209], v16 offset:0
    v_mfma_f32_16x16x32_bf16 a[120:123], a[212:215], v[72:75], a[120:123]
    ds_read_b64_tr_b16 a[210:211], v16 offset:5120
    v_mfma_f32_16x16x32_bf16 a[128:131], a[216:219], v[72:75], a[128:131]
    ds_read_b64_tr_b16 a[212:213], v17 offset:32
    v_mfma_f32_16x16x32_bf16 a[132:135], a[216:219], v[76:79], a[132:135]
    ds_read_b64_tr_b16 a[214:215], v17 offset:5152
    v_mfma_f32_16x16x32_bf16 a[140:143], a[220:223], v[76:79], a[140:143]
    ds_read_b64_tr_b16 a[216:217], v16 offset:64
    v_mfma_f32_16x16x32_bf16 a[136:139], a[220:223], v[72:75], a[136:139]
    ds_read_b64_tr_b16 a[218:219], v16 offset:5184
    buffer_load_dwordx4 a[84:87], v35, s[24:27], s53 offen offset:1024 sc1
    s_waitcnt lgkmcnt(8)
    v_mfma_f32_16x16x32_bf16 a[144:147], a[192:195], v[72:75], a[144:147]
    ds_read_b64_tr_b16 a[220:221], v17 offset:96
    v_mfma_f32_16x16x32_bf16 a[148:151], a[192:195], v[76:79], a[148:151]
    ds_read_b64_tr_b16 a[222:223], v17 offset:5216
    s_add_u32 m0, s83, 122880
    s_add_u32 s67, s22, 3932160
    buffer_load_dwordx4 v24, s[28:31], s67 offen offset:0 lds
    v_mfma_f32_16x16x32_bf16 a[156:159], a[196:199], v[76:79], a[156:159]
    ds_read_b64_tr_b16 a[192:193], v16 offset:128
    v_mfma_f32_16x16x32_bf16 a[152:155], a[196:199], v[72:75], a[152:155]
    ds_read_b64_tr_b16 a[194:195], v16 offset:5248
    v_mfma_f32_16x16x32_bf16 a[160:163], a[200:203], v[72:75], a[160:163]
    ds_read_b64_tr_b16 a[196:197], v18 offset:0
    v_mfma_f32_16x16x32_bf16 a[164:167], a[200:203], v[76:79], a[164:167]
    ds_read_b64_tr_b16 a[198:199], v18 offset:5120
    s_waitcnt vmcnt(23)
    s_waitcnt lgkmcnt(8)
    v_mfma_f32_16x16x32_bf16 a[172:175], a[204:207], v[76:79], a[172:175]
    ds_read_b64_tr_b16 a[200:201], v19 offset:32
    v_mfma_f32_16x16x32_bf16 a[168:171], a[204:207], v[72:75], a[168:171]
    ds_read_b64_tr_b16 a[202:203], v19 offset:5152
    v_mfma_f32_16x16x32_bf16 a[96:99], a[208:211], v[80:83], a[96:99]
    ds_read_b64_tr_b16 a[204:205], v18 offset:64
    v_mfma_f32_16x16x32_bf16 a[100:103], a[208:211], v[84:87], a[100:103]
    ds_read_b64_tr_b16 a[206:207], v18 offset:5184
    buffer_load_dwordx4 v25, s[28:31], s67 offen offset:1024 lds
    v_mfma_f32_16x16x32_bf16 a[108:111], a[212:215], v[84:87], a[108:111]
    ds_read_b64_tr_b16 a[208:209], v19 offset:96
    buffer_load_dwordx4 a[88:91], v35, s[24:27], s53 offen offset:2048 sc1
    v_mfma_f32_16x16x32_bf16 a[104:107], a[212:215], v[80:83], a[104:107]
    ds_read_b64_tr_b16 a[210:211], v19 offset:5216
    s_waitcnt lgkmcnt(8)
    v_mfma_f32_16x16x32_bf16 a[112:115], a[216:219], v[80:83], a[112:115]
    ds_read_b64_tr_b16 a[212:213], v18 offset:128
    v_mfma_f32_16x16x32_bf16 a[116:119], a[216:219], v[84:87], a[116:119]
    ds_read_b64_tr_b16 a[214:215], v18 offset:5248
    v_mfma_f32_16x16x32_bf16 a[124:127], a[220:223], v[84:87], a[124:127]
    ds_read_b64_tr_b16 a[216:217], v16 offset:10240
    v_mfma_f32_16x16x32_bf16 a[120:123], a[220:223], v[80:83], a[120:123]
    ds_read_b64_tr_b16 a[218:219], v16 offset:15360
    v_mfma_f32_16x16x32_bf16 a[128:131], a[192:195], v[80:83], a[128:131]
    ds_read_b64_tr_b16 a[220:221], v17 offset:10272
    v_mfma_f32_16x16x32_bf16 a[132:135], a[192:195], v[84:87], a[132:135]
    ds_read_b64_tr_b16 a[222:223], v17 offset:15392
    buffer_load_dwordx4 v26, s[28:31], s67 offen offset:2048 lds
    s_waitcnt lgkmcnt(8)
    v_mfma_f32_16x16x32_bf16 a[140:143], a[196:199], v[84:87], a[140:143]
    ds_read_b64_tr_b16 a[192:193], v16 offset:10304
    v_mfma_f32_16x16x32_bf16 a[136:139], a[196:199], v[80:83], a[136:139]
    ds_read_b64_tr_b16 a[194:195], v16 offset:15424
    buffer_load_dwordx4 a[92:95], v35, s[24:27], s53 offen offset:3072 sc1
    v_mfma_f32_16x16x32_bf16 a[144:147], a[200:203], v[80:83], a[144:147]
    ds_read_b64_tr_b16 a[196:197], v17 offset:10336
    v_mfma_f32_16x16x32_bf16 a[148:151], a[200:203], v[84:87], a[148:151]
    ds_read_b64_tr_b16 a[198:199], v17 offset:15456
    v_mfma_f32_16x16x32_bf16 a[156:159], a[204:207], v[84:87], a[156:159]
    ds_read_b64_tr_b16 a[200:201], v16 offset:10368
    v_mfma_f32_16x16x32_bf16 a[152:155], a[204:207], v[80:83], a[152:155]
    ds_read_b64_tr_b16 a[202:203], v16 offset:15488
    s_waitcnt lgkmcnt(8)
    v_mfma_f32_16x16x32_bf16 a[160:163], a[208:211], v[80:83], a[160:163]
    ds_read_b64_tr_b16 a[204:205], v18 offset:10240
    v_mfma_f32_16x16x32_bf16 a[164:167], a[208:211], v[84:87], a[164:167]
    ds_read_b64_tr_b16 a[206:207], v18 offset:15360
    buffer_load_dwordx4 v27, s[28:31], s67 offen offset:3072 lds
    v_mfma_f32_16x16x32_bf16 a[172:175], a[212:215], v[84:87], a[172:175]
    ds_read_b64_tr_b16 a[208:209], v19 offset:10272
    v_mfma_f32_16x16x32_bf16 a[168:171], a[212:215], v[80:83], a[168:171]
    ds_read_b64_tr_b16 a[210:211], v19 offset:15392
    v_mfma_f32_16x16x32_bf16 a[96:99], a[216:219], v[88:91], a[96:99]
    ds_read_b64_tr_b16 a[212:213], v18 offset:10304
    v_mfma_f32_16x16x32_bf16 a[100:103], a[216:219], v[92:95], a[100:103]
    ds_read_b64_tr_b16 a[214:215], v18 offset:15424
    s_mul_i32 s53, s94, 49152
    s_add_u32 s53, s53, s66
    s_add_u32 s53, s53, 786432
    buffer_load_dwordx4 v[96:99], v35, s[24:27], s53 offen offset:0 sc1
    s_waitcnt lgkmcnt(8)
    v_mfma_f32_16x16x32_bf16 a[108:111], a[220:223], v[92:95], a[108:111]
    ds_read_b64_tr_b16 a[216:217], v19 offset:10336
    v_mfma_f32_16x16x32_bf16 a[104:107], a[220:223], v[88:91], a[104:107]
    ds_read_b64_tr_b16 a[218:219], v19 offset:15456
    v_mfma_f32_16x16x32_bf16 a[112:115], a[192:195], v[88:91], a[112:115]
    ds_read_b64_tr_b16 a[220:221], v18 offset:10368
    v_mfma_f32_16x16x32_bf16 a[116:119], a[192:195], v[92:95], a[116:119]
    ds_read_b64_tr_b16 a[222:223], v18 offset:15488
    s_add_u32 m0, m0, 4096
    s_nop 0
    buffer_load_dwordx4 v28, s[28:31], s67 offen offset:0 lds
    v_mfma_f32_16x16x32_bf16 a[124:127], a[196:199], v[92:95], a[124:127]
    s_waitcnt vmcnt(18)
    s_barrier
    ds_read_b64_tr_b16 a[192:193], v12 offset:24576
    v_mfma_f32_16x16x32_bf16 a[120:123], a[196:199], v[88:91], a[120:123]
    ds_read_b64_tr_b16 a[194:195], v12 offset:29696
    s_waitcnt lgkmcnt(8)
    v_mfma_f32_16x16x32_bf16 a[128:131], a[200:203], v[88:91], a[128:131]
    ds_read_b64_tr_b16 a[196:197], v13 offset:24608
    v_mfma_f32_16x16x32_bf16 a[132:135], a[200:203], v[92:95], a[132:135]
    ds_read_b64_tr_b16 a[198:199], v13 offset:29728
    v_mfma_f32_16x16x32_bf16 a[140:143], a[204:207], v[92:95], a[140:143]
    ds_read_b64_tr_b16 a[200:201], v12 offset:24640
    v_mfma_f32_16x16x32_bf16 a[136:139], a[204:207], v[88:91], a[136:139]
    ds_read_b64_tr_b16 a[202:203], v12 offset:29760
    buffer_load_dwordx4 v[100:103], v35, s[24:27], s53 offen offset:1024 sc1
    v_mfma_f32_16x16x32_bf16 a[144:147], a[208:211], v[88:91], a[144:147]
    ds_read_b64_tr_b16 a[204:205], v13 offset:24672
    v_mfma_f32_16x16x32_bf16 a[148:151], a[208:211], v[92:95], a[148:151]
    ds_read_b64_tr_b16 a[206:207], v13 offset:29792
    s_add_u32 m0, s83, 143360
    s_add_u32 s67, s22, 4014080
    buffer_load_dwordx4 v24, s[28:31], s67 offen offset:0 lds
    s_waitcnt lgkmcnt(8)
    v_mfma_f32_16x16x32_bf16 a[156:159], a[212:215], v[92:95], a[156:159]
    ds_read_b64_tr_b16 a[208:209], v12 offset:24704
    v_mfma_f32_16x16x32_bf16 a[152:155], a[212:215], v[88:91], a[152:155]
    ds_read_b64_tr_b16 a[210:211], v12 offset:29824
    v_mfma_f32_16x16x32_bf16 a[160:163], a[216:219], v[88:91], a[160:163]
    ds_read_b64_tr_b16 a[212:213], v14 offset:24576
    v_mfma_f32_16x16x32_bf16 a[164:167], a[216:219], v[92:95], a[164:167]
    ds_read_b64_tr_b16 a[214:215], v14 offset:29696
    v_mfma_f32_16x16x32_bf16 a[172:175], a[220:223], v[92:95], a[172:175]
    ds_read_b64_tr_b16 a[216:217], v15 offset:24608
    v_mfma_f32_16x16x32_bf16 a[168:171], a[220:223], v[88:91], a[168:171]
    ds_read_b64_tr_b16 a[218:219], v15 offset:29728
    s_waitcnt lgkmcnt(8)
    v_mfma_f32_16x16x32_bf16 a[96:99], a[192:195], a[48:51], a[96:99]
    ds_read_b64_tr_b16 a[220:221], v14 offset:24640
    v_mfma_f32_16x16x32_bf16 a[100:103], a[192:195], a[52:55], a[100:103]
    ds_read_b64_tr_b16 a[222:223], v14 offset:29760
    buffer_load_dwordx4 v25, s[28:31], s67 offen offset:1024 lds
    v_mfma_f32_16x16x32_bf16 a[108:111], a[196:199], a[52:55], a[108:111]
    ds_read_b64_tr_b16 a[192:193], v15 offset:24672
    buffer_load_dwordx4 v[104:107], v35, s[24:27], s53 offen offset:2048 sc1
    v_mfma_f32_16x16x32_bf16 a[104:107], a[196:199], a[48:51], a[104:107]
    ds_read_b64_tr_b16 a[194:195], v15 offset:29792
    v_mfma_f32_16x16x32_bf16 a[112:115], a[200:203], a[48:51], a[112:115]
    ds_read_b64_tr_b16 a[196:197], v14 offset:24704
    v_mfma_f32_16x16x32_bf16 a[116:119], a[200:203], a[52:55], a[116:119]
    ds_read_b64_tr_b16 a[198:199], v14 offset:29824
    s_waitcnt lgkmcnt(8)
    v_mfma_f32_16x16x32_bf16 a[124:127], a[204:207], a[52:55], a[124:127]
    ds_read_b64_tr_b16 a[200:201], v12 offset:34816
    v_mfma_f32_16x16x32_bf16 a[120:123], a[204:207], a[48:51], a[120:123]
    ds_read_b64_tr_b16 a[202:203], v12 offset:39936
    v_mfma_f32_16x16x32_bf16 a[128:131], a[208:211], a[48:51], a[128:131]
    ds_read_b64_tr_b16 a[204:205], v13 offset:34848
    v_mfma_f32_16x16x32_bf16 a[132:135], a[208:211], a[52:55], a[132:135]
    ds_read_b64_tr_b16 a[206:207], v13 offset:39968
    buffer_load_dwordx4 v26, s[28:31], s67 offen offset:2048 lds
    v_mfma_f32_16x16x32_bf16 a[140:143], a[212:215], a[52:55], a[140:143]
    ds_read_b64_tr_b16 a[208:209], v12 offset:34880
    v_mfma_f32_16x16x32_bf16 a[136:139], a[212:215], a[48:51], a[136:139]
    ds_read_b64_tr_b16 a[210:211], v12 offset:40000
    buffer_load_dwordx4 v[108:111], v35, s[24:27], s53 offen offset:3072 sc1
    s_waitcnt lgkmcnt(8)
    v_mfma_f32_16x16x32_bf16 a[144:147], a[216:219], a[48:51], a[144:147]
    ds_read_b64_tr_b16 a[212:213], v13 offset:34912
    v_mfma_f32_16x16x32_bf16 a[148:151], a[216:219], a[52:55], a[148:151]
    ds_read_b64_tr_b16 a[214:215], v13 offset:40032
    v_mfma_f32_16x16x32_bf16 a[156:159], a[220:223], a[52:55], a[156:159]
    ds_read_b64_tr_b16 a[216:217], v12 offset:34944
    v_mfma_f32_16x16x32_bf16 a[152:155], a[220:223], a[48:51], a[152:155]
    ds_read_b64_tr_b16 a[218:219], v12 offset:40064
    v_mfma_f32_16x16x32_bf16 a[160:163], a[192:195], a[48:51], a[160:163]
    ds_read_b64_tr_b16 a[220:221], v14 offset:34816
    v_mfma_f32_16x16x32_bf16 a[164:167], a[192:195], a[52:55], a[164:167]
    ds_read_b64_tr_b16 a[222:223], v14 offset:39936
    buffer_load_dwordx4 v27, s[28:31], s67 offen offset:3072 lds
    s_waitcnt lgkmcnt(8)
    v_mfma_f32_16x16x32_bf16 a[172:175], a[196:199], a[52:55], a[172:175]
    ds_read_b64_tr_b16 a[192:193], v15 offset:34848
    v_mfma_f32_16x16x32_bf16 a[168:171], a[196:199], a[48:51], a[168:171]
    ds_read_b64_tr_b16 a[194:195], v15 offset:39968
    v_mfma_f32_16x16x32_bf16 a[96:99], a[200:203], a[56:59], a[96:99]
    ds_read_b64_tr_b16 a[196:197], v14 offset:34880
    v_mfma_f32_16x16x32_bf16 a[100:103], a[200:203], a[60:63], a[100:103]
    ds_read_b64_tr_b16 a[198:199], v14 offset:40000
    s_add_u32 s53, s53, 4096
    buffer_load_dwordx4 v[208:211], v35, s[24:27], s53 offen offset:0 sc1
    v_mfma_f32_16x16x32_bf16 a[108:111], a[204:207], a[60:63], a[108:111]
    ds_read_b64_tr_b16 a[200:201], v15 offset:34912
    v_mfma_f32_16x16x32_bf16 a[104:107], a[204:207], a[56:59], a[104:107]
    ds_read_b64_tr_b16 a[202:203], v15 offset:40032
    s_waitcnt lgkmcnt(8)
    v_mfma_f32_16x16x32_bf16 a[112:115], a[208:211], a[56:59], a[112:115]
    ds_read_b64_tr_b16 a[204:205], v14 offset:34944
    v_mfma_f32_16x16x32_bf16 a[116:119], a[208:211], a[60:63], a[116:119]
    ds_read_b64_tr_b16 a[206:207], v14 offset:40064
    s_add_u32 m0, m0, 4096
    s_nop 0
    buffer_load_dwordx4 v28, s[28:31], s67 offen offset:0 lds
    v_mfma_f32_16x16x32_bf16 a[124:127], a[212:215], a[60:63], a[124:127]
    ds_read_b64_tr_b16 a[208:209], v16 offset:24576
    v_mfma_f32_16x16x32_bf16 a[120:123], a[212:215], a[56:59], a[120:123]
    ds_read_b64_tr_b16 a[210:211], v16 offset:29696
    v_mfma_f32_16x16x32_bf16 a[128:131], a[216:219], a[56:59], a[128:131]
    ds_read_b64_tr_b16 a[212:213], v17 offset:24608
    v_mfma_f32_16x16x32_bf16 a[132:135], a[216:219], a[60:63], a[132:135]
    ds_read_b64_tr_b16 a[214:215], v17 offset:29728
    s_waitcnt lgkmcnt(8)
    v_mfma_f32_16x16x32_bf16 a[140:143], a[220:223], a[60:63], a[140:143]
    ds_read_b64_tr_b16 a[216:217], v16 offset:24640
    v_mfma_f32_16x16x32_bf16 a[136:139], a[220:223], a[56:59], a[136:139]
    ds_read_b64_tr_b16 a[218:219], v16 offset:29760
    buffer_load_dwordx4 v[212:215], v35, s[24:27], s53 offen offset:1024 sc1
    v_mfma_f32_16x16x32_bf16 a[144:147], a[192:195], a[56:59], a[144:147]
    ds_read_b64_tr_b16 a[220:221], v17 offset:24672
    v_mfma_f32_16x16x32_bf16 a[148:151], a[192:195], a[60:63], a[148:151]
    ds_read_b64_tr_b16 a[222:223], v17 offset:29792
    s_add_u32 m0, s83, 0
    s_add_u32 s67, s22, 4096000
    buffer_load_dwordx4 v24, s[28:31], s67 offen offset:0 lds
    v_mfma_f32_16x16x32_bf16 a[156:159], a[196:199], a[60:63], a[156:159]
    ds_read_b64_tr_b16 a[192:193], v16 offset:24704
    v_mfma_f32_16x16x32_bf16 a[152:155], a[196:199], a[56:59], a[152:155]
    ds_read_b64_tr_b16 a[194:195], v16 offset:29824
    s_waitcnt lgkmcnt(8)
    v_mfma_f32_16x16x32_bf16 a[160:163], a[200:203], a[56:59], a[160:163]
    ds_read_b64_tr_b16 a[196:197], v18 offset:24576
    v_mfma_f32_16x16x32_bf16 a[164:167], a[200:203], a[60:63], a[164:167]
    ds_read_b64_tr_b16 a[198:199], v18 offset:29696
    s_waitcnt vmcnt(23)
    v_mfma_f32_16x16x32_bf16 a[172:175], a[204:207], a[60:63], a[172:175]
    ds_read_b64_tr_b16 a[200:201], v19 offset:24608
    v_mfma_f32_16x16x32_bf16 a[168:171], a[204:207], a[56:59], a[168:171]
    ds_read_b64_tr_b16 a[202:203], v19 offset:29728
    v_mfma_f32_16x16x32_bf16 a[96:99], a[208:211], a[64:67], a[96:99]
    ds_read_b64_tr_b16 a[204:205], v18 offset:24640
    v_mfma_f32_16x16x32_bf16 a[100:103], a[208:211], a[68:71], a[100:103]
    ds_read_b64_tr_b16 a[206:207], v18 offset:29760
    buffer_load_dwordx4 v25, s[28:31], s67 offen offset:1024 lds
    s_waitcnt lgkmcnt(8)
    v_mfma_f32_16x16x32_bf16 a[108:111], a[212:215], a[68:71], a[108:111]
    ds_read_b64_tr_b16 a[208:209], v19 offset:24672
    buffer_load_dwordx4 v[216:219], v35, s[24:27], s53 offen offset:2048 sc1
    v_mfma_f32_16x16x32_bf16 a[104:107], a[212:215], a[64:67], a[104:107]
    ds_read_b64_tr_b16 a[210:211], v19 offset:29792
    v_mfma_f32_16x16x32_bf16 a[112:115], a[216:219], a[64:67], a[112:115]
    ds_read_b64_tr_b16 a[212:213], v18 offset:24704
    v_mfma_f32_16x16x32_bf16 a[116:119], a[216:219], a[68:71], a[116:119]
    ds_read_b64_tr_b16 a[214:215], v18 offset:29824
    v_mfma_f32_16x16x32_bf16 a[124:127], a[220:223], a[68:71], a[124:127]
    ds_read_b64_tr_b16 a[216:217], v16 offset:34816
    v_mfma_f32_16x16x32_bf16 a[120:123], a[220:223], a[64:67], a[120:123]
    ds_read_b64_tr_b16 a[218:219], v16 offset:39936
    s_waitcnt lgkmcnt(8)
    v_mfma_f32_16x16x32_bf16 a[128:131], a[192:195], a[64:67], a[128:131]
    ds_read_b64_tr_b16 a[220:221], v17 offset:34848
    v_mfma_f32_16x16x32_bf16 a[132:135], a[192:195], a[68:71], a[132:135]
    ds_read_b64_tr_b16 a[222:223], v17 offset:39968
    buffer_load_dwordx4 v26, s[28:31], s67 offen offset:2048 lds
    v_mfma_f32_16x16x32_bf16 a[140:143], a[196:199], a[68:71], a[140:143]
    ds_read_b64_tr_b16 a[192:193], v16 offset:34880
    v_mfma_f32_16x16x32_bf16 a[136:139], a[196:199], a[64:67], a[136:139]
    ds_read_b64_tr_b16 a[194:195], v16 offset:40000
    buffer_load_dwordx4 v[220:223], v35, s[24:27], s53 offen offset:3072 sc1
    v_mfma_f32_16x16x32_bf16 a[144:147], a[200:203], a[64:67], a[144:147]
    ds_read_b64_tr_b16 a[196:197], v17 offset:34912
    v_mfma_f32_16x16x32_bf16 a[148:151], a[200:203], a[68:71], a[148:151]
    ds_read_b64_tr_b16 a[198:199], v17 offset:40032
    s_waitcnt lgkmcnt(8)
    v_mfma_f32_16x16x32_bf16 a[156:159], a[204:207], a[68:71], a[156:159]
    ds_read_b64_tr_b16 a[200:201], v16 offset:34944
    v_mfma_f32_16x16x32_bf16 a[152:155], a[204:207], a[64:67], a[152:155]
    ds_read_b64_tr_b16 a[202:203], v16 offset:40064
    v_mfma_f32_16x16x32_bf16 a[160:163], a[208:211], a[64:67], a[160:163]
    ds_read_b64_tr_b16 a[204:205], v18 offset:34816
    v_mfma_f32_16x16x32_bf16 a[164:167], a[208:211], a[68:71], a[164:167]
    ds_read_b64_tr_b16 a[206:207], v18 offset:39936
    buffer_load_dwordx4 v27, s[28:31], s67 offen offset:3072 lds
    v_mfma_f32_16x16x32_bf16 a[172:175], a[212:215], a[68:71], a[172:175]
    ds_read_b64_tr_b16 a[208:209], v19 offset:34848
    v_mfma_f32_16x16x32_bf16 a[168:171], a[212:215], a[64:67], a[168:171]
    ds_read_b64_tr_b16 a[210:211], v19 offset:39968
    s_waitcnt lgkmcnt(8)
    v_mfma_f32_16x16x32_bf16 a[96:99], a[216:219], a[72:75], a[96:99]
    ds_read_b64_tr_b16 a[212:213], v18 offset:34880
    v_mfma_f32_16x16x32_bf16 a[100:103], a[216:219], a[76:79], a[100:103]
    ds_read_b64_tr_b16 a[214:215], v18 offset:40000
    s_add_u32 s53, s53, 4096
    buffer_load_dwordx4 v[224:227], v35, s[24:27], s53 offen offset:0 sc1
    v_mfma_f32_16x16x32_bf16 a[108:111], a[220:223], a[76:79], a[108:111]
    ds_read_b64_tr_b16 a[216:217], v19 offset:34912
    v_mfma_f32_16x16x32_bf16 a[104:107], a[220:223], a[72:75], a[104:107]
    ds_read_b64_tr_b16 a[218:219], v19 offset:40032
    v_mfma_f32_16x16x32_bf16 a[112:115], a[192:195], a[72:75], a[112:115]
    ds_read_b64_tr_b16 a[220:221], v18 offset:34944
    v_mfma_f32_16x16x32_bf16 a[116:119], a[192:195], a[76:79], a[116:119]
    ds_read_b64_tr_b16 a[222:223], v18 offset:40064
    s_add_u32 m0, m0, 4096
    s_nop 0
    buffer_load_dwordx4 v28, s[28:31], s67 offen offset:0 lds
    s_waitcnt lgkmcnt(8)
    v_mfma_f32_16x16x32_bf16 a[124:127], a[196:199], a[76:79], a[124:127]
    s_waitcnt vmcnt(18)
    s_barrier
    ds_read_b64_tr_b16 a[192:193], v20 offset:0
    v_mfma_f32_16x16x32_bf16 a[120:123], a[196:199], a[72:75], a[120:123]
    ds_read_b64_tr_b16 a[194:195], v20 offset:5120
    v_mfma_f32_16x16x32_bf16 a[128:131], a[200:203], a[72:75], a[128:131]
    ds_read_b64_tr_b16 a[196:197], v21 offset:32
    v_mfma_f32_16x16x32_bf16 a[132:135], a[200:203], a[76:79], a[132:135]
    ds_read_b64_tr_b16 a[198:199], v21 offset:5152
    v_mfma_f32_16x16x32_bf16 a[140:143], a[204:207], a[76:79], a[140:143]
    ds_read_b64_tr_b16 a[200:201], v20 offset:64
    v_mfma_f32_16x16x32_bf16 a[136:139], a[204:207], a[72:75], a[136:139]
    ds_read_b64_tr_b16 a[202:203], v20 offset:5184
    buffer_load_dwordx4 v[228:231], v35, s[24:27], s53 offen offset:1024 sc1
    s_waitcnt lgkmcnt(8)
    v_mfma_f32_16x16x32_bf16 a[144:147], a[208:211], a[72:75], a[144:147]
    ds_read_b64_tr_b16 a[204:205], v21 offset:96
    v_mfma_f32_16x16x32_bf16 a[148:151], a[208:211], a[76:79], a[148:151]
    ds_read_b64_tr_b16 a[206:207], v21 offset:5216
    s_add_u32 m0, s83, 49152
    s_add_u32 s67, s23, 3932160
    buffer_load_dwordx4 v24, s[28:31], s67 offen offset:0 lds
    v_mfma_f32_16x16x32_bf16 a[156:159], a[212:215], a[76:79], a[156:159]
    ds_read_b64_tr_b16 a[208:209], v20 offset:128
    v_mfma_f32_16x16x32_bf16 a[152:155], a[212:215], a[72:75], a[152:155]
    ds_read_b64_tr_b16 a[210:211], v20 offset:5248
    v_mfma_f32_16x16x32_bf16 a[160:163], a[216:219], a[72:75], a[160:163]
    ds_read_b64_tr_b16 a[212:213], v22 offset:0
    v_mfma_f32_16x16x32_bf16 a[164:167], a[216:219], a[76:79], a[164:167]
    ds_read_b64_tr_b16 a[214:215], v22 offset:5120
    s_waitcnt lgkmcnt(8)
    v_mfma_f32_16x16x32_bf16 a[172:175], a[220:223], a[76:79], a[172:175]
    ds_read_b64_tr_b16 a[216:217], v23 offset:32
    v_mfma_f32_16x16x32_bf16 a[168:171], a[220:223], a[72:75], a[168:171]
    ds_read_b64_tr_b16 a[218:219], v23 offset:5152
    v_mfma_f32_16x16x32_bf16 a[96:99], a[192:195], a[80:83], a[96:99]
    ds_read_b64_tr_b16 a[220:221], v22 offset:64
    v_mfma_f32_16x16x32_bf16 a[100:103], a[192:195], a[84:87], a[100:103]
    ds_read_b64_tr_b16 a[222:223], v22 offset:5184
    buffer_load_dwordx4 v25, s[28:31], s67 offen offset:1024 lds
    v_mfma_f32_16x16x32_bf16 a[108:111], a[196:199], a[84:87], a[108:111]
    ds_read_b64_tr_b16 a[192:193], v23 offset:96
    buffer_load_dwordx4 v[232:235], v35, s[24:27], s53 offen offset:2048 sc1
    v_mfma_f32_16x16x32_bf16 a[104:107], a[196:199], a[80:83], a[104:107]
    ds_read_b64_tr_b16 a[194:195], v23 offset:5216
    s_waitcnt lgkmcnt(8)
    v_mfma_f32_16x16x32_bf16 a[112:115], a[200:203], a[80:83], a[112:115]
    ds_read_b64_tr_b16 a[196:197], v22 offset:128
    v_mfma_f32_16x16x32_bf16 a[116:119], a[200:203], a[84:87], a[116:119]
    ds_read_b64_tr_b16 a[198:199], v22 offset:5248
    v_mfma_f32_16x16x32_bf16 a[124:127], a[204:207], a[84:87], a[124:127]
    ds_read_b64_tr_b16 a[200:201], v20 offset:10240
    v_mfma_f32_16x16x32_bf16 a[120:123], a[204:207], a[80:83], a[120:123]
    ds_read_b64_tr_b16 a[202:203], v20 offset:15360
    v_mfma_f32_16x16x32_bf16 a[128:131], a[208:211], a[80:83], a[128:131]
    ds_read_b64_tr_b16 a[204:205], v21 offset:10272
    v_mfma_f32_16x16x32_bf16 a[132:135], a[208:211], a[84:87], a[132:135]
    ds_read_b64_tr_b16 a[206:207], v21 offset:15392
    buffer_load_dwordx4 v26, s[28:31], s67 offen offset:2048 lds
    s_waitcnt lgkmcnt(8)
    v_mfma_f32_16x16x32_bf16 a[140:143], a[212:215], a[84:87], a[140:143]
    ds_read_b64_tr_b16 a[208:209], v20 offset:10304
    v_mfma_f32_16x16x32_bf16 a[136:139], a[212:215], a[80:83], a[136:139]
    ds_read_b64_tr_b16 a[210:211], v20 offset:15424
    buffer_load_dwordx4 v[236:239], v35, s[24:27], s53 offen offset:3072 sc1
    v_mfma_f32_16x16x32_bf16 a[144:147], a[216:219], a[80:83], a[144:147]
    ds_read_b64_tr_b16 a[212:213], v21 offset:10336
    v_mfma_f32_16x16x32_bf16 a[148:151], a[216:219], a[84:87], a[148:151]
    ds_read_b64_tr_b16 a[214:215], v21 offset:15456
    v_mfma_f32_16x16x32_bf16 a[156:159], a[220:223], a[84:87], a[156:159]
    ds_read_b64_tr_b16 a[216:217], v20 offset:10368
    v_mfma_f32_16x16x32_bf16 a[152:155], a[220:223], a[80:83], a[152:155]
    ds_read_b64_tr_b16 a[218:219], v20 offset:15488
    s_waitcnt lgkmcnt(8)
    v_mfma_f32_16x16x32_bf16 a[160:163], a[192:195], a[80:83], a[160:163]
    ds_read_b64_tr_b16 a[220:221], v22 offset:10240
    v_mfma_f32_16x16x32_bf16 a[164:167], a[192:195], a[84:87], a[164:167]
    ds_read_b64_tr_b16 a[222:223], v22 offset:15360
    buffer_load_dwordx4 v27, s[28:31], s67 offen offset:3072 lds
    v_mfma_f32_16x16x32_bf16 a[172:175], a[196:199], a[84:87], a[172:175]
    ds_read_b64_tr_b16 a[192:193], v23 offset:10272
    v_mfma_f32_16x16x32_bf16 a[168:171], a[196:199], a[80:83], a[168:171]
    ds_read_b64_tr_b16 a[194:195], v23 offset:15392
    v_mfma_f32_16x16x32_bf16 a[96:99], a[200:203], a[88:91], a[96:99]
    ds_read_b64_tr_b16 a[196:197], v22 offset:10304
    v_mfma_f32_16x16x32_bf16 a[100:103], a[200:203], a[92:95], a[100:103]
    ds_read_b64_tr_b16 a[198:199], v22 offset:15424
    s_mul_i32 s53, s95, 49152
    s_add_u32 s53, s53, s66
    s_add_u32 s53, s53, 786432
    buffer_load_dwordx4 v[120:123], v35, s[24:27], s53 offen offset:0 sc1
    s_waitcnt lgkmcnt(8)
    v_mfma_f32_16x16x32_bf16 a[108:111], a[204:207], a[92:95], a[108:111]
    ds_read_b64_tr_b16 a[200:201], v23 offset:10336
    v_mfma_f32_16x16x32_bf16 a[104:107], a[204:207], a[88:91], a[104:107]
    ds_read_b64_tr_b16 a[202:203], v23 offset:15456
    v_mfma_f32_16x16x32_bf16 a[112:115], a[208:211], a[88:91], a[112:115]
    ds_read_b64_tr_b16 a[204:205], v22 offset:10368
    v_mfma_f32_16x16x32_bf16 a[116:119], a[208:211], a[92:95], a[116:119]
    ds_read_b64_tr_b16 a[206:207], v22 offset:15488
    s_add_u32 m0, m0, 4096
    s_nop 0
    buffer_load_dwordx4 v28, s[28:31], s67 offen offset:0 lds
    v_mfma_f32_16x16x32_bf16 a[124:127], a[212:215], a[92:95], a[124:127]
    ds_read_b64_tr_b16 a[208:209], v20 offset:20480
    v_mfma_f32_16x16x32_bf16 a[120:123], a[212:215], a[88:91], a[120:123]
    ds_read_b64_tr_b16 a[210:211], v20 offset:25600
    s_waitcnt lgkmcnt(8)
    v_mfma_f32_16x16x32_bf16 a[128:131], a[216:219], a[88:91], a[128:131]
    ds_read_b64_tr_b16 a[212:213], v21 offset:20512
    v_mfma_f32_16x16x32_bf16 a[132:135], a[216:219], a[92:95], a[132:135]
    ds_read_b64_tr_b16 a[214:215], v21 offset:25632
    v_mfma_f32_16x16x32_bf16 a[140:143], a[220:223], a[92:95], a[140:143]
    ds_read_b64_tr_b16 a[216:217], v20 offset:20544
    v_mfma_f32_16x16x32_bf16 a[136:139], a[220:223], a[88:91], a[136:139]
    ds_read_b64_tr_b16 a[218:219], v20 offset:25664
    buffer_load_dwordx4 v[124:127], v35, s[24:27], s53 offen offset:1024 sc1
    v_mfma_f32_16x16x32_bf16 a[144:147], a[192:195], a[88:91], a[144:147]
    ds_read_b64_tr_b16 a[220:221], v21 offset:20576
    v_mfma_f32_16x16x32_bf16 a[148:151], a[192:195], a[92:95], a[148:151]
    ds_read_b64_tr_b16 a[222:223], v21 offset:25696
    s_add_u32 m0, s83, 24576
    s_add_u32 s67, s23, 4014080
    buffer_load_dwordx4 v24, s[28:31], s67 offen offset:0 lds
    s_waitcnt lgkmcnt(8)
    v_mfma_f32_16x16x32_bf16 a[156:159], a[196:199], a[92:95], a[156:159]
    ds_read_b64_tr_b16 a[192:193], v20 offset:20608
    v_mfma_f32_16x16x32_bf16 a[152:155], a[196:199], a[88:91], a[152:155]
    ds_read_b64_tr_b16 a[194:195], v20 offset:25728
    v_mfma_f32_16x16x32_bf16 a[160:163], a[200:203], a[88:91], a[160:163]
    ds_read_b64_tr_b16 a[196:197], v22 offset:20480
    v_mfma_f32_16x16x32_bf16 a[164:167], a[200:203], a[92:95], a[164:167]
    ds_read_b64_tr_b16 a[198:199], v22 offset:25600
    s_waitcnt vmcnt(23)
    v_mfma_f32_16x16x32_bf16 a[172:175], a[204:207], a[92:95], a[172:175]
    ds_read_b64_tr_b16 a[200:201], v23 offset:20512
    v_mfma_f32_16x16x32_bf16 a[168:171], a[204:207], a[88:91], a[168:171]
    ds_read_b64_tr_b16 a[202:203], v23 offset:25632
    s_waitcnt lgkmcnt(8)
    v_mfma_f32_16x16x32_bf16 a[96:99], a[208:211], v[96:99], a[96:99]
    ds_read_b64_tr_b16 a[204:205], v22 offset:20544
    v_mfma_f32_16x16x32_bf16 a[100:103], a[208:211], v[100:103], a[100:103]
    ds_read_b64_tr_b16 a[206:207], v22 offset:25664
    buffer_load_dwordx4 v25, s[28:31], s67 offen offset:1024 lds
    v_mfma_f32_16x16x32_bf16 a[108:111], a[212:215], v[100:103], a[108:111]
    ds_read_b64_tr_b16 a[208:209], v23 offset:20576
    buffer_load_dwordx4 v[136:139], v35, s[24:27], s53 offen offset:2048 sc1
    v_mfma_f32_16x16x32_bf16 a[104:107], a[212:215], v[96:99], a[104:107]
    ds_read_b64_tr_b16 a[210:211], v23 offset:25696
    v_mfma_f32_16x16x32_bf16 a[112:115], a[216:219], v[96:99], a[112:115]
    ds_read_b64_tr_b16 a[212:213], v22 offset:20608
    v_mfma_f32_16x16x32_bf16 a[116:119], a[216:219], v[100:103], a[116:119]
    ds_read_b64_tr_b16 a[214:215], v22 offset:25728
    s_waitcnt lgkmcnt(8)
    v_mfma_f32_16x16x32_bf16 a[124:127], a[220:223], v[100:103], a[124:127]
    ds_read_b64_tr_b16 a[216:217], v20 offset:30720
    v_mfma_f32_16x16x32_bf16 a[120:123], a[220:223], v[96:99], a[120:123]
    ds_read_b64_tr_b16 a[218:219], v20 offset:35840
    v_mfma_f32_16x16x32_bf16 a[128:131], a[192:195], v[96:99], a[128:131]
    ds_read_b64_tr_b16 a[220:221], v21 offset:30752
    v_mfma_f32_16x16x32_bf16 a[132:135], a[192:195], v[100:103], a[132:135]
    ds_read_b64_tr_b16 a[222:223], v21 offset:35872
    buffer_load_dwordx4 v26, s[28:31], s67 offen offset:2048 lds
    v_mfma_f32_16x16x32_bf16 a[140:143], a[196:199], v[100:103], a[140:143]
    ds_read_b64_tr_b16 a[192:193], v20 offset:30784
    v_mfma_f32_16x16x32_bf16 a[136:139], a[196:199], v[96:99], a[136:139]
    ds_read_b64_tr_b16 a[194:195], v20 offset:35904
    buffer_load_dwordx4 v[140:143], v35, s[24:27], s53 offen offset:3072 sc1
    s_waitcnt lgkmcnt(8)
    v_mfma_f32_16x16x32_bf16 a[144:147], a[200:203], v[96:99], a[144:147]
    ds_read_b64_tr_b16 a[196:197], v21 offset:30816
    v_mfma_f32_16x16x32_bf16 a[148:151], a[200:203], v[100:103], a[148:151]
    ds_read_b64_tr_b16 a[198:199], v21 offset:35936
    v_mfma_f32_16x16x32_bf16 a[156:159], a[204:207], v[100:103], a[156:159]
    ds_read_b64_tr_b16 a[200:201], v20 offset:30848
    v_mfma_f32_16x16x32_bf16 a[152:155], a[204:207], v[96:99], a[152:155]
    ds_read_b64_tr_b16 a[202:203], v20 offset:35968
    v_mfma_f32_16x16x32_bf16 a[160:163], a[208:211], v[96:99], a[160:163]
    ds_read_b64_tr_b16 a[204:205], v22 offset:30720
    v_mfma_f32_16x16x32_bf16 a[164:167], a[208:211], v[100:103], a[164:167]
    ds_read_b64_tr_b16 a[206:207], v22 offset:35840
    buffer_load_dwordx4 v27, s[28:31], s67 offen offset:3072 lds
    s_waitcnt lgkmcnt(8)
    v_mfma_f32_16x16x32_bf16 a[172:175], a[212:215], v[100:103], a[172:175]
    ds_read_b64_tr_b16 a[208:209], v23 offset:30752
    v_mfma_f32_16x16x32_bf16 a[168:171], a[212:215], v[96:99], a[168:171]
    ds_read_b64_tr_b16 a[210:211], v23 offset:35872
    v_mfma_f32_16x16x32_bf16 a[96:99], a[216:219], v[104:107], a[96:99]
    ds_read_b64_tr_b16 a[212:213], v22 offset:30784
    v_mfma_f32_16x16x32_bf16 a[100:103], a[216:219], v[108:111], a[100:103]
    ds_read_b64_tr_b16 a[214:215], v22 offset:35904
    s_add_u32 s53, s53, 4096
    buffer_load_dwordx4 v[152:155], v35, s[24:27], s53 offen offset:0 sc1
    v_mfma_f32_16x16x32_bf16 a[108:111], a[220:223], v[108:111], a[108:111]
    ds_read_b64_tr_b16 a[216:217], v23 offset:30816
    v_mfma_f32_16x16x32_bf16 a[104:107], a[220:223], v[104:107], a[104:107]
    ds_read_b64_tr_b16 a[218:219], v23 offset:35936
    s_waitcnt lgkmcnt(8)
    v_mfma_f32_16x16x32_bf16 a[112:115], a[192:195], v[104:107], a[112:115]
    ds_read_b64_tr_b16 a[220:221], v22 offset:30848
    v_mfma_f32_16x16x32_bf16 a[116:119], a[192:195], v[108:111], a[116:119]
    ds_read_b64_tr_b16 a[222:223], v22 offset:35968
    s_add_u32 m0, m0, 4096
    s_nop 0
    buffer_load_dwordx4 v28, s[28:31], s67 offen offset:0 lds
    v_mfma_f32_16x16x32_bf16 a[124:127], a[196:199], v[108:111], a[124:127]
    s_waitcnt vmcnt(18)
    s_barrier
    ds_read_b64_tr_b16 a[192:193], v20 offset:40960
    v_mfma_f32_16x16x32_bf16 a[120:123], a[196:199], v[104:107], a[120:123]
    ds_read_b64_tr_b16 a[194:195], v20 offset:46080
    v_mfma_f32_16x16x32_bf16 a[128:131], a[200:203], v[104:107], a[128:131]
    ds_read_b64_tr_b16 a[196:197], v21 offset:40992
    v_mfma_f32_16x16x32_bf16 a[132:135], a[200:203], v[108:111], a[132:135]
    ds_read_b64_tr_b16 a[198:199], v21 offset:46112
    s_waitcnt lgkmcnt(8)
    v_mfma_f32_16x16x32_bf16 a[140:143], a[204:207], v[108:111], a[140:143]
    ds_read_b64_tr_b16 a[200:201], v20 offset:41024
    v_mfma_f32_16x16x32_bf16 a[136:139], a[204:207], v[104:107], a[136:139]
    ds_read_b64_tr_b16 a[202:203], v20 offset:46144
    buffer_load_dwordx4 v[156:159], v35, s[24:27], s53 offen offset:1024 sc1
    v_mfma_f32_16x16x32_bf16 a[144:147], a[208:211], v[104:107], a[144:147]
    ds_read_b64_tr_b16 a[204:205], v21 offset:41056
    v_mfma_f32_16x16x32_bf16 a[148:151], a[208:211], v[108:111], a[148:151]
    ds_read_b64_tr_b16 a[206:207], v21 offset:46176
    s_add_u32 m0, s83, 73728
    s_add_u32 s67, s23, 4096000
    buffer_load_dwordx4 v24, s[28:31], s67 offen offset:0 lds
    v_mfma_f32_16x16x32_bf16 a[156:159], a[212:215], v[108:111], a[156:159]
    ds_read_b64_tr_b16 a[208:209], v20 offset:41088
    v_mfma_f32_16x16x32_bf16 a[152:155], a[212:215], v[104:107], a[152:155]
    ds_read_b64_tr_b16 a[210:211], v20 offset:46208
    s_waitcnt lgkmcnt(8)
    v_mfma_f32_16x16x32_bf16 a[160:163], a[216:219], v[104:107], a[160:163]
    ds_read_b64_tr_b16 a[212:213], v22 offset:40960
    v_mfma_f32_16x16x32_bf16 a[164:167], a[216:219], v[108:111], a[164:167]
    ds_read_b64_tr_b16 a[214:215], v22 offset:46080
    v_mfma_f32_16x16x32_bf16 a[172:175], a[220:223], v[108:111], a[172:175]
    ds_read_b64_tr_b16 a[216:217], v23 offset:40992
    v_mfma_f32_16x16x32_bf16 a[168:171], a[220:223], v[104:107], a[168:171]
    ds_read_b64_tr_b16 a[218:219], v23 offset:46112
    v_mfma_f32_16x16x32_bf16 a[96:99], a[192:195], v[208:211], a[96:99]
    ds_read_b64_tr_b16 a[220:221], v22 offset:41024
    v_mfma_f32_16x16x32_bf16 a[100:103], a[192:195], v[212:215], a[100:103]
    ds_read_b64_tr_b16 a[222:223], v22 offset:46144
    buffer_load_dwordx4 v25, s[28:31], s67 offen offset:1024 lds
    s_waitcnt lgkmcnt(8)
    v_mfma_f32_16x16x32_bf16 a[108:111], a[196:199], v[212:215], a[108:111]
    ds_read_b64_tr_b16 a[192:193], v23 offset:41056
    buffer_load_dwordx4 v[168:171], v35, s[24:27], s53 offen offset:2048 sc1
    v_mfma_f32_16x16x32_bf16 a[104:107], a[196:199], v[208:211], a[104:107]
    ds_read_b64_tr_b16 a[194:195], v23 offset:46176
    v_mfma_f32_16x16x32_bf16 a[112:115], a[200:203], v[208:211], a[112:115]
    ds_read_b64_tr_b16 a[196:197], v22 offset:41088
    v_mfma_f32_16x16x32_bf16 a[116:119], a[200:203], v[212:215], a[116:119]
    ds_read_b64_tr_b16 a[198:199], v22 offset:46208
    v_mfma_f32_16x16x32_bf16 a[124:127], a[204:207], v[212:215], a[124:127]
    ds_read_b64_tr_b16 a[200:201], v20 offset:51200
    v_mfma_f32_16x16x32_bf16 a[120:123], a[204:207], v[208:211], a[120:123]
    ds_read_b64_tr_b16 a[202:203], v20 offset:56320
    s_waitcnt lgkmcnt(8)
    v_mfma_f32_16x16x32_bf16 a[128:131], a[208:211], v[208:211], a[128:131]
    ds_read_b64_tr_b16 a[204:205], v21 offset:51232
    v_mfma_f32_16x16x32_bf16 a[132:135], a[208:211], v[212:215], a[132:135]
    ds_read_b64_tr_b16 a[206:207], v21 offset:56352
    buffer_load_dwordx4 v26, s[28:31], s67 offen offset:2048 lds
    v_mfma_f32_16x16x32_bf16 a[140:143], a[212:215], v[212:215], a[140:143]
    ds_read_b64_tr_b16 a[208:209], v20 offset:51264
    v_mfma_f32_16x16x32_bf16 a[136:139], a[212:215], v[208:211], a[136:139]
    ds_read_b64_tr_b16 a[210:211], v20 offset:56384
    buffer_load_dwordx4 v[172:175], v35, s[24:27], s53 offen offset:3072 sc1
    v_mfma_f32_16x16x32_bf16 a[144:147], a[216:219], v[208:211], a[144:147]
    ds_read_b64_tr_b16 a[212:213], v21 offset:51296
    v_mfma_f32_16x16x32_bf16 a[148:151], a[216:219], v[212:215], a[148:151]
    ds_read_b64_tr_b16 a[214:215], v21 offset:56416
    s_waitcnt lgkmcnt(8)
    v_mfma_f32_16x16x32_bf16 a[156:159], a[220:223], v[212:215], a[156:159]
    ds_read_b64_tr_b16 a[216:217], v20 offset:51328
    v_mfma_f32_16x16x32_bf16 a[152:155], a[220:223], v[208:211], a[152:155]
    ds_read_b64_tr_b16 a[218:219], v20 offset:56448
    v_mfma_f32_16x16x32_bf16 a[160:163], a[192:195], v[208:211], a[160:163]
    ds_read_b64_tr_b16 a[220:221], v22 offset:51200
    v_mfma_f32_16x16x32_bf16 a[164:167], a[192:195], v[212:215], a[164:167]
    ds_read_b64_tr_b16 a[222:223], v22 offset:56320
    buffer_load_dwordx4 v27, s[28:31], s67 offen offset:3072 lds
    v_mfma_f32_16x16x32_bf16 a[172:175], a[196:199], v[212:215], a[172:175]
    ds_read_b64_tr_b16 a[192:193], v23 offset:51232
    v_mfma_f32_16x16x32_bf16 a[168:171], a[196:199], v[208:211], a[168:171]
    ds_read_b64_tr_b16 a[194:195], v23 offset:56352
    s_waitcnt lgkmcnt(8)
    v_mfma_f32_16x16x32_bf16 a[96:99], a[200:203], v[216:219], a[96:99]
    ds_read_b64_tr_b16 a[196:197], v22 offset:51264
    v_mfma_f32_16x16x32_bf16 a[100:103], a[200:203], v[220:223], a[100:103]
    ds_read_b64_tr_b16 a[198:199], v22 offset:56384
    s_add_u32 s53, s53, 4096
    buffer_load_dwordx4 v[184:187], v35, s[24:27], s53 offen offset:0 sc1
    v_mfma_f32_16x16x32_bf16 a[108:111], a[204:207], v[220:223], a[108:111]
    ds_read_b64_tr_b16 a[200:201], v23 offset:51296
    v_mfma_f32_16x16x32_bf16 a[104:107], a[204:207], v[216:219], a[104:107]
    ds_read_b64_tr_b16 a[202:203], v23 offset:56416
    v_mfma_f32_16x16x32_bf16 a[112:115], a[208:211], v[216:219], a[112:115]
    ds_read_b64_tr_b16 a[204:205], v22 offset:51328
    v_mfma_f32_16x16x32_bf16 a[116:119], a[208:211], v[220:223], a[116:119]
    ds_read_b64_tr_b16 a[206:207], v22 offset:56448
    s_add_u32 m0, m0, 4096
    s_nop 0
    buffer_load_dwordx4 v28, s[28:31], s67 offen offset:0 lds
    s_waitcnt lgkmcnt(8)
    v_mfma_f32_16x16x32_bf16 a[124:127], a[212:215], v[220:223], a[124:127]
    ds_read_b64_tr_b16 a[208:209], v12 offset:0
    v_mfma_f32_16x16x32_bf16 a[120:123], a[212:215], v[216:219], a[120:123]
    ds_read_b64_tr_b16 a[210:211], v12 offset:5120
    v_mfma_f32_16x16x32_bf16 a[128:131], a[216:219], v[216:219], a[128:131]
    ds_read_b64_tr_b16 a[212:213], v13 offset:32
    v_mfma_f32_16x16x32_bf16 a[132:135], a[216:219], v[220:223], a[132:135]
    ds_read_b64_tr_b16 a[214:215], v13 offset:5152
    v_mfma_f32_16x16x32_bf16 a[140:143], a[220:223], v[220:223], a[140:143]
    ds_read_b64_tr_b16 a[216:217], v12 offset:64
    v_mfma_f32_16x16x32_bf16 a[136:139], a[220:223], v[216:219], a[136:139]
    ds_read_b64_tr_b16 a[218:219], v12 offset:5184
    buffer_load_dwordx4 v[188:191], v35, s[24:27], s53 offen offset:1024 sc1
    s_waitcnt lgkmcnt(8)
    v_mfma_f32_16x16x32_bf16 a[144:147], a[192:195], v[216:219], a[144:147]
    ds_read_b64_tr_b16 a[220:221], v13 offset:96
    v_mfma_f32_16x16x32_bf16 a[148:151], a[192:195], v[220:223], a[148:151]
    ds_read_b64_tr_b16 a[222:223], v13 offset:5216
    v_mfma_f32_16x16x32_bf16 a[156:159], a[196:199], v[220:223], a[156:159]
    ds_read_b64_tr_b16 a[192:193], v12 offset:128
    v_mfma_f32_16x16x32_bf16 a[152:155], a[196:199], v[216:219], a[152:155]
    ds_read_b64_tr_b16 a[194:195], v12 offset:5248
    v_mfma_f32_16x16x32_bf16 a[160:163], a[200:203], v[216:219], a[160:163]
    ds_read_b64_tr_b16 a[196:197], v14 offset:0
    v_mfma_f32_16x16x32_bf16 a[164:167], a[200:203], v[220:223], a[164:167]
    ds_read_b64_tr_b16 a[198:199], v14 offset:5120
    s_waitcnt vmcnt(22)
    s_waitcnt lgkmcnt(8)
    v_mfma_f32_16x16x32_bf16 a[172:175], a[204:207], v[220:223], a[172:175]
    ds_read_b64_tr_b16 a[200:201], v15 offset:32
    v_mfma_f32_16x16x32_bf16 a[168:171], a[204:207], v[216:219], a[168:171]
    ds_read_b64_tr_b16 a[202:203], v15 offset:5152
    v_mfma_f32_16x16x32_bf16 a[96:99], a[208:211], v[224:227], a[96:99]
    ds_read_b64_tr_b16 a[204:205], v14 offset:64
    v_mfma_f32_16x16x32_bf16 a[100:103], a[208:211], v[228:231], a[100:103]
    ds_read_b64_tr_b16 a[206:207], v14 offset:5184
    buffer_load_dwordx4 v[200:203], v35, s[24:27], s53 offen offset:2048 sc1
    v_mfma_f32_16x16x32_bf16 a[108:111], a[212:215], v[228:231], a[108:111]
    ds_read_b64_tr_b16 a[208:209], v15 offset:96
    v_mfma_f32_16x16x32_bf16 a[104:107], a[212:215], v[224:227], a[104:107]
    ds_read_b64_tr_b16 a[210:211], v15 offset:5216
    s_waitcnt lgkmcnt(8)
    v_mfma_f32_16x16x32_bf16 a[112:115], a[216:219], v[224:227], a[112:115]
    ds_read_b64_tr_b16 a[212:213], v14 offset:128
    v_mfma_f32_16x16x32_bf16 a[116:119], a[216:219], v[228:231], a[116:119]
    ds_read_b64_tr_b16 a[214:215], v14 offset:5248
    v_mfma_f32_16x16x32_bf16 a[124:127], a[220:223], v[228:231], a[124:127]
    ds_read_b64_tr_b16 a[216:217], v12 offset:10240
    v_mfma_f32_16x16x32_bf16 a[120:123], a[220:223], v[224:227], a[120:123]
    ds_read_b64_tr_b16 a[218:219], v12 offset:15360
    v_mfma_f32_16x16x32_bf16 a[128:131], a[192:195], v[224:227], a[128:131]
    ds_read_b64_tr_b16 a[220:221], v13 offset:10272
    v_mfma_f32_16x16x32_bf16 a[132:135], a[192:195], v[228:231], a[132:135]
    ds_read_b64_tr_b16 a[222:223], v13 offset:15392
    s_waitcnt lgkmcnt(8)
    v_mfma_f32_16x16x32_bf16 a[140:143], a[196:199], v[228:231], a[140:143]
    ds_read_b64_tr_b16 a[192:193], v12 offset:10304
    v_mfma_f32_16x16x32_bf16 a[136:139], a[196:199], v[224:227], a[136:139]
    ds_read_b64_tr_b16 a[194:195], v12 offset:15424
    buffer_load_dwordx4 v[204:207], v35, s[24:27], s53 offen offset:3072 sc1
    v_mfma_f32_16x16x32_bf16 a[144:147], a[200:203], v[224:227], a[144:147]
    ds_read_b64_tr_b16 a[196:197], v13 offset:10336
    v_mfma_f32_16x16x32_bf16 a[148:151], a[200:203], v[228:231], a[148:151]
    ds_read_b64_tr_b16 a[198:199], v13 offset:15456
    v_mfma_f32_16x16x32_bf16 a[156:159], a[204:207], v[228:231], a[156:159]
    ds_read_b64_tr_b16 a[200:201], v12 offset:10368
    v_mfma_f32_16x16x32_bf16 a[152:155], a[204:207], v[224:227], a[152:155]
    ds_read_b64_tr_b16 a[202:203], v12 offset:15488
    s_waitcnt lgkmcnt(8)
    v_mfma_f32_16x16x32_bf16 a[160:163], a[208:211], v[224:227], a[160:163]
    ds_read_b64_tr_b16 a[204:205], v14 offset:10240
    v_mfma_f32_16x16x32_bf16 a[164:167], a[208:211], v[228:231], a[164:167]
    ds_read_b64_tr_b16 a[206:207], v14 offset:15360
    v_mfma_f32_16x16x32_bf16 a[172:175], a[212:215], v[228:231], a[172:175]
    ds_read_b64_tr_b16 a[208:209], v15 offset:10272
    v_mfma_f32_16x16x32_bf16 a[168:171], a[212:215], v[224:227], a[168:171]
    ds_read_b64_tr_b16 a[210:211], v15 offset:15392
    v_mfma_f32_16x16x32_bf16 a[96:99], a[216:219], v[232:235], a[96:99]
    ds_read_b64_tr_b16 a[212:213], v14 offset:10304
    v_mfma_f32_16x16x32_bf16 a[100:103], a[216:219], v[236:239], a[100:103]
    ds_read_b64_tr_b16 a[214:215], v14 offset:15424
    s_waitcnt lgkmcnt(8)
    v_mfma_f32_16x16x32_bf16 a[108:111], a[220:223], v[236:239], a[108:111]
    ds_read_b64_tr_b16 a[216:217], v15 offset:10336
    v_mfma_f32_16x16x32_bf16 a[104:107], a[220:223], v[232:235], a[104:107]
    ds_read_b64_tr_b16 a[218:219], v15 offset:15456
    v_mfma_f32_16x16x32_bf16 a[112:115], a[192:195], v[232:235], a[112:115]
    ds_read_b64_tr_b16 a[220:221], v14 offset:10368
    v_mfma_f32_16x16x32_bf16 a[116:119], a[192:195], v[236:239], a[116:119]
    ds_read_b64_tr_b16 a[222:223], v14 offset:15488
    v_mfma_f32_16x16x32_bf16 a[124:127], a[196:199], v[236:239], a[124:127]
    s_waitcnt vmcnt(12)
    s_barrier
    ds_read_b64_tr_b16 a[192:193], v16 offset:0
    v_mfma_f32_16x16x32_bf16 a[120:123], a[196:199], v[232:235], a[120:123]
    ds_read_b64_tr_b16 a[194:195], v16 offset:5120
    s_waitcnt lgkmcnt(8)
    v_mfma_f32_16x16x32_bf16 a[128:131], a[200:203], v[232:235], a[128:131]
    ds_read_b64_tr_b16 a[196:197], v17 offset:32
    v_mfma_f32_16x16x32_bf16 a[132:135], a[200:203], v[236:239], a[132:135]
    ds_read_b64_tr_b16 a[198:199], v17 offset:5152
    v_mfma_f32_16x16x32_bf16 a[140:143], a[204:207], v[236:239], a[140:143]
    ds_read_b64_tr_b16 a[200:201], v16 offset:64
    v_mfma_f32_16x16x32_bf16 a[136:139], a[204:207], v[232:235], a[136:139]
    ds_read_b64_tr_b16 a[202:203], v16 offset:5184
    v_mfma_f32_16x16x32_bf16 a[144:147], a[208:211], v[232:235], a[144:147]
    ds_read_b64_tr_b16 a[204:205], v17 offset:96
    v_mfma_f32_16x16x32_bf16 a[148:151], a[208:211], v[236:239], a[148:151]
    ds_read_b64_tr_b16 a[206:207], v17 offset:5216
    s_waitcnt lgkmcnt(8)
    v_mfma_f32_16x16x32_bf16 a[156:159], a[212:215], v[236:239], a[156:159]
    ds_read_b64_tr_b16 a[208:209], v16 offset:128
    v_mfma_f32_16x16x32_bf16 a[152:155], a[212:215], v[232:235], a[152:155]
    ds_read_b64_tr_b16 a[210:211], v16 offset:5248
    v_mfma_f32_16x16x32_bf16 a[160:163], a[216:219], v[232:235], a[160:163]
    ds_read_b64_tr_b16 a[212:213], v18 offset:0
    v_mfma_f32_16x16x32_bf16 a[164:167], a[216:219], v[236:239], a[164:167]
    ds_read_b64_tr_b16 a[214:215], v18 offset:5120
    v_mfma_f32_16x16x32_bf16 a[172:175], a[220:223], v[236:239], a[172:175]
    ds_read_b64_tr_b16 a[216:217], v19 offset:32
    v_mfma_f32_16x16x32_bf16 a[168:171], a[220:223], v[232:235], a[168:171]
    ds_read_b64_tr_b16 a[218:219], v19 offset:5152
    s_waitcnt lgkmcnt(8)
    v_mfma_f32_16x16x32_bf16 a[96:99], a[192:195], v[120:123], a[96:99]
    ds_read_b64_tr_b16 a[220:221], v18 offset:64
    v_mfma_f32_16x16x32_bf16 a[100:103], a[192:195], v[124:127], a[100:103]
    ds_read_b64_tr_b16 a[222:223], v18 offset:5184
    v_lshlrev_b32 v9, 3, v0
    v_and_b32 v10, 15, v0
    v_mul_u32_u24 v10, 1280, v10
    v_mfma_f32_16x16x32_bf16 a[108:111], a[196:199], v[124:127], a[108:111]
    ds_read_b64_tr_b16 a[192:193], v19 offset:96
    v_lshrrev_b32 v11, 4, v0
    v_lshl_add_u32 v10, v11, 3, v10
    v_mfma_f32_16x16x32_bf16 a[104:107], a[196:199], v[120:123], a[104:107]
    ds_read_b64_tr_b16 a[194:195], v19 offset:5216
    s_lshl_b32 s50, s64, 2
    s_add_u32 s50, s50, s48
    v_mfma_f32_16x16x32_bf16 a[112:115], a[200:203], v[120:123], a[112:115]
    ds_read_b64_tr_b16 a[196:197], v18 offset:128
    s_lshl_b32 s50, s50, 1
    s_and_b32 s52, s82, 1
    v_mfma_f32_16x16x32_bf16 a[116:119], a[200:203], v[124:127], a[116:119]
    ds_read_b64_tr_b16 a[198:199], v18 offset:5248
    s_add_u32 s50, s50, s52
    s_mul_i32 s50, s50, 20480
    s_waitcnt lgkmcnt(8)
    v_mfma_f32_16x16x32_bf16 a[124:127], a[204:207], v[124:127], a[124:127]
    ds_read_b64_tr_b16 a[200:201], v16 offset:10240
    s_mul_i32 s52, s81, 320
    v_mfma_f32_16x16x32_bf16 a[120:123], a[204:207], v[120:123], a[120:123]
    ds_read_b64_tr_b16 a[202:203], v16 offset:15360
    s_add_u32 s50, s50, s52
    s_lshr_b32 s52, s82, 1
    v_mfma_f32_16x16x32_bf16 a[128:131], a[208:211], v[120:123], a[128:131]
    ds_read_b64_tr_b16 a[204:205], v17 offset:10272
    s_mul_i32 s52, s52, 160
    s_add_u32 s50, s50, s52
    v_mfma_f32_16x16x32_bf16 a[132:135], a[208:211], v[124:127], a[132:135]
    ds_read_b64_tr_b16 a[206:207], v17 offset:15392
    v_mfma_f32_16x16x32_bf16 a[140:143], a[212:215], v[124:127], a[140:143]
    ds_read_b64_tr_b16 a[208:209], v16 offset:10304
    v_mfma_f32_16x16x32_bf16 a[136:139], a[212:215], v[120:123], a[136:139]
    ds_read_b64_tr_b16 a[210:211], v16 offset:15424
    s_waitcnt lgkmcnt(8)
    v_mfma_f32_16x16x32_bf16 a[144:147], a[216:219], v[120:123], a[144:147]
    ds_read_b64_tr_b16 a[212:213], v17 offset:10336
    v_mfma_f32_16x16x32_bf16 a[148:151], a[216:219], v[124:127], a[148:151]
    ds_read_b64_tr_b16 a[214:215], v17 offset:15456
    v_mfma_f32_16x16x32_bf16 a[156:159], a[220:223], v[124:127], a[156:159]
    ds_read_b64_tr_b16 a[216:217], v16 offset:10368
    v_mfma_f32_16x16x32_bf16 a[152:155], a[220:223], v[120:123], a[152:155]
    ds_read_b64_tr_b16 a[218:219], v16 offset:15488
    v_mfma_f32_16x16x32_bf16 a[160:163], a[192:195], v[120:123], a[160:163]
    ds_read_b64_tr_b16 a[220:221], v18 offset:10240
    v_mfma_f32_16x16x32_bf16 a[164:167], a[192:195], v[124:127], a[164:167]
    ds_read_b64_tr_b16 a[222:223], v18 offset:15360
    s_waitcnt lgkmcnt(8)
    v_mfma_f32_16x16x32_bf16 a[172:175], a[196:199], v[124:127], a[172:175]
    ds_read_b64_tr_b16 a[192:193], v19 offset:10272
    v_mfma_f32_16x16x32_bf16 a[168:171], a[196:199], v[120:123], a[168:171]
    ds_read_b64_tr_b16 a[194:195], v19 offset:15392
    v_mfma_f32_16x16x32_bf16 a[96:99], a[200:203], v[136:139], a[96:99]
    ds_read_b64_tr_b16 a[196:197], v18 offset:10304
    v_mfma_f32_16x16x32_bf16 a[100:103], a[200:203], v[140:143], a[100:103]
    ds_read_b64_tr_b16 a[198:199], v18 offset:15424
    v_mfma_f32_16x16x32_bf16 a[108:111], a[204:207], v[140:143], a[108:111]
    ds_read_b64_tr_b16 a[200:201], v19 offset:10336
    v_mfma_f32_16x16x32_bf16 a[104:107], a[204:207], v[136:139], a[104:107]
    ds_read_b64_tr_b16 a[202:203], v19 offset:15456
    s_waitcnt lgkmcnt(8)
    v_mfma_f32_16x16x32_bf16 a[112:115], a[208:211], v[136:139], a[112:115]
    ds_read_b64_tr_b16 a[204:205], v18 offset:10368
    v_mfma_f32_16x16x32_bf16 a[116:119], a[208:211], v[140:143], a[116:119]
    ds_read_b64_tr_b16 a[206:207], v18 offset:15488
    v_mfma_f32_16x16x32_bf16 a[124:127], a[212:215], v[140:143], a[124:127]
    ds_read_b64_tr_b16 a[208:209], v12 offset:24576
    v_mfma_f32_16x16x32_bf16 a[120:123], a[212:215], v[136:139], a[120:123]
    ds_read_b64_tr_b16 a[210:211], v12 offset:29696
    v_mfma_f32_16x16x32_bf16 a[128:131], a[216:219], v[136:139], a[128:131]
    ds_read_b64_tr_b16 a[212:213], v13 offset:24608
    v_mfma_f32_16x16x32_bf16 a[132:135], a[216:219], v[140:143], a[132:135]
    ds_read_b64_tr_b16 a[214:215], v13 offset:29728
    s_waitcnt lgkmcnt(8)
    v_mfma_f32_16x16x32_bf16 a[140:143], a[220:223], v[140:143], a[140:143]
    ds_read_b64_tr_b16 a[216:217], v12 offset:24640
    v_mfma_f32_16x16x32_bf16 a[136:139], a[220:223], v[136:139], a[136:139]
    ds_read_b64_tr_b16 a[218:219], v12 offset:29760
    v_mfma_f32_16x16x32_bf16 a[144:147], a[192:195], v[136:139], a[144:147]
    ds_read_b64_tr_b16 a[220:221], v13 offset:24672
    v_mfma_f32_16x16x32_bf16 a[148:151], a[192:195], v[140:143], a[148:151]
    ds_read_b64_tr_b16 a[222:223], v13 offset:29792
    v_mfma_f32_16x16x32_bf16 a[156:159], a[196:199], v[140:143], a[156:159]
    ds_read_b64_tr_b16 a[192:193], v12 offset:24704
    v_mfma_f32_16x16x32_bf16 a[152:155], a[196:199], v[136:139], a[152:155]
    ds_read_b64_tr_b16 a[194:195], v12 offset:29824
    s_waitcnt lgkmcnt(8)
    v_mfma_f32_16x16x32_bf16 a[160:163], a[200:203], v[136:139], a[160:163]
    ds_read_b64_tr_b16 a[196:197], v14 offset:24576
    v_mfma_f32_16x16x32_bf16 a[164:167], a[200:203], v[140:143], a[164:167]
    ds_read_b64_tr_b16 a[198:199], v14 offset:29696
    s_waitcnt vmcnt(6)
    v_mfma_f32_16x16x32_bf16 a[172:175], a[204:207], v[140:143], a[172:175]
    ds_read_b64_tr_b16 a[200:201], v15 offset:24608
    v_mfma_f32_16x16x32_bf16 a[168:171], a[204:207], v[136:139], a[168:171]
    ds_read_b64_tr_b16 a[202:203], v15 offset:29728
    v_mfma_f32_16x16x32_bf16 a[96:99], a[208:211], v[152:155], a[96:99]
    ds_read_b64_tr_b16 a[204:205], v14 offset:24640
    v_mfma_f32_16x16x32_bf16 a[100:103], a[208:211], v[156:159], a[100:103]
    ds_read_b64_tr_b16 a[206:207], v14 offset:29760
    s_waitcnt lgkmcnt(8)
    v_mfma_f32_16x16x32_bf16 a[108:111], a[212:215], v[156:159], a[108:111]
    ds_read_b64_tr_b16 a[208:209], v15 offset:24672
    v_mfma_f32_16x16x32_bf16 a[104:107], a[212:215], v[152:155], a[104:107]
    ds_read_b64_tr_b16 a[210:211], v15 offset:29792
    v_mfma_f32_16x16x32_bf16 a[112:115], a[216:219], v[152:155], a[112:115]
    ds_read_b64_tr_b16 a[212:213], v14 offset:24704
    v_mfma_f32_16x16x32_bf16 a[116:119], a[216:219], v[156:159], a[116:119]
    ds_read_b64_tr_b16 a[214:215], v14 offset:29824
    v_mfma_f32_16x16x32_bf16 a[124:127], a[220:223], v[156:159], a[124:127]
    ds_read_b64_tr_b16 a[216:217], v12 offset:34816
    v_mfma_f32_16x16x32_bf16 a[120:123], a[220:223], v[152:155], a[120:123]
    ds_read_b64_tr_b16 a[218:219], v12 offset:39936
    s_waitcnt lgkmcnt(8)
    v_mfma_f32_16x16x32_bf16 a[128:131], a[192:195], v[152:155], a[128:131]
    ds_read_b64_tr_b16 a[220:221], v13 offset:34848
    v_mfma_f32_16x16x32_bf16 a[132:135], a[192:195], v[156:159], a[132:135]
    ds_read_b64_tr_b16 a[222:223], v13 offset:39968
    v_mfma_f32_16x16x32_bf16 a[140:143], a[196:199], v[156:159], a[140:143]
    ds_read_b64_tr_b16 a[192:193], v12 offset:34880
    v_mfma_f32_16x16x32_bf16 a[136:139], a[196:199], v[152:155], a[136:139]
    ds_read_b64_tr_b16 a[194:195], v12 offset:40000
    v_mfma_f32_16x16x32_bf16 a[144:147], a[200:203], v[152:155], a[144:147]
    ds_read_b64_tr_b16 a[196:197], v13 offset:34912
    v_mfma_f32_16x16x32_bf16 a[148:151], a[200:203], v[156:159], a[148:151]
    ds_read_b64_tr_b16 a[198:199], v13 offset:40032
    s_waitcnt lgkmcnt(8)
    v_mfma_f32_16x16x32_bf16 a[156:159], a[204:207], v[156:159], a[156:159]
    ds_read_b64_tr_b16 a[200:201], v12 offset:34944
    v_mfma_f32_16x16x32_bf16 a[152:155], a[204:207], v[152:155], a[152:155]
    ds_read_b64_tr_b16 a[202:203], v12 offset:40064
    v_mfma_f32_16x16x32_bf16 a[160:163], a[208:211], v[152:155], a[160:163]
    ds_read_b64_tr_b16 a[204:205], v14 offset:34816
    v_mfma_f32_16x16x32_bf16 a[164:167], a[208:211], v[156:159], a[164:167]
    ds_read_b64_tr_b16 a[206:207], v14 offset:39936
    v_mfma_f32_16x16x32_bf16 a[172:175], a[212:215], v[156:159], a[172:175]
    ds_read_b64_tr_b16 a[208:209], v15 offset:34848
    v_mfma_f32_16x16x32_bf16 a[168:171], a[212:215], v[152:155], a[168:171]
    ds_read_b64_tr_b16 a[210:211], v15 offset:39968
    s_waitcnt lgkmcnt(8)
    v_mfma_f32_16x16x32_bf16 a[96:99], a[216:219], v[168:171], a[96:99]
    ds_read_b64_tr_b16 a[212:213], v14 offset:34880
    v_mfma_f32_16x16x32_bf16 a[100:103], a[216:219], v[172:175], a[100:103]
    ds_read_b64_tr_b16 a[214:215], v14 offset:40000
    v_mfma_f32_16x16x32_bf16 a[108:111], a[220:223], v[172:175], a[108:111]
    ds_read_b64_tr_b16 a[216:217], v15 offset:34912
    v_mfma_f32_16x16x32_bf16 a[104:107], a[220:223], v[168:171], a[104:107]
    ds_read_b64_tr_b16 a[218:219], v15 offset:40032
    v_mfma_f32_16x16x32_bf16 a[112:115], a[192:195], v[168:171], a[112:115]
    ds_read_b64_tr_b16 a[220:221], v14 offset:34944
    v_mfma_f32_16x16x32_bf16 a[116:119], a[192:195], v[172:175], a[116:119]
    ds_read_b64_tr_b16 a[222:223], v14 offset:40064
    s_waitcnt lgkmcnt(8)
    v_mfma_f32_16x16x32_bf16 a[124:127], a[196:199], v[172:175], a[124:127]
    s_waitcnt vmcnt(0)
    s_barrier
    ds_read_b64_tr_b16 a[192:193], v18 offset:24576
    v_mfma_f32_16x16x32_bf16 a[120:123], a[196:199], v[168:171], a[120:123]
    ds_read_b64_tr_b16 a[194:195], v18 offset:29696
    v_mfma_f32_16x16x32_bf16 a[128:131], a[200:203], v[168:171], a[128:131]
    ds_read_b64_tr_b16 a[196:197], v19 offset:24608
    v_mfma_f32_16x16x32_bf16 a[132:135], a[200:203], v[172:175], a[132:135]
    ds_read_b64_tr_b16 a[198:199], v19 offset:29728
    v_mfma_f32_16x16x32_bf16 a[140:143], a[204:207], v[172:175], a[140:143]
    ds_read_b64_tr_b16 a[200:201], v18 offset:24640
    v_mfma_f32_16x16x32_bf16 a[136:139], a[204:207], v[168:171], a[136:139]
    ds_read_b64_tr_b16 a[202:203], v18 offset:29760
    s_waitcnt lgkmcnt(8)
    v_mfma_f32_16x16x32_bf16 a[144:147], a[208:211], v[168:171], a[144:147]
    ds_read_b64_tr_b16 a[204:205], v19 offset:24672
    v_mfma_f32_16x16x32_bf16 a[148:151], a[208:211], v[172:175], a[148:151]
    ds_read_b64_tr_b16 a[206:207], v19 offset:29792
    v_mfma_f32_16x16x32_bf16 a[156:159], a[212:215], v[172:175], a[156:159]
    ds_read_b64_tr_b16 a[208:209], v18 offset:24704
    v_mfma_f32_16x16x32_bf16 a[152:155], a[212:215], v[168:171], a[152:155]
    ds_read_b64_tr_b16 a[210:211], v18 offset:29824
    v_mfma_f32_16x16x32_bf16 a[160:163], a[216:219], v[168:171], a[160:163]
    ds_read_b64_tr_b16 a[212:213], v18 offset:34816
    v_mfma_f32_16x16x32_bf16 a[164:167], a[216:219], v[172:175], a[164:167]
    ds_read_b64_tr_b16 a[214:215], v18 offset:39936
    s_waitcnt lgkmcnt(8)
    v_mfma_f32_16x16x32_bf16 a[172:175], a[220:223], v[172:175], a[172:175]
    ds_read_b64_tr_b16 a[216:217], v19 offset:34848
    v_mfma_f32_16x16x32_bf16 a[168:171], a[220:223], v[168:171], a[168:171]
    ds_read_b64_tr_b16 a[218:219], v19 offset:39968
    v_mfma_f32_16x16x32_bf16 a[136:139], a[192:195], v[184:187], a[136:139]
    ds_read_b64_tr_b16 a[220:221], v18 offset:34880
    v_mfma_f32_16x16x32_bf16 a[140:143], a[192:195], v[188:191], a[140:143]
    ds_read_b64_tr_b16 a[222:223], v18 offset:40000
    v_mfma_f32_16x16x32_bf16 a[148:151], a[196:199], v[188:191], a[148:151]
    ds_read_b64_tr_b16 a[192:193], v19 offset:34912
    v_mfma_f32_16x16x32_bf16 a[144:147], a[196:199], v[184:187], a[144:147]
    ds_read_b64_tr_b16 a[194:195], v19 offset:40032
    s_waitcnt lgkmcnt(8)
    v_mfma_f32_16x16x32_bf16 a[152:155], a[200:203], v[184:187], a[152:155]
    ds_read_b64_tr_b16 a[196:197], v18 offset:34944
    v_mfma_f32_16x16x32_bf16 a[156:159], a[200:203], v[188:191], a[156:159]
    ds_read_b64_tr_b16 a[198:199], v18 offset:40064
    v_mfma_f32_16x16x32_bf16 a[164:167], a[204:207], v[188:191], a[164:167]
    ds_read_b64_tr_b16 a[200:201], v16 offset:24576
    v_mfma_f32_16x16x32_bf16 a[160:163], a[204:207], v[184:187], a[160:163]
    ds_read_b64_tr_b16 a[202:203], v16 offset:29696
    v_mfma_f32_16x16x32_bf16 a[168:171], a[208:211], v[184:187], a[168:171]
    ds_read_b64_tr_b16 a[204:205], v17 offset:24608
    v_mfma_f32_16x16x32_bf16 a[172:175], a[208:211], v[188:191], a[172:175]
    ds_read_b64_tr_b16 a[206:207], v17 offset:29728
    s_waitcnt lgkmcnt(8)
    v_mfma_f32_16x16x32_bf16 a[140:143], a[212:215], v[204:207], a[140:143]
    ds_read_b64_tr_b16 a[208:209], v16 offset:24640
    v_mfma_f32_16x16x32_bf16 a[136:139], a[212:215], v[200:203], a[136:139]
    ds_read_b64_tr_b16 a[210:211], v16 offset:29760
    v_mfma_f32_16x16x32_bf16 a[144:147], a[216:219], v[200:203], a[144:147]
    ds_read_b64_tr_b16 a[212:213], v17 offset:24672
    v_mfma_f32_16x16x32_bf16 a[148:151], a[216:219], v[204:207], a[148:151]
    ds_read_b64_tr_b16 a[214:215], v17 offset:29792
    v_mfma_f32_16x16x32_bf16 a[156:159], a[220:223], v[204:207], a[156:159]
    ds_read_b64_tr_b16 a[216:217], v16 offset:24704
    v_mfma_f32_16x16x32_bf16 a[152:155], a[220:223], v[200:203], a[152:155]
    ds_read_b64_tr_b16 a[218:219], v16 offset:29824
    s_waitcnt lgkmcnt(8)
    v_mfma_f32_16x16x32_bf16 a[160:163], a[192:195], v[200:203], a[160:163]
    ds_read_b64_tr_b16 a[220:221], v16 offset:34816
    v_mfma_f32_16x16x32_bf16 a[164:167], a[192:195], v[204:207], a[164:167]
    ds_read_b64_tr_b16 a[222:223], v16 offset:39936
    v_mfma_f32_16x16x32_bf16 a[172:175], a[196:199], v[204:207], a[172:175]
    ds_read_b64_tr_b16 a[192:193], v17 offset:34848
    v_mfma_f32_16x16x32_bf16 a[168:171], a[196:199], v[200:203], a[168:171]
    ds_read_b64_tr_b16 a[194:195], v17 offset:39968
    v_mfma_f32_16x16x32_bf16 a[96:99], a[200:203], v[184:187], a[96:99]
    ds_read_b64_tr_b16 a[196:197], v16 offset:34880
    v_mfma_f32_16x16x32_bf16 a[100:103], a[200:203], v[188:191], a[100:103]
    ds_read_b64_tr_b16 a[198:199], v16 offset:40000
    v_accvgpr_read_b32 v84, a136
    v_accvgpr_read_b32 v85, a137
    v_accvgpr_read_b32 v86, a138
    s_waitcnt lgkmcnt(8)
    v_mfma_f32_16x16x32_bf16 a[108:111], a[204:207], v[188:191], a[108:111]
    ds_read_b64_tr_b16 a[200:201], v17 offset:34912
    v_accvgpr_read_b32 v87, a139
    v_mfma_f32_16x16x32_bf16 a[104:107], a[204:207], v[184:187], a[104:107]
    ds_read_b64_tr_b16 a[202:203], v17 offset:40032
    v_cvt_pk_bf16_f32 v60, v84, v85
    v_cvt_pk_bf16_f32 v61, v86, v87
    v_mfma_f32_16x16x32_bf16 a[112:115], a[208:211], v[184:187], a[112:115]
    ds_read_b64_tr_b16 a[204:205], v16 offset:34944
    v_accvgpr_read_b32 v88, a144
    v_accvgpr_read_b32 v89, a145
    v_mfma_f32_16x16x32_bf16 a[116:119], a[208:211], v[188:191], a[116:119]
    ds_read_b64_tr_b16 a[206:207], v16 offset:40064
    v_accvgpr_read_b32 v90, a146
    v_accvgpr_read_b32 v91, a147
    v_mfma_f32_16x16x32_bf16 a[124:127], a[212:215], v[188:191], a[124:127]
    v_cvt_pk_bf16_f32 v62, v88, v89
    v_cvt_pk_bf16_f32 v63, v90, v91
    v_accvgpr_read_b32 v92, a152
    v_mfma_f32_16x16x32_bf16 a[120:123], a[212:215], v[184:187], a[120:123]
    v_accvgpr_read_b32 v93, a153
    v_accvgpr_read_b32 v94, a154
    v_accvgpr_read_b32 v95, a155
    s_waitcnt lgkmcnt(6)
    v_mfma_f32_16x16x32_bf16 a[128:131], a[216:219], v[184:187], a[128:131]
    v_cvt_pk_bf16_f32 v64, v92, v93
    v_cvt_pk_bf16_f32 v65, v94, v95
    v_mfma_f32_16x16x32_bf16 a[132:135], a[216:219], v[188:191], a[132:135]
    v_accvgpr_read_b32 v84, a160
    v_accvgpr_read_b32 v85, a161
    v_accvgpr_read_b32 v86, a162
    v_mfma_f32_16x16x32_bf16 a[100:103], a[220:223], v[204:207], a[100:103]
    v_accvgpr_read_b32 v87, a163
    v_cvt_pk_bf16_f32 v66, v84, v85
    v_cvt_pk_bf16_f32 v67, v86, v87
    v_mfma_f32_16x16x32_bf16 a[96:99], a[220:223], v[200:203], a[96:99]
    v_accvgpr_read_b32 v88, a168
    v_accvgpr_read_b32 v89, a169
    v_accvgpr_read_b32 v90, a170
    v_mfma_f32_16x16x32_bf16 a[104:107], a[192:195], v[200:203], a[104:107]
    v_accvgpr_read_b32 v91, a171
    v_cvt_pk_bf16_f32 v68, v88, v89
    v_cvt_pk_bf16_f32 v69, v90, v91
    v_mfma_f32_16x16x32_bf16 a[108:111], a[192:195], v[204:207], a[108:111]
    buffer_store_dwordx4 v[60:63], v35, s[24:27], s39 offen sc1
    buffer_store_dwordx4 v[64:67], v35, s[24:27], s39 offen offset:1024 sc1
    s_waitcnt lgkmcnt(0)
    v_mfma_f32_16x16x32_bf16 a[116:119], a[196:199], v[204:207], a[116:119]
    buffer_store_dwordx2 v[68:69], v9, s[24:27], s39 offen offset:2048 sc1
    v_mfma_f32_16x16x32_bf16 a[112:115], a[196:199], v[200:203], a[112:115]
    v_accvgpr_read_b32 v84, a140
    v_accvgpr_read_b32 v85, a141
    v_mfma_f32_16x16x32_bf16 a[120:123], a[200:203], v[200:203], a[120:123]
    v_accvgpr_read_b32 v86, a142
    v_accvgpr_read_b32 v87, a143
    v_cvt_pk_bf16_f32 v72, v84, v85
    v_mfma_f32_16x16x32_bf16 a[124:127], a[200:203], v[204:207], a[124:127]
    v_cvt_pk_bf16_f32 v73, v86, v87
    v_accvgpr_read_b32 v88, a148
    v_accvgpr_read_b32 v89, a149
    v_mfma_f32_16x16x32_bf16 a[132:135], a[204:207], v[204:207], a[132:135]
    v_accvgpr_read_b32 v90, a150
    v_accvgpr_read_b32 v91, a151
    v_cvt_pk_bf16_f32 v74, v88, v89
    v_mfma_f32_16x16x32_bf16 a[128:131], a[204:207], v[200:203], a[128:131]
    v_cvt_pk_bf16_f32 v75, v90, v91
    v_accvgpr_read_b32 v92, a156
    v_accvgpr_read_b32 v93, a157
    v_accvgpr_read_b32 v94, a158
    v_accvgpr_read_b32 v95, a159
    v_cvt_pk_bf16_f32 v76, v92, v93
    v_cvt_pk_bf16_f32 v77, v94, v95
    v_accvgpr_read_b32 v84, a164
    v_accvgpr_read_b32 v85, a165
    v_accvgpr_read_b32 v86, a166
    v_accvgpr_read_b32 v87, a167
    v_cvt_pk_bf16_f32 v78, v84, v85
    v_cvt_pk_bf16_f32 v79, v86, v87
    v_accvgpr_read_b32 v88, a172
    v_accvgpr_read_b32 v89, a173
    v_accvgpr_read_b32 v90, a174
    v_accvgpr_read_b32 v91, a175
    v_cvt_pk_bf16_f32 v80, v88, v89
    v_cvt_pk_bf16_f32 v81, v90, v91
    buffer_store_dwordx4 v[72:75], v35, s[24:27], s40 offen sc1
    buffer_store_dwordx4 v[76:79], v35, s[24:27], s40 offen offset:1024 sc1
    buffer_store_dwordx2 v[80:81], v9, s[24:27], s40 offen offset:2048 sc1
    v_accvgpr_read_b32 v84, a100
    v_accvgpr_read_b32 v85, a101
    v_accvgpr_read_b32 v86, a102
    v_accvgpr_read_b32 v87, a103
    v_cvt_pk_bf16_f32 v48, v84, v85
    v_cvt_pk_bf16_f32 v49, v86, v87
    v_accvgpr_read_b32 v88, a108
    v_accvgpr_read_b32 v89, a109
    v_accvgpr_read_b32 v90, a110
    v_accvgpr_read_b32 v91, a111
    v_cvt_pk_bf16_f32 v50, v88, v89
    v_cvt_pk_bf16_f32 v51, v90, v91
    v_accvgpr_read_b32 v92, a116
    v_accvgpr_read_b32 v93, a117
    v_accvgpr_read_b32 v94, a118
    v_accvgpr_read_b32 v95, a119
    v_cvt_pk_bf16_f32 v52, v92, v93
    v_cvt_pk_bf16_f32 v53, v94, v95
    v_accvgpr_read_b32 v84, a124
    v_accvgpr_read_b32 v85, a125
    v_accvgpr_read_b32 v86, a126
    v_accvgpr_read_b32 v87, a127
    v_cvt_pk_bf16_f32 v54, v84, v85
    v_cvt_pk_bf16_f32 v55, v86, v87
    v_accvgpr_read_b32 v88, a132
    v_accvgpr_read_b32 v89, a133
    v_accvgpr_read_b32 v90, a134
    v_accvgpr_read_b32 v91, a135
    v_cvt_pk_bf16_f32 v56, v88, v89
    v_cvt_pk_bf16_f32 v57, v90, v91
    buffer_store_dwordx4 v[48:51], v35, s[24:27], s38 offen sc1
    buffer_store_dwordx4 v[52:55], v35, s[24:27], s38 offen offset:1024 sc1
    buffer_store_dwordx2 v[56:57], v9, s[24:27], s38 offen offset:2048 sc1
    v_accvgpr_read_b32 v208, a96
    v_accvgpr_read_b32 v209, a97
    v_accvgpr_read_b32 v210, a98
    v_accvgpr_read_b32 v211, a99
    v_accvgpr_read_b32 v212, a104
    v_accvgpr_read_b32 v213, a105
    v_accvgpr_read_b32 v214, a106
    v_accvgpr_read_b32 v215, a107
    v_accvgpr_read_b32 v216, a112
    v_accvgpr_read_b32 v217, a113
    v_accvgpr_read_b32 v218, a114
    v_accvgpr_read_b32 v219, a115
    v_accvgpr_read_b32 v220, a120
    v_accvgpr_read_b32 v221, a121
    v_accvgpr_read_b32 v222, a122
    v_accvgpr_read_b32 v223, a123
    v_accvgpr_read_b32 v224, a128
    v_accvgpr_read_b32 v225, a129
    v_accvgpr_read_b32 v226, a130
    v_accvgpr_read_b32 v227, a131
    s_waitcnt vmcnt(0)
    v_mov_b32 v8, 1
    s_mov_b64 exec, 1
    buffer_store_dword v8, off, s[24:27], s99 sc1
    s_mov_b64 exec, -1
    buffer_load_dwordx4 v[252:255], off, s[24:27], s100 sc1
    s_waitcnt vmcnt(0)
L_c3:
    v_and_b32 v252, v252, v253
    v_and_b32 v254, v254, v255
    v_and_b32 v252, v252, v254
    s_nop 0
    v_readfirstlane_b32 s52, v252
    s_cmp_eq_u32 s52, 1
    s_cbranch_scc1 L_c3d
    buffer_load_dwordx4 v[252:255], off, s[24:27], s100 sc1
    s_waitcnt vmcnt(0)
    s_sub_u32 s96, s96, 1
    s_cbranch_scc0 L_c3
    s_mov_b32 s96, 0
L_c3d:
    buffer_load_dwordx4 v[112:115], v35, s[24:27], s42 offen sc1
    buffer_load_dwordx4 v[116:119], v35, s[24:27], s42 offen offset:1024 sc1
    buffer_load_dwordx2 v[120:121], v9, s[24:27], s42 offen offset:2048 sc1
    buffer_load_dwordx4 v[128:131], v35, s[24:27], s43 offen sc1
    buffer_load_dwordx4 v[132:135], v35, s[24:27], s43 offen offset:1024 sc1
    buffer_load_dwordx2 v[136:137], v9, s[24:27], s43 offen offset:2048 sc1
    buffer_load_dwordx4 v[144:147], v35, s[24:27], s44 offen sc1
    buffer_load_dwordx4 v[148:151], v35, s[24:27], s44 offen offset:1024 sc1
    buffer_load_dwordx2 v[152:153], v9, s[24:27], s44 offen offset:2048 sc1
    s_waitcnt vmcnt(6)
    v_lshlrev_b32 v124, 16, v112
    v_and_b32 v125, 0xffff0000, v112
    v_pk_add_f32 v[208:209], v[208:209], v[124:125]
    v_lshlrev_b32 v126, 16, v113
    v_and_b32 v127, 0xffff0000, v113
    v_pk_add_f32 v[210:211], v[210:211], v[126:127]
    v_lshlrev_b32 v124, 16, v114
    v_and_b32 v125, 0xffff0000, v114
    v_pk_add_f32 v[212:213], v[212:213], v[124:125]
    v_lshlrev_b32 v126, 16, v115
    v_and_b32 v127, 0xffff0000, v115
    v_pk_add_f32 v[214:215], v[214:215], v[126:127]
    v_lshlrev_b32 v124, 16, v116
    v_and_b32 v125, 0xffff0000, v116
    v_pk_add_f32 v[216:217], v[216:217], v[124:125]
    v_lshlrev_b32 v126, 16, v117
    v_and_b32 v127, 0xffff0000, v117
    v_pk_add_f32 v[218:219], v[218:219], v[126:127]
    v_lshlrev_b32 v124, 16, v118
    v_and_b32 v125, 0xffff0000, v118
    v_pk_add_f32 v[220:221], v[220:221], v[124:125]
    v_lshlrev_b32 v126, 16, v119
    v_and_b32 v127, 0xffff0000, v119
    v_pk_add_f32 v[222:223], v[222:223], v[126:127]
    v_lshlrev_b32 v124, 16, v120
    v_and_b32 v125, 0xffff0000, v120
    v_pk_add_f32 v[224:225], v[224:225], v[124:125]
    v_lshlrev_b32 v126, 16, v121
    v_and_b32 v127, 0xffff0000, v121
    v_pk_add_f32 v[226:227], v[226:227], v[126:127]
    s_waitcnt vmcnt(3)
    v_lshlrev_b32 v140, 16, v128
    v_and_b32 v141, 0xffff0000, v128
    v_pk_add_f32 v[208:209], v[208:209], v[140:141]
    v_lshlrev_b32 v142, 16, v129
    v_and_b32 v143, 0xffff0000, v129
    v_pk_add_f32 v[210:211], v[210:211], v[142:143]
    v_lshlrev_b32 v140, 16, v130
    v_and_b32 v141, 0xffff0000, v130
    v_pk_add_f32 v[212:213], v[212:213], v[140:141]
    v_lshlrev_b32 v142, 16, v131
    v_and_b32 v143, 0xffff0000, v131
    v_pk_add_f32 v[214:215], v[214:215], v[142:143]
    v_lshlrev_b32 v140, 16, v132
    v_and_b32 v141, 0xffff0000, v132
    v_pk_add_f32 v[216:217], v[216:217], v[140:141]
    v_lshlrev_b32 v142, 16, v133
    v_and_b32 v143, 0xffff0000, v133
    v_pk_add_f32 v[218:219], v[218:219], v[142:143]
    v_lshlrev_b32 v140, 16, v134
    v_and_b32 v141, 0xffff0000, v134
    v_pk_add_f32 v[220:221], v[220:221], v[140:141]
    v_lshlrev_b32 v142, 16, v135
    v_and_b32 v143, 0xffff0000, v135
    v_pk_add_f32 v[222:223], v[222:223], v[142:143]
    v_lshlrev_b32 v140, 16, v136
    v_and_b32 v141, 0xffff0000, v136
    v_pk_add_f32 v[224:225], v[224:225], v[140:141]
    v_lshlrev_b32 v142, 16, v137
    v_and_b32 v143, 0xffff0000, v137
    v_pk_add_f32 v[226:227], v[226:227], v[142:143]
    s_waitcnt vmcnt(0)
    v_lshlrev_b32 v156, 16, v144
    v_and_b32 v157, 0xffff0000, v144
    v_pk_add_f32 v[208:209], v[208:209], v[156:157]
    v_lshlrev_b32 v158, 16, v145
    v_and_b32 v159, 0xffff0000, v145
    v_pk_add_f32 v[210:211], v[210:211], v[158:159]
    v_cvt_pk_bf16_f32 v208, v208, v209
    v_cvt_pk_bf16_f32 v209, v210, v211
    buffer_store_dwordx2 v[208:209], v10, s[88:91], s50 offen offset:0 sc1
    v_lshlrev_b32 v156, 16, v146
    v_and_b32 v157, 0xffff0000, v146
    v_pk_add_f32 v[212:213], v[212:213], v[156:157]
    v_lshlrev_b32 v158, 16, v147
    v_and_b32 v159, 0xffff0000, v147
    v_pk_add_f32 v[214:215], v[214:215], v[158:159]
    v_cvt_pk_bf16_f32 v212, v212, v213
    v_cvt_pk_bf16_f32 v213, v214, v215
    buffer_store_dwordx2 v[212:213], v10, s[88:91], s50 offen offset:32 sc1
    v_lshlrev_b32 v156, 16, v148
    v_and_b32 v157, 0xffff0000, v148
    v_pk_add_f32 v[216:217], v[216:217], v[156:157]
    v_lshlrev_b32 v158, 16, v149
    v_and_b32 v159, 0xffff0000, v149
    v_pk_add_f32 v[218:219], v[218:219], v[158:159]
    v_cvt_pk_bf16_f32 v216, v216, v217
    v_cvt_pk_bf16_f32 v217, v218, v219
    buffer_store_dwordx2 v[216:217], v10, s[88:91], s50 offen offset:64 sc1
    v_lshlrev_b32 v156, 16, v150
    v_and_b32 v157, 0xffff0000, v150
    v_pk_add_f32 v[220:221], v[220:221], v[156:157]
    v_lshlrev_b32 v158, 16, v151
    v_and_b32 v159, 0xffff0000, v151
    v_pk_add_f32 v[222:223], v[222:223], v[158:159]
    v_cvt_pk_bf16_f32 v220, v220, v221
    v_cvt_pk_bf16_f32 v221, v222, v223
    buffer_store_dwordx2 v[220:221], v10, s[88:91], s50 offen offset:96 sc1
    v_lshlrev_b32 v156, 16, v152
    v_and_b32 v157, 0xffff0000, v152
    v_pk_add_f32 v[224:225], v[224:225], v[156:157]
    v_lshlrev_b32 v158, 16, v153
    v_and_b32 v159, 0xffff0000, v153
    v_pk_add_f32 v[226:227], v[226:227], v[158:159]
    v_cvt_pk_bf16_f32 v224, v224, v225
    v_cvt_pk_bf16_f32 v225, v226, v227
    buffer_store_dwordx2 v[224:225], v10, s[88:91], s50 offen offset:128 sc1
L_end:
    s_endpgm
.section .rodata,"a"
.p2align 6
.amdhsa_kernel standalone__gqa_block_cached__near_ridge_kernel
  .amdhsa_next_free_vgpr 512
  .amdhsa_next_free_sgpr 102
  .amdhsa_accum_offset 256
  .amdhsa_group_segment_fixed_size 0
  .amdhsa_kernarg_size 64
  .amdhsa_user_sgpr_count 2
  .amdhsa_user_sgpr_kernarg_segment_ptr 1
  .amdhsa_system_sgpr_workgroup_id_x 1
.end_amdhsa_kernel
```
